```python
import torch

def _softmax(x, axis=-1):
    return torch.softmax(x, dim=axis)
def _gelu(x):
    return torch.nn.functional.gelu(x, approximate="tanh")
def _silu(x):
    return torch.nn.functional.silu(x)
def _sigmoid(x):
    return torch.sigmoid(x)
def _layernorm(x, axis=-1, eps=1e-5):
    m = x.mean(dim=axis, keepdim=True)
    v = x.var(dim=axis, keepdim=True, unbiased=False)
    return (x - m) / torch.sqrt(v + eps)
def _scatter_add(tgt, idx, src, axis=0):
    return tgt.clone().index_add_(axis, idx, src)
def _segment_sum(src, seg, n):
    out = torch.zeros((n,) + src.shape[1:], dtype=src.dtype)
    return out.index_add_(0, seg, src)
def _pad(x, pw):
    flat = tuple(v for pair in reversed(pw) for v in pair)
    return torch.nn.functional.pad(x, flat)

kernel_name = 'gated_mix__spectral_gfnet__softmax_full_mha__prompt'

def setup_inputs():

    _w = (lambda a: (lambda t: t.to(torch.bfloat16) if t.is_floating_point() else t)(torch.as_tensor(a)))
    def _A_setup():
        B, S, D = 1, 2048, 448
        Df = D // 2 + 1
        return {
            "x": _w((lambda *s: torch.randn(*s, dtype=torch.bfloat16) * 0.05)(B, S, D)),
            "w_r": _w((lambda *s: torch.randn(*s, dtype=torch.bfloat16) * 6.4)(S, Df) * 0.02),
            "w_i": _w((lambda *s: torch.randn(*s, dtype=torch.bfloat16) * 6.4)(S, Df) * 0.02),
        }
    _A_in = _A_setup()

    def _B_setup():
        B, S, D = 1, 2048, 448
        return {
            "x": _w((lambda *s: torch.randn(*s, dtype=torch.bfloat16) * 0.05)(B, S, D)),
            "wqkv": _w((lambda *s: torch.randn(*s, dtype=torch.bfloat16) * 0.8)(D, 3 * D)),
            "wo": _w((lambda *s: torch.randn(*s, dtype=torch.bfloat16) * 0.05)(D, D)),
        }
    _B_in = _B_setup()

    return {
        "A_x": _A_in["x"],
        "A_w_r": _A_in["w_r"],
        "A_w_i": _A_in["w_i"],
        "B_x": _B_in["x"],
        "B_wqkv": _B_in["wqkv"],
        "B_wo": _B_in["wo"],
        "gate_w": _w((lambda *s: torch.randn(*s, dtype=torch.bfloat16) * 0.05)(448) * 16.0),
    }

def reference(A_x, A_w_r, A_w_i, B_x, B_wqkv, B_wo, gate_w):
    def _A_ref(x, w_r, w_i):
        B, S, D = x.shape
        X = (lambda x, axes=(-2,-1): torch.fft.rfft2(x.float(), dim=axes))(x, axes=(-2, -1))
        W = w_r + 1j * w_i
        X = X * W
        y = (lambda x, s, axes=(-2,-1): torch.fft.irfft2(x, s=s, dim=axes).to(torch.bfloat16))(X, (S, D), axes=(-2, -1))
        return y

    def _B_ref(x, wqkv, wo):
        B, S, D = x.shape
        H = 16; Dh = D // H
        qkv = (lambda x, *d: x.permute(*d))((x @ wqkv).reshape(B, S, 3, H, Dh), 2, 0, 3, 1, 4)
        q, k, v = qkv[0], qkv[1], qkv[2]
        scale = Dh ** -0.5
        scores = torch.einsum("bhqd,bhkd->bhqk", q, k) * scale
        p = _softmax(scores, axis=-1)
        o = torch.einsum("bhqk,bhkd->bhqd", p, v)
        return (lambda x, *d: x.permute(*d))(o, 0, 2, 1, 3).reshape(B, S, D) @ wo

    x = A_x
    g = _sigmoid((x * gate_w).sum(-1, keepdims=True))
    a = _A_ref(x, A_w_r, A_w_i)
    b = _B_ref(x, B_wqkv, B_wo)
    return g * a + (1 - g) * b
```

```asm
; @launch grid=(256,1,1) block=(384,1,1) lds=163840
.amdgcn_target "amdgcn-amd-amdhsa--gfx950"
.set TAB_INV_BYTES,401408
.text
.globl gated_mix__spectral_gfnet__softmax_full_mha__prompt_kernel
.p2align 8
.type gated_mix__spectral_gfnet__softmax_full_mha__prompt_kernel,@function
gated_mix__spectral_gfnet__softmax_full_mha__prompt_kernel:
    s_cmp_ge_u32 s2, 256
    s_cbranch_scc1 k2_end
    s_load_dwordx2 s[8:9], s[0:1], 0
    s_load_dwordx2 s[12:13], s[0:1], 32
    s_load_dwordx2 s[16:17], s[0:1], 72
    s_load_dwordx2 s[20:21], s[0:1], 8
    s_load_dwordx2 s[24:25], s[0:1], 16
    s_load_dwordx2 s[60:61], s[0:1], 48
    s_load_dwordx2 s[4:5], s[0:1], 64
    s_getpc_b64 s[28:29]
k1_pc:
    v_and_b32 v64, 63, v0
    v_lshrrev_b32 v172, 6, v0
    v_mul_u32_u24 v173, 24, v172
    v_add_lshl_u32 v173, v173, v64, 7
    s_mov_b64 exec, 0xffffff
    global_load_dword v224, v173, s[28:29]
    s_mov_b64 exec, -1
    v_readfirstlane_b32 s47, v172
    s_lshr_b32 s46, s2, 3
    s_and_b32 s38, s46, 3
    s_lshr_b32 s39, s46, 2
    s_bfe_u32 s31, s2, 0x20001
    s_lshl_b32 s31, s31, 2
    s_add_u32 s31, s31, s38
    s_and_b32 s32, s2, 1
    s_lshl_b32 s32, s32, 3
    s_add_u32 s32, s32, s39
    s_and_b32 s58, s39, 1
    s_lshr_b32 s39, s39, 1
    s_add_u32 s33, s38, s39
    s_lshl_b32 s33, s33, 1
    s_cmp_ge_u32 s33, 7
    s_cselect_b32 s38, 7, 0
    s_sub_u32 s33, s33, s38
    s_and_b32 s30, s47, 3
    s_lshl_b32 s40, s31, 1
    s_add_u32 s40, s40, s58
    s_lshl_b32 s40, s40, 1
    s_and_b32 s38, s30, 1
    s_add_u32 s40, s40, s38
    s_xor_b32 s59, s40, 2
    s_movk_i32 s36, 1024
    s_cmp_ge_u32 s32, 12
    s_cselect_b32 s36, s36, 2688
    s_cselect_b32 s41, 64, 56
    s_lshl_b32 s42, s38, 12
    s_add_u32 s42, s42, 114688
    s_cmp_lt_u32 s47, 4
    s_cbranch_scc1 k1_comp
    s_mul_i32 s34, s40, 896
    s_lshl_b32 s38, s33, 7
    s_add_u32 s34, s34, s38
    v_lshrrev_b32 v172, 3, v64
    v_mul_u32_u24 v65, 57344, v172
    v_lshrrev_b32 v173, 4, v64
    v_and_b32 v175, 7, v64
    v_xor_b32 v175, v175, v173
    v_lshl_add_u32 v65, v175, 4, v65
    v_xor_b32 v66, 64, v65
    s_mov_b32 s10, 1835008
    s_mov_b32 s11, 0x20000
    s_mul_i32 s38, s32, 224
    s_lshl_b32 s39, s32, 8
    s_sub_u32 s39, s39, 3072
    s_cmp_ge_u32 s32, 12
    s_cselect_b32 s35, s39, s38
    s_lshl_b32 s37, s36, 2
    s_sub_u32 s37, s37, 1024
    s_lshl_b32 s38, s33, 1
    s_add_u32 s38, s38, s30
    s_lshl_b32 s38, s38, 5
    s_mul_i32 s38, s38, s36
    s_add_u32 s35, s35, s38
    s_lshl_b32 s43, s30, 13
    v_mul_u32_u24 v67, s36, v173
    v_bfe_u32 v175, v64, 2, 2
    v_xor_b32 v175, v175, v173
    v_lshlrev_b32 v175, 2, v175
    v_and_or_b32 v175, v64, 3, v175
    v_lshl_add_u32 v67, v175, 4, v67
    s_getpc_b64 s[56:57]
    s_add_u32 s56, s56, tab_fwd@rel32@lo+4
    s_addc_u32 s57, s57, tab_fwd@rel32@hi+12
    s_mov_b32 s14, 458752
    s_mov_b32 s15, 0x20000
    s_cmp_ge_u32 s32, 12
    s_cselect_b32 s38, 16, 14
    s_cmp_eq_u32 s32, 15
    s_cselect_b32 s38, 12, s38
    v_cmp_gt_u32 s[54:55], s38, v175
    s_mov_b32 s53, s33
    s_lshl_b32 s44, s36, 6
    s_mul_i32 s45, s44, 7
    s_waitcnt lgkmcnt(0)
    s_cmp_ge_u32 s32, 12
    s_cselect_b32 s12, s56, s12
    s_cselect_b32 s13, s57, s13
    s_cselect_b32 s14, s14, 1204224
    s_add_u32 m0, s42, 0
    s_add_u32 s38, s34, 0
    buffer_load_dwordx4 v65, s[8:11], s38 offen offset:0 lds
    s_add_u32 s38, s34, 457728
    buffer_load_dwordx4 v66, s[8:11], s38 offen offset:1024 lds
    s_add_u32 s38, s34, 915456
    buffer_load_dwordx4 v65, s[8:11], s38 offen offset:2048 lds
    s_add_u32 s38, s34, 1373184
    buffer_load_dwordx4 v66, s[8:11], s38 offen offset:3072 lds
    s_mov_b64 exec, s[54:55]
    s_add_u32 m0, s43, 0
    s_mov_b32 s38, s35
    buffer_load_dwordx4 v67, s[12:15], s38 offen offset:0 lds
    s_add_u32 s38, s38, s37
    buffer_load_dwordx4 v67, s[12:15], s38 offen offset:1024 lds
    s_add_u32 s38, s38, s37
    buffer_load_dwordx4 v67, s[12:15], s38 offen offset:2048 lds
    s_add_u32 s38, s38, s37
    buffer_load_dwordx4 v67, s[12:15], s38 offen offset:3072 lds
    s_add_u32 m0, s43, 4096
    s_add_u32 s38, s38, s37
    s_add_u32 s38, s38, 4096
    buffer_load_dwordx4 v67, s[12:15], s38 offen offset:0 lds
    s_add_u32 s38, s38, s37
    buffer_load_dwordx4 v67, s[12:15], s38 offen offset:1024 lds
    s_add_u32 s38, s38, s37
    buffer_load_dwordx4 v67, s[12:15], s38 offen offset:2048 lds
    s_add_u32 s38, s38, s37
    buffer_load_dwordx4 v67, s[12:15], s38 offen offset:3072 lds
    s_mov_b64 exec, -1
    s_add_u32 s34, s34, 128
    s_add_u32 s35, s35, s44
    s_add_u32 s33, s33, 1
    s_cmp_eq_u32 s33, 7
    s_cselect_b32 s38, 896, 0
    s_cselect_b32 s39, s45, 0
    s_cselect_b32 s33, 0, s33
    s_sub_u32 s34, s34, s38
    s_sub_u32 s35, s35, s39
    s_mov_b32 s62, 896
    s_mov_b32 s63, 0x20000
    s_cmp_lg_u32 s32, 15
    s_cbranch_scc1 k1_nog
    v_and_b32 v176, 31, v64
    v_lshlrev_b32 v177, 1, v176
    s_lshl_b32 s38, s30, 6
    s_lshl_b32 s39, s53, 7
    s_add_u32 s38, s38, s39
    buffer_load_ushort v112, v177, s[60:63], s38 offen
    s_add_u32 s38, s38, 128
    s_cmp_ge_u32 s38, 896
    s_cselect_b32 s39, 896, 0
    s_sub_u32 s38, s38, s39
    buffer_load_ushort v113, v177, s[60:63], s38 offen
    s_add_u32 s38, s38, 128
    s_cmp_ge_u32 s38, 896
    s_cselect_b32 s39, 896, 0
    s_sub_u32 s38, s38, s39
    buffer_load_ushort v114, v177, s[60:63], s38 offen
    s_add_u32 s38, s38, 128
    s_cmp_ge_u32 s38, 896
    s_cselect_b32 s39, 896, 0
    s_sub_u32 s38, s38, s39
    buffer_load_ushort v115, v177, s[60:63], s38 offen
    s_add_u32 s38, s38, 128
    s_cmp_ge_u32 s38, 896
    s_cselect_b32 s39, 896, 0
    s_sub_u32 s38, s38, s39
    buffer_load_ushort v116, v177, s[60:63], s38 offen
    s_add_u32 s38, s38, 128
    s_cmp_ge_u32 s38, 896
    s_cselect_b32 s39, 896, 0
    s_sub_u32 s38, s38, s39
    buffer_load_ushort v117, v177, s[60:63], s38 offen
    s_add_u32 s38, s38, 128
    s_cmp_ge_u32 s38, 896
    s_cselect_b32 s39, 896, 0
    s_sub_u32 s38, s38, s39
    buffer_load_ushort v118, v177, s[60:63], s38 offen
    v_and_b32 v177, 3, v64
    v_xor_b32 v177, 3, v177
    v_lshlrev_b32 v177, 6, v177
    v_lshl_add_u32 v120, v176, 8, v177
    v_add_u32 v120, s43, v120
    v_add_u32 v121, 0x10000, v120
k1_nog:
    s_add_u32 m0, s42, 8192
    s_add_u32 s38, s34, 0
    buffer_load_dwordx4 v65, s[8:11], s38 offen offset:0 lds
    s_add_u32 s38, s34, 457728
    buffer_load_dwordx4 v66, s[8:11], s38 offen offset:1024 lds
    s_add_u32 s38, s34, 915456
    buffer_load_dwordx4 v65, s[8:11], s38 offen offset:2048 lds
    s_add_u32 s38, s34, 1373184
    buffer_load_dwordx4 v66, s[8:11], s38 offen offset:3072 lds
    s_mov_b64 exec, s[54:55]
    s_add_u32 m0, s43, 16384
    s_mov_b32 s38, s35
    buffer_load_dwordx4 v67, s[12:15], s38 offen offset:0 lds
    s_add_u32 s38, s38, s37
    buffer_load_dwordx4 v67, s[12:15], s38 offen offset:1024 lds
    s_add_u32 s38, s38, s37
    buffer_load_dwordx4 v67, s[12:15], s38 offen offset:2048 lds
    s_add_u32 s38, s38, s37
    buffer_load_dwordx4 v67, s[12:15], s38 offen offset:3072 lds
    s_add_u32 m0, s43, 20480
    s_add_u32 s38, s38, s37
    s_add_u32 s38, s38, 4096
    buffer_load_dwordx4 v67, s[12:15], s38 offen offset:0 lds
    s_add_u32 s38, s38, s37
    buffer_load_dwordx4 v67, s[12:15], s38 offen offset:1024 lds
    s_add_u32 s38, s38, s37
    buffer_load_dwordx4 v67, s[12:15], s38 offen offset:2048 lds
    s_add_u32 s38, s38, s37
    buffer_load_dwordx4 v67, s[12:15], s38 offen offset:3072 lds
    s_mov_b64 exec, -1
    s_add_u32 s34, s34, 128
    s_add_u32 s35, s35, s44
    s_add_u32 s33, s33, 1
    s_cmp_eq_u32 s33, 7
    s_cselect_b32 s38, 896, 0
    s_cselect_b32 s39, s45, 0
    s_cselect_b32 s33, 0, s33
    s_sub_u32 s34, s34, s38
    s_sub_u32 s35, s35, s39
    s_mov_b32 s18, 16777216
    s_mov_b32 s19, 0x20000
    s_mov_b32 s22, 921600
    s_mov_b32 s23, 0x20000
    s_mov_b32 s26, 921600
    s_mov_b32 s27, 0x20000
    s_lshr_b32 s38, s2, 4
    s_bfe_u32 s39, s2, 0x20002
    s_lshl_b32 s39, s39, 1
    s_and_b32 s48, s30, 1
    s_add_u32 s39, s39, s48
    s_lshl_b32 s52, s38, 3
    s_add_u32 s52, s52, s39
    s_mul_i32 s52, s52, 16512
    s_lshl_b32 s48, s38, 5
    s_add_u32 s48, s48, s39
    s_mul_i32 s48, s48, 1800
    s_and_b32 s38, s2, 3
    s_lshl_b32 s41, s38, 1
    s_lshl_b32 s39, s41, 6
    s_add_u32 s48, s48, s39
    s_lshl_b32 s39, s41, 11
    s_add_u32 s52, s52, s39
    s_add_u32 s52, s52, 8650752
    v_bfe_u32 v172, v64, 3, 2
    v_lshlrev_b32 v172, 5, v172
    v_lshrrev_b32 v188, 5, v64
    v_add_u32 v172, v172, v188
    v_mul_u32_u24 v172, 450, v172
    v_and_b32 v188, 7, v64
    v_lshl_add_u32 v188, v188, 4, v172
    v_lshlrev_b32 v189, 4, v64
    v_and_b32 v178, 3, v64
    v_lshlrev_b32 v178, 6, v178
    v_and_or_b32 v178, v64, 60, v178
    s_and_b32 s38, s32, 3
    s_lshl_b32 s38, s38, 8
    s_lshl_b32 s39, s31, 1
    s_add_u32 s39, s39, s30
    s_cmp_ge_u32 s32, 4
    s_cselect_b32 s39, s39, s40
    s_add_u32 s38, s38, s39
    s_lshl_b32 s38, s38, 11
    s_lshr_b32 s39, s32, 2
    s_lshl_b32 s39, s39, 21
    s_add_u32 s59, s38, s39
    s_lshl_b32 s38, s32, 13
    s_mul_i32 s39, s40, 32896
    s_add_u32 s38, s38, s39
    s_add_u32 s38, s38, 6193152
    s_movk_i32 s53, 2048
    s_cmp_ge_u32 s32, 12
    s_cselect_b32 s59, s38, s59
    s_cselect_b32 s53, s53, 131072
    s_lshl_b32 s38, s30, 12
    v_add_u32 v179, s38, v189
    s_waitcnt vmcnt(12)
    s_cmp_lg_u32 s32, 15
    s_cbranch_scc1 k1_ng
    ds_write_b16 v120, v112 offset:0
    ds_write_b16 v120, v113 offset:16384
    ds_write_b16 v120, v114 offset:32768
    ds_write_b16 v120, v115 offset:49152
    ds_write_b16 v121, v116 offset:0
    ds_write_b16 v121, v117 offset:16384
    ds_write_b16 v121, v118 offset:32768
    s_waitcnt lgkmcnt(0)
k1_ng:
    s_barrier
    s_add_u32 m0, s42, 16384
    s_add_u32 s38, s34, 0
    buffer_load_dwordx4 v65, s[8:11], s38 offen offset:0 lds
    s_add_u32 s38, s34, 457728
    buffer_load_dwordx4 v66, s[8:11], s38 offen offset:1024 lds
    s_add_u32 s38, s34, 915456
    buffer_load_dwordx4 v65, s[8:11], s38 offen offset:2048 lds
    s_add_u32 s38, s34, 1373184
    buffer_load_dwordx4 v66, s[8:11], s38 offen offset:3072 lds
    s_mov_b64 exec, s[54:55]
    s_add_u32 m0, s43, 32768
    s_mov_b32 s38, s35
    buffer_load_dwordx4 v67, s[12:15], s38 offen offset:0 lds
    s_add_u32 s38, s38, s37
    buffer_load_dwordx4 v67, s[12:15], s38 offen offset:1024 lds
    s_add_u32 s38, s38, s37
    buffer_load_dwordx4 v67, s[12:15], s38 offen offset:2048 lds
    s_add_u32 s38, s38, s37
    buffer_load_dwordx4 v67, s[12:15], s38 offen offset:3072 lds
    s_add_u32 m0, s43, 36864
    s_add_u32 s38, s38, s37
    s_add_u32 s38, s38, 4096
    buffer_load_dwordx4 v67, s[12:15], s38 offen offset:0 lds
    s_add_u32 s38, s38, s37
    buffer_load_dwordx4 v67, s[12:15], s38 offen offset:1024 lds
    s_add_u32 s38, s38, s37
    buffer_load_dwordx4 v67, s[12:15], s38 offen offset:2048 lds
    s_add_u32 s38, s38, s37
    buffer_load_dwordx4 v67, s[12:15], s38 offen offset:3072 lds
    s_mov_b64 exec, -1
    s_add_u32 s34, s34, 128
    s_add_u32 s35, s35, s44
    s_add_u32 s33, s33, 1
    s_cmp_eq_u32 s33, 7
    s_cselect_b32 s38, 896, 0
    s_cselect_b32 s39, s45, 0
    s_cselect_b32 s33, 0, s33
    s_sub_u32 s34, s34, s38
    s_sub_u32 s35, s35, s39
    s_waitcnt vmcnt(12)
    s_barrier
    s_add_u32 m0, s42, 24576
    s_add_u32 s38, s34, 0
    buffer_load_dwordx4 v65, s[8:11], s38 offen offset:0 lds
    s_add_u32 s38, s34, 457728
    buffer_load_dwordx4 v66, s[8:11], s38 offen offset:1024 lds
    s_add_u32 s38, s34, 915456
    buffer_load_dwordx4 v65, s[8:11], s38 offen offset:2048 lds
    s_add_u32 s38, s34, 1373184
    buffer_load_dwordx4 v66, s[8:11], s38 offen offset:3072 lds
    s_mov_b64 exec, s[54:55]
    s_add_u32 m0, s43, 49152
    s_mov_b32 s38, s35
    buffer_load_dwordx4 v67, s[12:15], s38 offen offset:0 lds
    s_add_u32 s38, s38, s37
    buffer_load_dwordx4 v67, s[12:15], s38 offen offset:1024 lds
    s_add_u32 s38, s38, s37
    buffer_load_dwordx4 v67, s[12:15], s38 offen offset:2048 lds
    s_add_u32 s38, s38, s37
    buffer_load_dwordx4 v67, s[12:15], s38 offen offset:3072 lds
    s_add_u32 m0, s43, 53248
    s_add_u32 s38, s38, s37
    s_add_u32 s38, s38, 4096
    buffer_load_dwordx4 v67, s[12:15], s38 offen offset:0 lds
    s_add_u32 s38, s38, s37
    buffer_load_dwordx4 v67, s[12:15], s38 offen offset:1024 lds
    s_add_u32 s38, s38, s37
    buffer_load_dwordx4 v67, s[12:15], s38 offen offset:2048 lds
    s_add_u32 s38, s38, s37
    buffer_load_dwordx4 v67, s[12:15], s38 offen offset:3072 lds
    s_mov_b64 exec, -1
    s_add_u32 s34, s34, 128
    s_add_u32 s35, s35, s44
    s_add_u32 s33, s33, 1
    s_cmp_eq_u32 s33, 7
    s_cselect_b32 s38, 896, 0
    s_cselect_b32 s39, s45, 0
    s_cselect_b32 s33, 0, s33
    s_sub_u32 s34, s34, s38
    s_sub_u32 s35, s35, s39
    s_waitcnt vmcnt(12)
    s_barrier
    s_add_u32 m0, s42, 32768
    s_add_u32 s38, s34, 0
    buffer_load_dwordx4 v65, s[8:11], s38 offen offset:0 lds
    s_add_u32 s38, s34, 457728
    buffer_load_dwordx4 v66, s[8:11], s38 offen offset:1024 lds
    s_add_u32 s38, s34, 915456
    buffer_load_dwordx4 v65, s[8:11], s38 offen offset:2048 lds
    s_add_u32 s38, s34, 1373184
    buffer_load_dwordx4 v66, s[8:11], s38 offen offset:3072 lds
    s_mov_b64 exec, s[54:55]
    s_add_u32 m0, s43, 65536
    s_mov_b32 s38, s35
    buffer_load_dwordx4 v67, s[12:15], s38 offen offset:0 lds
    s_add_u32 s38, s38, s37
    buffer_load_dwordx4 v67, s[12:15], s38 offen offset:1024 lds
    s_add_u32 s38, s38, s37
    buffer_load_dwordx4 v67, s[12:15], s38 offen offset:2048 lds
    s_add_u32 s38, s38, s37
    buffer_load_dwordx4 v67, s[12:15], s38 offen offset:3072 lds
    s_add_u32 m0, s43, 69632
    s_add_u32 s38, s38, s37
    s_add_u32 s38, s38, 4096
    buffer_load_dwordx4 v67, s[12:15], s38 offen offset:0 lds
    s_add_u32 s38, s38, s37
    buffer_load_dwordx4 v67, s[12:15], s38 offen offset:1024 lds
    s_add_u32 s38, s38, s37
    buffer_load_dwordx4 v67, s[12:15], s38 offen offset:2048 lds
    s_add_u32 s38, s38, s37
    buffer_load_dwordx4 v67, s[12:15], s38 offen offset:3072 lds
    s_mov_b64 exec, -1
    s_add_u32 s34, s34, 128
    s_add_u32 s35, s35, s44
    s_add_u32 s33, s33, 1
    s_cmp_eq_u32 s33, 7
    s_cselect_b32 s38, 896, 0
    s_cselect_b32 s39, s45, 0
    s_cselect_b32 s33, 0, s33
    s_sub_u32 s34, s34, s38
    s_sub_u32 s35, s35, s39
    s_waitcnt vmcnt(12)
    s_barrier
    s_add_u32 m0, s42, 40960
    s_add_u32 s38, s34, 0
    buffer_load_dwordx4 v65, s[8:11], s38 offen offset:0 lds
    s_add_u32 s38, s34, 457728
    buffer_load_dwordx4 v66, s[8:11], s38 offen offset:1024 lds
    s_add_u32 s38, s34, 915456
    buffer_load_dwordx4 v65, s[8:11], s38 offen offset:2048 lds
    s_add_u32 s38, s34, 1373184
    buffer_load_dwordx4 v66, s[8:11], s38 offen offset:3072 lds
    s_mov_b64 exec, s[54:55]
    s_add_u32 m0, s43, 81920
    s_mov_b32 s38, s35
    buffer_load_dwordx4 v67, s[12:15], s38 offen offset:0 lds
    s_add_u32 s38, s38, s37
    buffer_load_dwordx4 v67, s[12:15], s38 offen offset:1024 lds
    s_add_u32 s38, s38, s37
    buffer_load_dwordx4 v67, s[12:15], s38 offen offset:2048 lds
    s_add_u32 s38, s38, s37
    buffer_load_dwordx4 v67, s[12:15], s38 offen offset:3072 lds
    s_add_u32 m0, s43, 86016
    s_add_u32 s38, s38, s37
    s_add_u32 s38, s38, 4096
    buffer_load_dwordx4 v67, s[12:15], s38 offen offset:0 lds
    s_add_u32 s38, s38, s37
    buffer_load_dwordx4 v67, s[12:15], s38 offen offset:1024 lds
    s_add_u32 s38, s38, s37
    buffer_load_dwordx4 v67, s[12:15], s38 offen offset:2048 lds
    s_add_u32 s38, s38, s37
    buffer_load_dwordx4 v67, s[12:15], s38 offen offset:3072 lds
    s_mov_b64 exec, -1
    s_add_u32 s34, s34, 128
    s_add_u32 s35, s35, s44
    s_add_u32 s33, s33, 1
    s_cmp_eq_u32 s33, 7
    s_cselect_b32 s38, 896, 0
    s_cselect_b32 s39, s45, 0
    s_cselect_b32 s33, 0, s33
    s_sub_u32 s34, s34, s38
    s_sub_u32 s35, s35, s39
    s_waitcnt vmcnt(12)
    s_barrier
    s_add_u32 m0, s42, 0
    s_add_u32 s38, s34, 0
    buffer_load_dwordx4 v65, s[8:11], s38 offen offset:0 lds
    s_add_u32 s38, s34, 457728
    buffer_load_dwordx4 v66, s[8:11], s38 offen offset:1024 lds
    s_add_u32 s38, s34, 915456
    buffer_load_dwordx4 v65, s[8:11], s38 offen offset:2048 lds
    s_add_u32 s38, s34, 1373184
    buffer_load_dwordx4 v66, s[8:11], s38 offen offset:3072 lds
    s_mov_b64 exec, s[54:55]
    s_add_u32 m0, s43, 98304
    s_mov_b32 s38, s35
    buffer_load_dwordx4 v67, s[12:15], s38 offen offset:0 lds
    s_add_u32 s38, s38, s37
    buffer_load_dwordx4 v67, s[12:15], s38 offen offset:1024 lds
    s_add_u32 s38, s38, s37
    buffer_load_dwordx4 v67, s[12:15], s38 offen offset:2048 lds
    s_add_u32 s38, s38, s37
    buffer_load_dwordx4 v67, s[12:15], s38 offen offset:3072 lds
    s_add_u32 m0, s43, 102400
    s_add_u32 s38, s38, s37
    s_add_u32 s38, s38, 4096
    buffer_load_dwordx4 v67, s[12:15], s38 offen offset:0 lds
    s_add_u32 s38, s38, s37
    buffer_load_dwordx4 v67, s[12:15], s38 offen offset:1024 lds
    s_add_u32 s38, s38, s37
    buffer_load_dwordx4 v67, s[12:15], s38 offen offset:2048 lds
    s_add_u32 s38, s38, s37
    buffer_load_dwordx4 v67, s[12:15], s38 offen offset:3072 lds
    s_mov_b64 exec, -1
    s_add_u32 s34, s34, 128
    s_add_u32 s33, s33, 1
    s_cmp_eq_u32 s33, 7
    s_cselect_b32 s38, 896, 0
    s_cselect_b32 s33, 0, s33
    s_sub_u32 s34, s34, s38
    s_mul_i32 s38, s58, -3584
    s_add_u32 s34, s34, s38
    s_add_u32 s34, s34, 1792
    s_add_u32 m0, s42, 8192
    s_add_u32 s38, s34, 0
    buffer_load_dwordx4 v65, s[8:11], s38 offen offset:0 lds
    s_add_u32 s38, s34, 457728
    buffer_load_dwordx4 v66, s[8:11], s38 offen offset:1024 lds
    s_add_u32 s38, s34, 915456
    buffer_load_dwordx4 v65, s[8:11], s38 offen offset:2048 lds
    s_add_u32 s38, s34, 1373184
    buffer_load_dwordx4 v66, s[8:11], s38 offen offset:3072 lds
    s_add_u32 s34, s34, 128
    s_add_u32 s33, s33, 1
    s_cmp_eq_u32 s33, 7
    s_cselect_b32 s38, 896, 0
    s_cselect_b32 s33, 0, s33
    s_sub_u32 s34, s34, s38
    s_add_u32 m0, s42, 16384
    s_add_u32 s38, s34, 0
    buffer_load_dwordx4 v65, s[8:11], s38 offen offset:0 lds
    s_add_u32 s38, s34, 457728
    buffer_load_dwordx4 v66, s[8:11], s38 offen offset:1024 lds
    s_add_u32 s38, s34, 915456
    buffer_load_dwordx4 v65, s[8:11], s38 offen offset:2048 lds
    s_add_u32 s38, s34, 1373184
    buffer_load_dwordx4 v66, s[8:11], s38 offen offset:3072 lds
    s_add_u32 s34, s34, 128
    s_add_u32 s33, s33, 1
    s_cmp_eq_u32 s33, 7
    s_cselect_b32 s38, 896, 0
    s_cselect_b32 s33, 0, s33
    s_sub_u32 s34, s34, s38
    s_waitcnt vmcnt(20)
    s_barrier
    s_add_u32 m0, s42, 24576
    s_add_u32 s38, s34, 0
    buffer_load_dwordx4 v65, s[8:11], s38 offen offset:0 lds
    s_add_u32 s38, s34, 457728
    buffer_load_dwordx4 v66, s[8:11], s38 offen offset:1024 lds
    s_add_u32 s38, s34, 915456
    buffer_load_dwordx4 v65, s[8:11], s38 offen offset:2048 lds
    s_add_u32 s38, s34, 1373184
    buffer_load_dwordx4 v66, s[8:11], s38 offen offset:3072 lds
    s_add_u32 s34, s34, 128
    s_add_u32 s33, s33, 1
    s_cmp_eq_u32 s33, 7
    s_cselect_b32 s38, 896, 0
    s_cselect_b32 s33, 0, s33
    s_sub_u32 s34, s34, s38
    buffer_load_dwordx4 v[76:79], v188, s[20:23], s48 offen offset:0
    buffer_load_dwordx4 v[80:83], v188, s[20:23], s48 offen offset:900
    buffer_load_dwordx4 v[84:87], v188, s[24:27], s48 offen offset:0
    buffer_load_dwordx4 v[88:91], v188, s[24:27], s48 offen offset:900
    s_lshl_b32 s38, s2, 1
    s_add_u32 s38, s38, s30
    s_cmp_lg_u32 s38, 511
    s_cbranch_scc1 k1_wl
    v_mov_b32 v110, 921598
    buffer_load_ushort v108, v110, s[20:23], 0 offen
    buffer_load_ushort v109, v110, s[24:27], 0 offen
k1_wl:
    s_load_dwordx2 s[60:61], s[0:1], 40
    s_getpc_b64 s[56:57]
    s_add_u32 s56, s56, tab_inv@rel32@lo+4
    s_addc_u32 s57, s57, tab_inv@rel32@hi+12
    s_mov_b32 s62, 401408
    s_mul_i32 s38, s2, 1664
    v_lshl_add_u32 v172, v64, 7, s38
    s_waitcnt lgkmcnt(0)
    s_bitcmp1_b32 s30, 0
    s_cselect_b32 s60, s56, s60
    s_cselect_b32 s61, s57, s61
    s_mov_b64 exec, 0x1fff
    buffer_load_dword v226, v172, s[60:63], 0 offen
    s_mov_b64 exec, -1
    s_cmp_lg_u32 s47, 4
    s_cbranch_scc1 k1_npf
    s_cmp_ge_u32 s46, 8
    s_cbranch_scc1 k1_npf
    s_getpc_b64 s[56:57]
    s_add_u32 s56, s56, tab_small@rel32@lo+4
    s_addc_u32 s57, s57, tab_small@rel32@hi+12
    s_getpc_b64 s[62:63]
    s_add_u32 s62, s62, k2_start@rel32@lo+1028
    s_addc_u32 s63, s63, k2_start@rel32@hi+1036
    s_cmp_ge_u32 s46, 6
    s_cselect_b32 s56, s62, s56
    s_cselect_b32 s57, s63, s57
    s_cselect_b32 s38, 6, 0
    s_sub_u32 s38, s46, s38
    s_lshl_b32 s38, s38, 13
    v_lshl_add_u32 v172, v64, 7, s38
    global_load_dword v227, v172, s[56:57]
k1_npf:
    s_waitcnt vmcnt(17)
    s_barrier
    s_add_u32 m0, s42, 32768
    s_add_u32 s38, s34, 0
    buffer_load_dwordx4 v65, s[8:11], s38 offen offset:0 lds
    s_add_u32 s38, s34, 457728
    buffer_load_dwordx4 v66, s[8:11], s38 offen offset:1024 lds
    s_add_u32 s38, s34, 915456
    buffer_load_dwordx4 v65, s[8:11], s38 offen offset:2048 lds
    s_add_u32 s38, s34, 1373184
    buffer_load_dwordx4 v66, s[8:11], s38 offen offset:3072 lds
    s_add_u32 s34, s34, 128
    s_add_u32 s33, s33, 1
    s_cmp_eq_u32 s33, 7
    s_cselect_b32 s38, 896, 0
    s_cselect_b32 s33, 0, s33
    s_sub_u32 s34, s34, s38
    s_waitcnt vmcnt(17)
    s_barrier
    s_add_u32 m0, s42, 40960
    s_add_u32 s38, s34, 0
    buffer_load_dwordx4 v65, s[8:11], s38 offen offset:0 lds
    s_add_u32 s38, s34, 457728
    buffer_load_dwordx4 v66, s[8:11], s38 offen offset:1024 lds
    s_add_u32 s38, s34, 915456
    buffer_load_dwordx4 v65, s[8:11], s38 offen offset:2048 lds
    s_add_u32 s38, s34, 1373184
    buffer_load_dwordx4 v66, s[8:11], s38 offen offset:3072 lds
    s_add_u32 s34, s34, 128
    s_add_u32 s33, s33, 1
    s_cmp_eq_u32 s33, 7
    s_cselect_b32 s38, 896, 0
    s_cselect_b32 s33, 0, s33
    s_sub_u32 s34, s34, s38
    s_waitcnt vmcnt(17)
    s_barrier
    s_add_u32 m0, s42, 0
    s_add_u32 s38, s34, 0
    buffer_load_dwordx4 v65, s[8:11], s38 offen offset:0 lds
    s_add_u32 s38, s34, 457728
    buffer_load_dwordx4 v66, s[8:11], s38 offen offset:1024 lds
    s_add_u32 s38, s34, 915456
    buffer_load_dwordx4 v65, s[8:11], s38 offen offset:2048 lds
    s_add_u32 s38, s34, 1373184
    buffer_load_dwordx4 v66, s[8:11], s38 offen offset:3072 lds
    s_add_u32 s34, s34, 128
    s_add_u32 s33, s33, 1
    s_cmp_eq_u32 s33, 7
    s_cselect_b32 s38, 896, 0
    s_cselect_b32 s33, 0, s33
    s_sub_u32 s34, s34, s38
    s_waitcnt vmcnt(17)
    s_barrier
    s_add_u32 m0, s42, 8192
    s_add_u32 s38, s34, 0
    buffer_load_dwordx4 v65, s[8:11], s38 offen offset:0 lds
    s_add_u32 s38, s34, 457728
    buffer_load_dwordx4 v66, s[8:11], s38 offen offset:1024 lds
    s_add_u32 s38, s34, 915456
    buffer_load_dwordx4 v65, s[8:11], s38 offen offset:2048 lds
    s_add_u32 s38, s34, 1373184
    buffer_load_dwordx4 v66, s[8:11], s38 offen offset:3072 lds
    s_waitcnt vmcnt(12)
    s_barrier
    s_load_dwordx2 s[28:29], s[4:5], 0
    s_waitcnt vmcnt(0)
    s_barrier
    ds_read_b128 v[192:195], v179 offset:0
    ds_read_b128 v[196:199], v179 offset:1024
    ds_read_b128 v[200:203], v179 offset:2048
    ds_read_b128 v[204:207], v179 offset:3072
    ds_read_b128 v[208:211], v179 offset:8192
    ds_read_b128 v[212:215], v179 offset:9216
    ds_read_b128 v[216:219], v179 offset:10240
    ds_read_b128 v[220:223], v179 offset:11264
    s_cmp_eq_u32 s32, 15
    s_cselect_b64 s[54:55], 0xff, -1
    s_cselect_b64 s[56:57], 0xff, -1
    s_waitcnt lgkmcnt(7)
    buffer_store_dwordx4 v[192:195], v189, s[16:19], s59 offen offset:0 sc1
    s_waitcnt lgkmcnt(6)
    buffer_store_dwordx4 v[196:199], v189, s[16:19], s59 offen offset:1024 sc1
    s_waitcnt lgkmcnt(5)
    s_add_u32 s59, s59, s53
    buffer_store_dwordx4 v[200:203], v189, s[16:19], s59 offen offset:0 sc1
    s_waitcnt lgkmcnt(4)
    buffer_store_dwordx4 v[204:207], v189, s[16:19], s59 offen offset:1024 sc1
    s_waitcnt lgkmcnt(3)
    s_mov_b64 exec, s[54:55]
    s_add_u32 s59, s59, s53
    buffer_store_dwordx4 v[208:211], v189, s[16:19], s59 offen offset:0 sc1
    s_waitcnt lgkmcnt(2)
    s_mov_b64 exec, s[56:57]
    buffer_store_dwordx4 v[212:215], v189, s[16:19], s59 offen offset:1024 sc1
    s_waitcnt lgkmcnt(1)
    s_mov_b64 exec, s[54:55]
    s_add_u32 s59, s59, s53
    buffer_store_dwordx4 v[216:219], v189, s[16:19], s59 offen offset:0 sc1
    s_waitcnt lgkmcnt(0)
    s_mov_b64 exec, s[56:57]
    buffer_store_dwordx4 v[220:223], v189, s[16:19], s59 offen offset:1024 sc1
    s_mov_b64 exec, -1
    s_lshl_b32 s38, s30, 12
    s_add_u32 s38, s38, 32768
    v_add_u32 v180, s38, v189
    v_lshrrev_b32 v181, 2, v64
    v_lshlrev_b32 v181, 7, v181
    v_and_b32 v182, 3, v64
    v_lshl_add_u32 v181, v182, 3, v181
    v_add_u32 v181, s38, v181
    ds_write_b128 v180, v[76:79] offset:0
    ds_write_b128 v180, v[80:83] offset:1024
    ds_write_b128 v180, v[84:87] offset:2048
    ds_write_b128 v180, v[88:91] offset:3072
    s_lshl_b32 s38, s2, 1
    s_add_u32 s38, s38, s30
    s_cmp_lg_u32 s38, 511
    s_cbranch_scc1 k1_wp
    v_mov_b32 v110, 38848
    ds_write_b16 v110, v108
    ds_write_b16 v110, v109 offset:2048
k1_wp:
    s_waitcnt lgkmcnt(0)
    ds_read_b64_tr_b16 v[76:77], v181 offset:0
    ds_read_b64_tr_b16 v[78:79], v181 offset:2048
    ds_read_b64_tr_b16 v[84:85], v181 offset:32
    ds_read_b64_tr_b16 v[86:87], v181 offset:2080
    ds_read_b64_tr_b16 v[92:93], v181 offset:64
    ds_read_b64_tr_b16 v[94:95], v181 offset:2112
    ds_read_b64_tr_b16 v[100:101], v181 offset:96
    ds_read_b64_tr_b16 v[102:103], v181 offset:2144
    s_waitcnt lgkmcnt(0)
    ds_bpermute_b32 v80, v178, v76
    ds_bpermute_b32 v81, v178, v77
    ds_bpermute_b32 v82, v178, v78
    ds_bpermute_b32 v83, v178, v79
    ds_bpermute_b32 v88, v178, v84
    ds_bpermute_b32 v89, v178, v85
    ds_bpermute_b32 v90, v178, v86
    ds_bpermute_b32 v91, v178, v87
    ds_bpermute_b32 v96, v178, v92
    ds_bpermute_b32 v97, v178, v93
    ds_bpermute_b32 v98, v178, v94
    ds_bpermute_b32 v99, v178, v95
    ds_bpermute_b32 v104, v178, v100
    ds_bpermute_b32 v105, v178, v101
    ds_bpermute_b32 v106, v178, v102
    ds_bpermute_b32 v107, v178, v103
    s_cmp_eq_u32 s41, 6
    s_cselect_b64 s[54:55], 0xff, -1
    s_cselect_b64 s[56:57], 1, -1
    s_waitcnt lgkmcnt(0)
    buffer_store_dwordx4 v[80:83], v189, s[16:19], s52 offen offset:0 sc1
    buffer_store_dwordx4 v[88:91], v189, s[16:19], s52 offen offset:1024 sc1
    s_mov_b64 exec, s[54:55]
    buffer_store_dwordx4 v[96:99], v189, s[16:19], s52 offen offset:2048 sc1
    s_mov_b64 exec, s[56:57]
    buffer_store_dwordx4 v[104:107], v189, s[16:19], s52 offen offset:3072 sc1
    s_mov_b64 exec, -1
    s_branch k1_pf
k1_comp:
    s_mov_b32 s18, 16777216
    s_mov_b32 s19, 0x20000
    s_or_b32 s38, s2, s30
    s_cmp_lg_u32 s38, 0
    s_cbranch_scc1 k1_ntag
    s_memrealtime s[62:63]
    s_mov_b32 s6, 256
    s_mov_b32 s7, 0x20000
    v_mov_b32 v172, 0
    s_waitcnt lgkmcnt(0)
    s_or_b32 s62, s62, 1
    v_mov_b32 v174, s62
    v_mov_b32 v175, s63
    s_mov_b64 exec, 1
    buffer_store_dwordx2 v[174:175], v172, s[4:7], 0 offen sc1
    s_mov_b64 exec, -1
k1_ntag:
    v_lshlrev_b32 v189, 4, v64
    v_and_b32 v172, 31, v64
    v_lshrrev_b32 v173, 5, v64
    v_bfe_u32 v174, v64, 1, 3
    v_xor_b32 v174, v174, v173
    v_lshlrev_b32 v174, 4, v174
    v_lshl_add_u32 v174, v172, 7, v174
    v_add_u32 v68, s42, v174
    v_xor_b32 v69, 32, v68
    v_xor_b32 v70, 64, v68
    v_xor_b32 v71, 96, v68
    v_bfe_u32 v174, v64, 2, 2
    v_lshl_add_u32 v175, v173, 3, v174
    v_lshlrev_b32 v175, 8, v175
    v_bfe_u32 v176, v64, 4, 1
    v_lshlrev_b32 v176, 5, v176
    v_and_b32 v177, 3, v64
    v_lshl_add_u32 v176, v177, 3, v176
    s_and_b32 s38, s30, 2
    s_mul_i32 s38, s38, s41
    v_add_u32 v176, s38, v176
    v_lshlrev_b32 v174, 6, v174
    v_xor_b32 v177, v176, v174
    v_add_u32 v72, v177, v175
    v_add_u32 v74, 0x10000, v72
    v_add_u32 v176, s41, v176
    v_xor_b32 v177, v176, v174
    v_add_u32 v73, v177, v175
    v_add_u32 v75, 0x10000, v73
    s_cmp_lt_u32 s32, 12
    s_cbranch_scc1 k1_nom
    v_cvt_f32_u32 v175, v172
    v_mul_f32 v175, 0x3d000000, v175
    v_lshl_add_u32 v174, v173, 8, s40
    v_mul_u32_u24 v174, v174, v172
    v_cvt_f32_u32 v174, v174
    v_mul_f32 v174, 0x3a000000, v174
    v_fmamk_f32 v176, v175, 0x0, v174
    v_fract_f32 v176, v176
    v_fmamk_f32 v177, v175, 0x3f800000, v174
    v_fract_f32 v177, v177
    v_cos_f32 v178, v176
    v_cos_f32 v179, v177
    v_sin_f32 v180, v176
    v_sin_f32 v181, v177
    v_cvt_pk_bf16_f32 v124, v178, v179
    v_cvt_pk_bf16_f32 v132, v180, v181
    v_cvt_pk_bf16_f32 v140, -v180, -v181
    v_fmamk_f32 v176, v175, 0x40000000, v174
    v_fract_f32 v176, v176
    v_fmamk_f32 v177, v175, 0x40400000, v174
    v_fract_f32 v177, v177
    v_cos_f32 v178, v176
    v_cos_f32 v179, v177
    v_sin_f32 v180, v176
    v_sin_f32 v181, v177
    v_cvt_pk_bf16_f32 v125, v178, v179
    v_cvt_pk_bf16_f32 v133, v180, v181
    v_cvt_pk_bf16_f32 v141, -v180, -v181
    v_fmamk_f32 v176, v175, 0x41000000, v174
    v_fract_f32 v176, v176
    v_fmamk_f32 v177, v175, 0x41100000, v174
    v_fract_f32 v177, v177
    v_cos_f32 v178, v176
    v_cos_f32 v179, v177
    v_sin_f32 v180, v176
    v_sin_f32 v181, v177
    v_cvt_pk_bf16_f32 v126, v178, v179
    v_cvt_pk_bf16_f32 v134, v180, v181
    v_cvt_pk_bf16_f32 v142, -v180, -v181
    v_fmamk_f32 v176, v175, 0x41200000, v174
    v_fract_f32 v176, v176
    v_fmamk_f32 v177, v175, 0x41300000, v174
    v_fract_f32 v177, v177
    v_cos_f32 v178, v176
    v_cos_f32 v179, v177
    v_sin_f32 v180, v176
    v_sin_f32 v181, v177
    v_cvt_pk_bf16_f32 v127, v178, v179
    v_cvt_pk_bf16_f32 v135, v180, v181
    v_cvt_pk_bf16_f32 v143, -v180, -v181
    v_fmamk_f32 v176, v175, 0x41800000, v174
    v_fract_f32 v176, v176
    v_fmamk_f32 v177, v175, 0x41880000, v174
    v_fract_f32 v177, v177
    v_cos_f32 v178, v176
    v_cos_f32 v179, v177
    v_sin_f32 v180, v176
    v_sin_f32 v181, v177
    v_cvt_pk_bf16_f32 v128, v178, v179
    v_cvt_pk_bf16_f32 v136, v180, v181
    v_cvt_pk_bf16_f32 v144, -v180, -v181
    v_fmamk_f32 v176, v175, 0x41900000, v174
    v_fract_f32 v176, v176
    v_fmamk_f32 v177, v175, 0x41980000, v174
    v_fract_f32 v177, v177
    v_cos_f32 v178, v176
    v_cos_f32 v179, v177
    v_sin_f32 v180, v176
    v_sin_f32 v181, v177
    v_cvt_pk_bf16_f32 v129, v178, v179
    v_cvt_pk_bf16_f32 v137, v180, v181
    v_cvt_pk_bf16_f32 v145, -v180, -v181
    v_fmamk_f32 v176, v175, 0x41c00000, v174
    v_fract_f32 v176, v176
    v_fmamk_f32 v177, v175, 0x41c80000, v174
    v_fract_f32 v177, v177
    v_cos_f32 v178, v176
    v_cos_f32 v179, v177
    v_sin_f32 v180, v176
    v_sin_f32 v181, v177
    v_cvt_pk_bf16_f32 v130, v178, v179
    v_cvt_pk_bf16_f32 v138, v180, v181
    v_cvt_pk_bf16_f32 v146, -v180, -v181
    v_fmamk_f32 v176, v175, 0x41d00000, v174
    v_fract_f32 v176, v176
    v_fmamk_f32 v177, v175, 0x41d80000, v174
    v_fract_f32 v177, v177
    v_cos_f32 v178, v176
    v_cos_f32 v179, v177
    v_sin_f32 v180, v176
    v_sin_f32 v181, v177
    v_cvt_pk_bf16_f32 v131, v178, v179
    v_cvt_pk_bf16_f32 v139, v180, v181
    v_cvt_pk_bf16_f32 v147, -v180, -v181
    v_lshl_add_u32 v174, v173, 8, s59
    v_mul_u32_u24 v174, v174, v172
    v_cvt_f32_u32 v174, v174
    v_mul_f32 v174, 0x3a000000, v174
    v_fmamk_f32 v176, v175, 0x0, v174
    v_fract_f32 v176, v176
    v_fmamk_f32 v177, v175, 0x3f800000, v174
    v_fract_f32 v177, v177
    v_cos_f32 v178, v176
    v_cos_f32 v179, v177
    v_sin_f32 v180, v176
    v_sin_f32 v181, v177
    v_cvt_pk_bf16_f32 v148, v178, v179
    v_cvt_pk_bf16_f32 v156, v180, v181
    v_cvt_pk_bf16_f32 v164, -v180, -v181
    v_fmamk_f32 v176, v175, 0x40000000, v174
    v_fract_f32 v176, v176
    v_fmamk_f32 v177, v175, 0x40400000, v174
    v_fract_f32 v177, v177
    v_cos_f32 v178, v176
    v_cos_f32 v179, v177
    v_sin_f32 v180, v176
    v_sin_f32 v181, v177
    v_cvt_pk_bf16_f32 v149, v178, v179
    v_cvt_pk_bf16_f32 v157, v180, v181
    v_cvt_pk_bf16_f32 v165, -v180, -v181
    v_fmamk_f32 v176, v175, 0x41000000, v174
    v_fract_f32 v176, v176
    v_fmamk_f32 v177, v175, 0x41100000, v174
    v_fract_f32 v177, v177
    v_cos_f32 v178, v176
    v_cos_f32 v179, v177
    v_sin_f32 v180, v176
    v_sin_f32 v181, v177
    v_cvt_pk_bf16_f32 v150, v178, v179
    v_cvt_pk_bf16_f32 v158, v180, v181
    v_cvt_pk_bf16_f32 v166, -v180, -v181
    v_fmamk_f32 v176, v175, 0x41200000, v174
    v_fract_f32 v176, v176
    v_fmamk_f32 v177, v175, 0x41300000, v174
    v_fract_f32 v177, v177
    v_cos_f32 v178, v176
    v_cos_f32 v179, v177
    v_sin_f32 v180, v176
    v_sin_f32 v181, v177
    v_cvt_pk_bf16_f32 v151, v178, v179
    v_cvt_pk_bf16_f32 v159, v180, v181
    v_cvt_pk_bf16_f32 v167, -v180, -v181
    v_fmamk_f32 v176, v175, 0x41800000, v174
    v_fract_f32 v176, v176
    v_fmamk_f32 v177, v175, 0x41880000, v174
    v_fract_f32 v177, v177
    v_cos_f32 v178, v176
    v_cos_f32 v179, v177
    v_sin_f32 v180, v176
    v_sin_f32 v181, v177
    v_cvt_pk_bf16_f32 v152, v178, v179
    v_cvt_pk_bf16_f32 v160, v180, v181
    v_cvt_pk_bf16_f32 v168, -v180, -v181
    v_fmamk_f32 v176, v175, 0x41900000, v174
    v_fract_f32 v176, v176
    v_fmamk_f32 v177, v175, 0x41980000, v174
    v_fract_f32 v177, v177
    v_cos_f32 v178, v176
    v_cos_f32 v179, v177
    v_sin_f32 v180, v176
    v_sin_f32 v181, v177
    v_cvt_pk_bf16_f32 v153, v178, v179
    v_cvt_pk_bf16_f32 v161, v180, v181
    v_cvt_pk_bf16_f32 v169, -v180, -v181
    v_fmamk_f32 v176, v175, 0x41c00000, v174
    v_fract_f32 v176, v176
    v_fmamk_f32 v177, v175, 0x41c80000, v174
    v_fract_f32 v177, v177
    v_cos_f32 v178, v176
    v_cos_f32 v179, v177
    v_sin_f32 v180, v176
    v_sin_f32 v181, v177
    v_cvt_pk_bf16_f32 v154, v178, v179
    v_cvt_pk_bf16_f32 v162, v180, v181
    v_cvt_pk_bf16_f32 v170, -v180, -v181
    v_fmamk_f32 v176, v175, 0x41d00000, v174
    v_fract_f32 v176, v176
    v_fmamk_f32 v177, v175, 0x41d80000, v174
    v_fract_f32 v177, v177
    v_cos_f32 v178, v176
    v_cos_f32 v179, v177
    v_sin_f32 v180, v176
    v_sin_f32 v181, v177
    v_cvt_pk_bf16_f32 v155, v178, v179
    v_cvt_pk_bf16_f32 v163, v180, v181
    v_cvt_pk_bf16_f32 v171, -v180, -v181
k1_nom:
    s_waitcnt lgkmcnt(0)
    s_cmp_ge_u32 s32, 8
    s_cbranch_scc1 k1_vd
    s_cmp_ge_u32 s32, 4
    s_cselect_b32 s37, 2097152, 0
    s_cselect_b32 s44, 0x3e8b97f6, 1.0
    s_cselect_b32 s42, 0x3f803f80, 0
    s_cselect_b32 s43, 0x3f80, 0
    s_cselect_b32 s33, 12, 0
    s_and_b32 s38, s32, 3
    s_lshl_b32 s38, s38, 2
    s_and_b32 s39, s30, 2
    s_add_u32 s38, s38, s39
    s_lshl_b32 s38, s38, 6
    s_lshl_b32 s39, s31, 1
    s_and_b32 s35, s30, 1
    s_add_u32 s39, s39, s35
    s_add_u32 s39, s39, 32
    s_cmp_ge_u32 s32, 4
    s_cselect_b32 s39, s39, s59
    s_add_u32 s35, s38, s39
    s_lshl_b32 s35, s35, 11
    s_add_u32 s35, s35, s37
    v_mov_b32 v178, s42
    v_mov_b32 v179, s43
    v_lshrrev_b32 v172, 1, v64
    v_xor_b32 v172, v172, v64
    v_and_b32 v172, 4, v172
    v_mul_u32_u24 v172, 3, v172
    v_and_b32 v172, s33, v172
    v_xor_b32 v172, v172, v64
    v_lshlrev_b32 v189, 4, v172
    v_cmp_lt_u32 vcc, 31, v64
    s_lshl_b32 s38, s30, 12
    v_add_u32 v180, s38, v189
    s_waitcnt lgkmcnt(0)
    s_barrier
    ds_read_b128 v[76:79], v68 offset:0
    ds_read_b64_tr_b16 v[80:81], v72 offset:0
    ds_read_b64_tr_b16 v[82:83], v72 offset:1024
    ds_read_b64_tr_b16 v[84:85], v73 offset:0
    ds_read_b64_tr_b16 v[86:87], v73 offset:1024
    ds_read_b128 v[88:91], v69 offset:0
    ds_read_b64_tr_b16 v[92:93], v72 offset:4096
    ds_read_b64_tr_b16 v[94:95], v72 offset:5120
    ds_read_b64_tr_b16 v[96:97], v73 offset:4096
    ds_read_b64_tr_b16 v[98:99], v73 offset:5120
    ds_read_b128 v[100:103], v70 offset:0
    ds_read_b64_tr_b16 v[104:105], v72 offset:8192
    ds_read_b64_tr_b16 v[106:107], v72 offset:9216
    ds_read_b64_tr_b16 v[108:109], v73 offset:8192
    ds_read_b64_tr_b16 v[110:111], v73 offset:9216
    s_waitcnt lgkmcnt(10)
    v_mfma_f32_32x32x16_bf16 v[0:15], v[80:83], v[76:79], 0
    ds_read_b128 v[112:115], v71 offset:0
    ds_read_b64_tr_b16 v[116:117], v72 offset:12288
    ds_read_b64_tr_b16 v[118:119], v72 offset:13312
    v_mfma_f32_32x32x16_bf16 v[16:31], v[84:87], v[76:79], 0
    ds_read_b64_tr_b16 v[120:121], v73 offset:12288
    ds_read_b64_tr_b16 v[122:123], v73 offset:13312
    s_waitcnt lgkmcnt(10)
    s_barrier
    v_mfma_f32_32x32x16_bf16 v[0:15], v[92:95], v[88:91], v[0:15]
    ds_read_b128 v[76:79], v68 offset:8192
    ds_read_b64_tr_b16 v[80:81], v72 offset:16384
    ds_read_b64_tr_b16 v[82:83], v72 offset:17408
    v_mfma_f32_32x32x16_bf16 v[16:31], v[96:99], v[88:91], v[16:31]
    ds_read_b64_tr_b16 v[84:85], v73 offset:16384
    ds_read_b64_tr_b16 v[86:87], v73 offset:17408
    s_waitcnt lgkmcnt(10)
    v_mfma_f32_32x32x16_bf16 v[0:15], v[104:107], v[100:103], v[0:15]
    ds_read_b128 v[88:91], v69 offset:8192
    ds_read_b64_tr_b16 v[92:93], v72 offset:20480
    ds_read_b64_tr_b16 v[94:95], v72 offset:21504
    v_mfma_f32_32x32x16_bf16 v[16:31], v[108:111], v[100:103], v[16:31]
    ds_read_b64_tr_b16 v[96:97], v73 offset:20480
    ds_read_b64_tr_b16 v[98:99], v73 offset:21504
    s_waitcnt lgkmcnt(10)
    v_mfma_f32_32x32x16_bf16 v[0:15], v[116:119], v[112:115], v[0:15]
    ds_read_b128 v[100:103], v70 offset:8192
    ds_read_b64_tr_b16 v[104:105], v72 offset:24576
    ds_read_b64_tr_b16 v[106:107], v72 offset:25600
    v_mfma_f32_32x32x16_bf16 v[16:31], v[120:123], v[112:115], v[16:31]
    ds_read_b64_tr_b16 v[108:109], v73 offset:24576
    ds_read_b64_tr_b16 v[110:111], v73 offset:25600
    s_waitcnt lgkmcnt(10)
    v_mfma_f32_32x32x16_bf16 v[0:15], v[80:83], v[76:79], v[0:15]
    ds_read_b128 v[112:115], v71 offset:8192
    ds_read_b64_tr_b16 v[116:117], v72 offset:28672
    ds_read_b64_tr_b16 v[118:119], v72 offset:29696
    v_mfma_f32_32x32x16_bf16 v[16:31], v[84:87], v[76:79], v[16:31]
    ds_read_b64_tr_b16 v[120:121], v73 offset:28672
    ds_read_b64_tr_b16 v[122:123], v73 offset:29696
    s_waitcnt lgkmcnt(10)
    s_barrier
    v_mfma_f32_32x32x16_bf16 v[0:15], v[92:95], v[88:91], v[0:15]
    ds_read_b128 v[76:79], v68 offset:16384
    ds_read_b64_tr_b16 v[80:81], v72 offset:32768
    ds_read_b64_tr_b16 v[82:83], v72 offset:33792
    v_mfma_f32_32x32x16_bf16 v[16:31], v[96:99], v[88:91], v[16:31]
    ds_read_b64_tr_b16 v[84:85], v73 offset:32768
    ds_read_b64_tr_b16 v[86:87], v73 offset:33792
    s_waitcnt lgkmcnt(10)
    v_mfma_f32_32x32x16_bf16 v[0:15], v[104:107], v[100:103], v[0:15]
    ds_read_b128 v[88:91], v69 offset:16384
    ds_read_b64_tr_b16 v[92:93], v72 offset:36864
    ds_read_b64_tr_b16 v[94:95], v72 offset:37888
    v_mfma_f32_32x32x16_bf16 v[16:31], v[108:111], v[100:103], v[16:31]
    ds_read_b64_tr_b16 v[96:97], v73 offset:36864
    ds_read_b64_tr_b16 v[98:99], v73 offset:37888
    s_waitcnt lgkmcnt(10)
    v_mfma_f32_32x32x16_bf16 v[0:15], v[116:119], v[112:115], v[0:15]
    ds_read_b128 v[100:103], v70 offset:16384
    ds_read_b64_tr_b16 v[104:105], v72 offset:40960
    ds_read_b64_tr_b16 v[106:107], v72 offset:41984
    v_mfma_f32_32x32x16_bf16 v[16:31], v[120:123], v[112:115], v[16:31]
    ds_read_b64_tr_b16 v[108:109], v73 offset:40960
    ds_read_b64_tr_b16 v[110:111], v73 offset:41984
    s_waitcnt lgkmcnt(10)
    v_mfma_f32_32x32x16_bf16 v[0:15], v[80:83], v[76:79], v[0:15]
    ds_read_b128 v[112:115], v71 offset:16384
    ds_read_b64_tr_b16 v[116:117], v72 offset:45056
    ds_read_b64_tr_b16 v[118:119], v72 offset:46080
    v_mfma_f32_32x32x16_bf16 v[16:31], v[84:87], v[76:79], v[16:31]
    ds_read_b64_tr_b16 v[120:121], v73 offset:45056
    ds_read_b64_tr_b16 v[122:123], v73 offset:46080
    s_waitcnt lgkmcnt(10)
    s_barrier
    v_mfma_f32_32x32x16_bf16 v[0:15], v[92:95], v[88:91], v[0:15]
    ds_read_b128 v[76:79], v68 offset:24576
    ds_read_b64_tr_b16 v[80:81], v72 offset:49152
    ds_read_b64_tr_b16 v[82:83], v72 offset:50176
    v_mfma_f32_32x32x16_bf16 v[16:31], v[96:99], v[88:91], v[16:31]
    ds_read_b64_tr_b16 v[84:85], v73 offset:49152
    ds_read_b64_tr_b16 v[86:87], v73 offset:50176
    s_waitcnt lgkmcnt(10)
    v_mfma_f32_32x32x16_bf16 v[0:15], v[104:107], v[100:103], v[0:15]
    ds_read_b128 v[88:91], v69 offset:24576
    ds_read_b64_tr_b16 v[92:93], v72 offset:53248
    ds_read_b64_tr_b16 v[94:95], v72 offset:54272
    v_mfma_f32_32x32x16_bf16 v[16:31], v[108:111], v[100:103], v[16:31]
    ds_read_b64_tr_b16 v[96:97], v73 offset:53248
    ds_read_b64_tr_b16 v[98:99], v73 offset:54272
    s_waitcnt lgkmcnt(10)
    v_mfma_f32_32x32x16_bf16 v[0:15], v[116:119], v[112:115], v[0:15]
    ds_read_b128 v[100:103], v70 offset:24576
    ds_read_b64_tr_b16 v[104:105], v72 offset:57344
    ds_read_b64_tr_b16 v[106:107], v72 offset:58368
    v_mfma_f32_32x32x16_bf16 v[16:31], v[120:123], v[112:115], v[16:31]
    ds_read_b64_tr_b16 v[108:109], v73 offset:57344
    ds_read_b64_tr_b16 v[110:111], v73 offset:58368
    s_waitcnt lgkmcnt(10)
    v_mfma_f32_32x32x16_bf16 v[0:15], v[80:83], v[76:79], v[0:15]
    ds_read_b128 v[112:115], v71 offset:24576
    ds_read_b64_tr_b16 v[116:117], v72 offset:61440
    ds_read_b64_tr_b16 v[118:119], v72 offset:62464
    v_mfma_f32_32x32x16_bf16 v[16:31], v[84:87], v[76:79], v[16:31]
    ds_read_b64_tr_b16 v[120:121], v73 offset:61440
    ds_read_b64_tr_b16 v[122:123], v73 offset:62464
    s_waitcnt lgkmcnt(10)
    s_barrier
    v_mfma_f32_32x32x16_bf16 v[0:15], v[92:95], v[88:91], v[0:15]
    ds_read_b128 v[76:79], v68 offset:32768
    ds_read_b64_tr_b16 v[80:81], v74 offset:0
    ds_read_b64_tr_b16 v[82:83], v74 offset:1024
    v_mfma_f32_32x32x16_bf16 v[16:31], v[96:99], v[88:91], v[16:31]
    ds_read_b64_tr_b16 v[84:85], v75 offset:0
    ds_read_b64_tr_b16 v[86:87], v75 offset:1024
    s_waitcnt lgkmcnt(10)
    v_mfma_f32_32x32x16_bf16 v[0:15], v[104:107], v[100:103], v[0:15]
    ds_read_b128 v[88:91], v69 offset:32768
    ds_read_b64_tr_b16 v[92:93], v74 offset:4096
    ds_read_b64_tr_b16 v[94:95], v74 offset:5120
    v_mfma_f32_32x32x16_bf16 v[16:31], v[108:111], v[100:103], v[16:31]
    ds_read_b64_tr_b16 v[96:97], v75 offset:4096
    ds_read_b64_tr_b16 v[98:99], v75 offset:5120
    s_waitcnt lgkmcnt(10)
    v_mfma_f32_32x32x16_bf16 v[0:15], v[116:119], v[112:115], v[0:15]
    ds_read_b128 v[100:103], v70 offset:32768
    ds_read_b64_tr_b16 v[104:105], v74 offset:8192
    ds_read_b64_tr_b16 v[106:107], v74 offset:9216
    v_mfma_f32_32x32x16_bf16 v[16:31], v[120:123], v[112:115], v[16:31]
    ds_read_b64_tr_b16 v[108:109], v75 offset:8192
    ds_read_b64_tr_b16 v[110:111], v75 offset:9216
    s_waitcnt lgkmcnt(10)
    v_mfma_f32_32x32x16_bf16 v[0:15], v[80:83], v[76:79], v[0:15]
    ds_read_b128 v[112:115], v71 offset:32768
    ds_read_b64_tr_b16 v[116:117], v74 offset:12288
    ds_read_b64_tr_b16 v[118:119], v74 offset:13312
    v_mfma_f32_32x32x16_bf16 v[16:31], v[84:87], v[76:79], v[16:31]
    ds_read_b64_tr_b16 v[120:121], v75 offset:12288
    ds_read_b64_tr_b16 v[122:123], v75 offset:13312
    s_waitcnt lgkmcnt(10)
    s_barrier
    v_mfma_f32_32x32x16_bf16 v[0:15], v[92:95], v[88:91], v[0:15]
    ds_read_b128 v[76:79], v68 offset:40960
    ds_read_b64_tr_b16 v[80:81], v74 offset:16384
    ds_read_b64_tr_b16 v[82:83], v74 offset:17408
    v_mfma_f32_32x32x16_bf16 v[16:31], v[96:99], v[88:91], v[16:31]
    ds_read_b64_tr_b16 v[84:85], v75 offset:16384
    ds_read_b64_tr_b16 v[86:87], v75 offset:17408
    s_waitcnt lgkmcnt(10)
    v_mfma_f32_32x32x16_bf16 v[0:15], v[104:107], v[100:103], v[0:15]
    ds_read_b128 v[88:91], v69 offset:40960
    ds_read_b64_tr_b16 v[92:93], v74 offset:20480
    ds_read_b64_tr_b16 v[94:95], v74 offset:21504
    v_mfma_f32_32x32x16_bf16 v[16:31], v[108:111], v[100:103], v[16:31]
    ds_read_b64_tr_b16 v[96:97], v75 offset:20480
    ds_read_b64_tr_b16 v[98:99], v75 offset:21504
    s_waitcnt lgkmcnt(10)
    v_mfma_f32_32x32x16_bf16 v[0:15], v[116:119], v[112:115], v[0:15]
    ds_read_b128 v[100:103], v70 offset:40960
    ds_read_b64_tr_b16 v[104:105], v74 offset:24576
    ds_read_b64_tr_b16 v[106:107], v74 offset:25600
    v_mfma_f32_32x32x16_bf16 v[16:31], v[120:123], v[112:115], v[16:31]
    ds_read_b64_tr_b16 v[108:109], v75 offset:24576
    ds_read_b64_tr_b16 v[110:111], v75 offset:25600
    s_waitcnt lgkmcnt(10)
    v_mfma_f32_32x32x16_bf16 v[0:15], v[80:83], v[76:79], v[0:15]
    ds_read_b128 v[112:115], v71 offset:40960
    ds_read_b64_tr_b16 v[116:117], v74 offset:28672
    ds_read_b64_tr_b16 v[118:119], v74 offset:29696
    v_mfma_f32_32x32x16_bf16 v[16:31], v[84:87], v[76:79], v[16:31]
    ds_read_b64_tr_b16 v[120:121], v75 offset:28672
    ds_read_b64_tr_b16 v[122:123], v75 offset:29696
    s_waitcnt lgkmcnt(10)
    s_barrier
    v_mfma_f32_32x32x16_bf16 v[0:15], v[92:95], v[88:91], v[0:15]
    ds_read_b128 v[76:79], v68 offset:0
    ds_read_b64_tr_b16 v[80:81], v74 offset:32768
    ds_read_b64_tr_b16 v[82:83], v74 offset:33792
    v_mfma_f32_32x32x16_bf16 v[16:31], v[96:99], v[88:91], v[16:31]
    ds_read_b64_tr_b16 v[84:85], v75 offset:32768
    ds_read_b64_tr_b16 v[86:87], v75 offset:33792
    s_waitcnt lgkmcnt(10)
    v_mfma_f32_32x32x16_bf16 v[0:15], v[104:107], v[100:103], v[0:15]
    ds_read_b128 v[88:91], v69 offset:0
    ds_read_b64_tr_b16 v[92:93], v74 offset:36864
    ds_read_b64_tr_b16 v[94:95], v74 offset:37888
    v_mfma_f32_32x32x16_bf16 v[16:31], v[108:111], v[100:103], v[16:31]
    ds_read_b64_tr_b16 v[96:97], v75 offset:36864
    ds_read_b64_tr_b16 v[98:99], v75 offset:37888
    s_waitcnt lgkmcnt(10)
    v_mfma_f32_32x32x16_bf16 v[0:15], v[116:119], v[112:115], v[0:15]
    ds_read_b128 v[100:103], v70 offset:0
    ds_read_b64_tr_b16 v[104:105], v74 offset:40960
    ds_read_b64_tr_b16 v[106:107], v74 offset:41984
    v_mfma_f32_32x32x16_bf16 v[16:31], v[120:123], v[112:115], v[16:31]
    ds_read_b64_tr_b16 v[108:109], v75 offset:40960
    ds_read_b64_tr_b16 v[110:111], v75 offset:41984
    s_waitcnt lgkmcnt(10)
    v_mfma_f32_32x32x16_bf16 v[0:15], v[80:83], v[76:79], v[0:15]
    ds_read_b128 v[112:115], v71 offset:0
    ds_read_b64_tr_b16 v[116:117], v74 offset:45056
    ds_read_b64_tr_b16 v[118:119], v74 offset:46080
    v_mfma_f32_32x32x16_bf16 v[16:31], v[84:87], v[76:79], v[16:31]
    ds_read_b64_tr_b16 v[120:121], v75 offset:45056
    ds_read_b64_tr_b16 v[122:123], v75 offset:46080
    s_waitcnt lgkmcnt(10)
    s_barrier
    v_mfma_f32_32x32x16_bf16 v[0:15], v[92:95], v[88:91], v[0:15]
    ds_read_b128 v[76:79], v68 offset:8192
    ds_read_b64_tr_b16 v[80:81], v72 offset:0
    ds_read_b64_tr_b16 v[82:83], v72 offset:1024
    v_mfma_f32_32x32x16_bf16 v[16:31], v[96:99], v[88:91], v[16:31]
    ds_read_b64_tr_b16 v[84:85], v73 offset:0
    ds_read_b64_tr_b16 v[86:87], v73 offset:1024
    s_waitcnt lgkmcnt(10)
    v_mfma_f32_32x32x16_bf16 v[0:15], v[104:107], v[100:103], v[0:15]
    ds_read_b128 v[88:91], v69 offset:8192
    ds_read_b64_tr_b16 v[92:93], v72 offset:4096
    ds_read_b64_tr_b16 v[94:95], v72 offset:5120
    v_mfma_f32_32x32x16_bf16 v[16:31], v[108:111], v[100:103], v[16:31]
    ds_read_b64_tr_b16 v[96:97], v73 offset:4096
    ds_read_b64_tr_b16 v[98:99], v73 offset:5120
    s_waitcnt lgkmcnt(10)
    v_mfma_f32_32x32x16_bf16 v[0:15], v[116:119], v[112:115], v[0:15]
    ds_read_b128 v[100:103], v70 offset:8192
    ds_read_b64_tr_b16 v[104:105], v72 offset:8192
    ds_read_b64_tr_b16 v[106:107], v72 offset:9216
    v_mfma_f32_32x32x16_bf16 v[16:31], v[120:123], v[112:115], v[16:31]
    ds_read_b64_tr_b16 v[108:109], v73 offset:8192
    ds_read_b64_tr_b16 v[110:111], v73 offset:9216
    s_waitcnt lgkmcnt(10)
    v_mfma_f32_32x32x16_bf16 v[32:47], v[80:83], v[76:79], 0
    ds_read_b128 v[112:115], v71 offset:8192
    ds_read_b64_tr_b16 v[116:117], v72 offset:12288
    ds_read_b64_tr_b16 v[118:119], v72 offset:13312
    v_mfma_f32_32x32x16_bf16 v[48:63], v[84:87], v[76:79], 0
    ds_read_b64_tr_b16 v[120:121], v73 offset:12288
    ds_read_b64_tr_b16 v[122:123], v73 offset:13312
    s_waitcnt lgkmcnt(10)
    s_barrier
    v_mfma_f32_32x32x16_bf16 v[32:47], v[92:95], v[88:91], v[32:47]
    ds_read_b128 v[76:79], v68 offset:16384
    ds_read_b64_tr_b16 v[80:81], v72 offset:16384
    ds_read_b64_tr_b16 v[82:83], v72 offset:17408
    v_mfma_f32_32x32x16_bf16 v[48:63], v[96:99], v[88:91], v[48:63]
    ds_read_b64_tr_b16 v[84:85], v73 offset:16384
    ds_read_b64_tr_b16 v[86:87], v73 offset:17408
    s_waitcnt lgkmcnt(10)
    v_mfma_f32_32x32x16_bf16 v[32:47], v[104:107], v[100:103], v[32:47]
    v_mul_f32 v0, s44, v0
    v_mul_f32 v1, s44, v1
    v_mul_f32 v2, s44, v2
    ds_read_b128 v[88:91], v69 offset:16384
    ds_read_b64_tr_b16 v[92:93], v72 offset:20480
    ds_read_b64_tr_b16 v[94:95], v72 offset:21504
    v_mfma_f32_32x32x16_bf16 v[48:63], v[108:111], v[100:103], v[48:63]
    v_mul_f32 v3, s44, v3
    v_mul_f32 v4, s44, v4
    v_mul_f32 v5, s44, v5
    ds_read_b64_tr_b16 v[96:97], v73 offset:20480
    ds_read_b64_tr_b16 v[98:99], v73 offset:21504
    s_waitcnt lgkmcnt(10)
    v_mfma_f32_32x32x16_bf16 v[32:47], v[116:119], v[112:115], v[32:47]
    v_mul_f32 v6, s44, v6
    v_mul_f32 v7, s44, v7
    v_mul_f32 v8, s44, v8
    ds_read_b128 v[100:103], v70 offset:16384
    ds_read_b64_tr_b16 v[104:105], v72 offset:24576
    ds_read_b64_tr_b16 v[106:107], v72 offset:25600
    v_mfma_f32_32x32x16_bf16 v[48:63], v[120:123], v[112:115], v[48:63]
    v_mul_f32 v9, s44, v9
    v_mul_f32 v10, s44, v10
    v_mul_f32 v11, s44, v11
    ds_read_b64_tr_b16 v[108:109], v73 offset:24576
    ds_read_b64_tr_b16 v[110:111], v73 offset:25600
    s_waitcnt lgkmcnt(10)
    v_mfma_f32_32x32x16_bf16 v[32:47], v[80:83], v[76:79], v[32:47]
    v_mul_f32 v12, s44, v12
    v_mul_f32 v13, s44, v13
    ds_read_b128 v[112:115], v71 offset:16384
    ds_read_b64_tr_b16 v[116:117], v72 offset:28672
    ds_read_b64_tr_b16 v[118:119], v72 offset:29696
    v_mfma_f32_32x32x16_bf16 v[48:63], v[84:87], v[76:79], v[48:63]
    v_mul_f32 v14, s44, v14
    v_mul_f32 v15, s44, v15
    v_cvt_pk_bf16_f32 v192, v0, v1
    ds_read_b64_tr_b16 v[120:121], v73 offset:28672
    ds_read_b64_tr_b16 v[122:123], v73 offset:29696
    s_waitcnt lgkmcnt(10)
    s_barrier
    v_mfma_f32_32x32x16_bf16 v[32:47], v[92:95], v[88:91], v[32:47]
    v_cvt_pk_bf16_f32 v193, v2, v3
    v_cvt_pk_bf16_f32 v194, v4, v5
    v_cvt_pk_bf16_f32 v195, v6, v7
    ds_read_b128 v[76:79], v68 offset:24576
    ds_read_b64_tr_b16 v[80:81], v72 offset:32768
    ds_read_b64_tr_b16 v[82:83], v72 offset:33792
    v_mfma_f32_32x32x16_bf16 v[48:63], v[96:99], v[88:91], v[48:63]
    v_cvt_pk_bf16_f32 v196, v8, v9
    v_cvt_pk_bf16_f32 v197, v10, v11
    v_cvt_pk_bf16_f32 v198, v12, v13
    ds_read_b64_tr_b16 v[84:85], v73 offset:32768
    ds_read_b64_tr_b16 v[86:87], v73 offset:33792
    s_waitcnt lgkmcnt(10)
    v_mfma_f32_32x32x16_bf16 v[32:47], v[104:107], v[100:103], v[32:47]
    v_cvt_pk_bf16_f32 v199, v14, v15
    v_cndmask_b32 v198, v198, v178, vcc
    v_cndmask_b32 v199, v199, v179, vcc
    ds_read_b128 v[88:91], v69 offset:24576
    ds_read_b64_tr_b16 v[92:93], v72 offset:36864
    ds_read_b64_tr_b16 v[94:95], v72 offset:37888
    v_mfma_f32_32x32x16_bf16 v[48:63], v[108:111], v[100:103], v[48:63]
    v_mul_f32 v16, s44, v16
    v_mul_f32 v17, s44, v17
    ds_read_b64_tr_b16 v[96:97], v73 offset:36864
    ds_read_b64_tr_b16 v[98:99], v73 offset:37888
    s_waitcnt lgkmcnt(10)
    v_mfma_f32_32x32x16_bf16 v[32:47], v[116:119], v[112:115], v[32:47]
    v_mul_f32 v18, s44, v18
    v_mul_f32 v19, s44, v19
    v_mul_f32 v20, s44, v20
    ds_read_b128 v[100:103], v70 offset:24576
    ds_read_b64_tr_b16 v[104:105], v72 offset:40960
    ds_read_b64_tr_b16 v[106:107], v72 offset:41984
    v_mfma_f32_32x32x16_bf16 v[48:63], v[120:123], v[112:115], v[48:63]
    v_mul_f32 v21, s44, v21
    v_mul_f32 v22, s44, v22
    v_mul_f32 v23, s44, v23
    ds_read_b64_tr_b16 v[108:109], v73 offset:40960
    ds_read_b64_tr_b16 v[110:111], v73 offset:41984
    s_waitcnt lgkmcnt(10)
    v_mfma_f32_32x32x16_bf16 v[32:47], v[80:83], v[76:79], v[32:47]
    v_mul_f32 v24, s44, v24
    v_mul_f32 v25, s44, v25
    v_mul_f32 v26, s44, v26
    ds_read_b128 v[112:115], v71 offset:24576
    ds_read_b64_tr_b16 v[116:117], v72 offset:45056
    ds_read_b64_tr_b16 v[118:119], v72 offset:46080
    v_mfma_f32_32x32x16_bf16 v[48:63], v[84:87], v[76:79], v[48:63]
    v_mul_f32 v27, s44, v27
    v_mul_f32 v28, s44, v28
    v_mul_f32 v29, s44, v29
    ds_read_b64_tr_b16 v[120:121], v73 offset:45056
    ds_read_b64_tr_b16 v[122:123], v73 offset:46080
    s_waitcnt lgkmcnt(10)
    s_barrier
    v_mfma_f32_32x32x16_bf16 v[32:47], v[92:95], v[88:91], v[32:47]
    v_mul_f32 v30, s44, v30
    v_mul_f32 v31, s44, v31
    ds_read_b128 v[76:79], v68 offset:32768
    ds_read_b64_tr_b16 v[80:81], v72 offset:49152
    ds_read_b64_tr_b16 v[82:83], v72 offset:50176
    v_mfma_f32_32x32x16_bf16 v[48:63], v[96:99], v[88:91], v[48:63]
    v_cvt_pk_bf16_f32 v200, v16, v17
    v_cvt_pk_bf16_f32 v201, v18, v19
    v_cvt_pk_bf16_f32 v202, v20, v21
    ds_read_b64_tr_b16 v[84:85], v73 offset:49152
    ds_read_b64_tr_b16 v[86:87], v73 offset:50176
    s_waitcnt lgkmcnt(10)
    v_mfma_f32_32x32x16_bf16 v[32:47], v[104:107], v[100:103], v[32:47]
    v_cvt_pk_bf16_f32 v203, v22, v23
    v_cvt_pk_bf16_f32 v204, v24, v25
    v_cvt_pk_bf16_f32 v205, v26, v27
    ds_read_b128 v[88:91], v69 offset:32768
    ds_read_b64_tr_b16 v[92:93], v72 offset:53248
    ds_read_b64_tr_b16 v[94:95], v72 offset:54272
    v_mfma_f32_32x32x16_bf16 v[48:63], v[108:111], v[100:103], v[48:63]
    v_cvt_pk_bf16_f32 v206, v28, v29
    v_cvt_pk_bf16_f32 v207, v30, v31
    v_cndmask_b32 v206, v206, v178, vcc
    ds_read_b64_tr_b16 v[96:97], v73 offset:53248
    ds_read_b64_tr_b16 v[98:99], v73 offset:54272
    s_waitcnt lgkmcnt(10)
    v_mfma_f32_32x32x16_bf16 v[32:47], v[116:119], v[112:115], v[32:47]
    v_cndmask_b32 v207, v207, v179, vcc
    ds_write_b128 v180, v[192:195] offset:0
    ds_write_b128 v180, v[196:199] offset:1024
    ds_read_b128 v[100:103], v70 offset:32768
    ds_read_b64_tr_b16 v[104:105], v72 offset:57344
    ds_read_b64_tr_b16 v[106:107], v72 offset:58368
    v_mfma_f32_32x32x16_bf16 v[48:63], v[120:123], v[112:115], v[48:63]
    ds_write_b128 v180, v[200:203] offset:2048
    ds_write_b128 v180, v[204:207] offset:3072
    ds_read_b64_tr_b16 v[108:109], v73 offset:57344
    ds_read_b64_tr_b16 v[110:111], v73 offset:58368
    s_waitcnt lgkmcnt(10)
    v_mfma_f32_32x32x16_bf16 v[32:47], v[80:83], v[76:79], v[32:47]
    ds_read_b128 v[112:115], v71 offset:32768
    ds_read_b64_tr_b16 v[116:117], v72 offset:61440
    ds_read_b64_tr_b16 v[118:119], v72 offset:62464
    v_mfma_f32_32x32x16_bf16 v[48:63], v[84:87], v[76:79], v[48:63]
    ds_read_b64_tr_b16 v[120:121], v73 offset:61440
    ds_read_b64_tr_b16 v[122:123], v73 offset:62464
    s_waitcnt lgkmcnt(10)
    s_waitcnt lgkmcnt(5)
    s_barrier
    v_mfma_f32_32x32x16_bf16 v[32:47], v[92:95], v[88:91], v[32:47]
    ds_read_b128 v[76:79], v68 offset:40960
    ds_read_b64_tr_b16 v[80:81], v74 offset:0
    ds_read_b64_tr_b16 v[82:83], v74 offset:1024
    v_mfma_f32_32x32x16_bf16 v[48:63], v[96:99], v[88:91], v[48:63]
    ds_read_b64_tr_b16 v[84:85], v75 offset:0
    ds_read_b64_tr_b16 v[86:87], v75 offset:1024
    s_waitcnt lgkmcnt(10)
    v_mfma_f32_32x32x16_bf16 v[32:47], v[104:107], v[100:103], v[32:47]
    ds_read_b128 v[88:91], v69 offset:40960
    ds_read_b64_tr_b16 v[92:93], v74 offset:4096
    ds_read_b64_tr_b16 v[94:95], v74 offset:5120
    v_mfma_f32_32x32x16_bf16 v[48:63], v[108:111], v[100:103], v[48:63]
    ds_read_b64_tr_b16 v[96:97], v75 offset:4096
    ds_read_b64_tr_b16 v[98:99], v75 offset:5120
    s_waitcnt lgkmcnt(10)
    v_mfma_f32_32x32x16_bf16 v[32:47], v[116:119], v[112:115], v[32:47]
    ds_read_b128 v[100:103], v70 offset:40960
    ds_read_b64_tr_b16 v[104:105], v74 offset:8192
    ds_read_b64_tr_b16 v[106:107], v74 offset:9216
    v_mfma_f32_32x32x16_bf16 v[48:63], v[120:123], v[112:115], v[48:63]
    ds_read_b64_tr_b16 v[108:109], v75 offset:8192
    ds_read_b64_tr_b16 v[110:111], v75 offset:9216
    s_waitcnt lgkmcnt(10)
    v_mfma_f32_32x32x16_bf16 v[32:47], v[80:83], v[76:79], v[32:47]
    ds_read_b128 v[112:115], v71 offset:40960
    ds_read_b64_tr_b16 v[116:117], v74 offset:12288
    ds_read_b64_tr_b16 v[118:119], v74 offset:13312
    v_mfma_f32_32x32x16_bf16 v[48:63], v[84:87], v[76:79], v[48:63]
    ds_read_b64_tr_b16 v[120:121], v75 offset:12288
    ds_read_b64_tr_b16 v[122:123], v75 offset:13312
    s_waitcnt lgkmcnt(10)
    v_mfma_f32_32x32x16_bf16 v[32:47], v[92:95], v[88:91], v[32:47]
    ds_read_b128 v[76:79], v68 offset:0
    ds_read_b64_tr_b16 v[80:81], v74 offset:16384
    ds_read_b64_tr_b16 v[82:83], v74 offset:17408
    v_mfma_f32_32x32x16_bf16 v[48:63], v[96:99], v[88:91], v[48:63]
    ds_read_b64_tr_b16 v[84:85], v75 offset:16384
    ds_read_b64_tr_b16 v[86:87], v75 offset:17408
    s_waitcnt lgkmcnt(10)
    v_mfma_f32_32x32x16_bf16 v[32:47], v[104:107], v[100:103], v[32:47]
    ds_read_b128 v[88:91], v69 offset:0
    ds_read_b64_tr_b16 v[92:93], v74 offset:20480
    ds_read_b64_tr_b16 v[94:95], v74 offset:21504
    v_mfma_f32_32x32x16_bf16 v[48:63], v[108:111], v[100:103], v[48:63]
    ds_read_b64_tr_b16 v[96:97], v75 offset:20480
    ds_read_b64_tr_b16 v[98:99], v75 offset:21504
    s_waitcnt lgkmcnt(10)
    v_mfma_f32_32x32x16_bf16 v[32:47], v[116:119], v[112:115], v[32:47]
    ds_read_b128 v[100:103], v70 offset:0
    ds_read_b64_tr_b16 v[104:105], v74 offset:24576
    ds_read_b64_tr_b16 v[106:107], v74 offset:25600
    v_mfma_f32_32x32x16_bf16 v[48:63], v[120:123], v[112:115], v[48:63]
    ds_read_b64_tr_b16 v[108:109], v75 offset:24576
    ds_read_b64_tr_b16 v[110:111], v75 offset:25600
    s_waitcnt lgkmcnt(10)
    v_mfma_f32_32x32x16_bf16 v[32:47], v[80:83], v[76:79], v[32:47]
    ds_read_b128 v[112:115], v71 offset:0
    ds_read_b64_tr_b16 v[116:117], v74 offset:28672
    ds_read_b64_tr_b16 v[118:119], v74 offset:29696
    v_mfma_f32_32x32x16_bf16 v[48:63], v[84:87], v[76:79], v[48:63]
    ds_read_b64_tr_b16 v[120:121], v75 offset:28672
    ds_read_b64_tr_b16 v[122:123], v75 offset:29696
    s_waitcnt lgkmcnt(10)
    v_mfma_f32_32x32x16_bf16 v[32:47], v[92:95], v[88:91], v[32:47]
    ds_read_b128 v[76:79], v68 offset:8192
    ds_read_b64_tr_b16 v[80:81], v74 offset:32768
    ds_read_b64_tr_b16 v[82:83], v74 offset:33792
    v_mfma_f32_32x32x16_bf16 v[48:63], v[96:99], v[88:91], v[48:63]
    ds_read_b64_tr_b16 v[84:85], v75 offset:32768
    ds_read_b64_tr_b16 v[86:87], v75 offset:33792
    s_waitcnt lgkmcnt(10)
    v_mfma_f32_32x32x16_bf16 v[32:47], v[104:107], v[100:103], v[32:47]
    ds_read_b128 v[88:91], v69 offset:8192
    ds_read_b64_tr_b16 v[92:93], v74 offset:36864
    ds_read_b64_tr_b16 v[94:95], v74 offset:37888
    v_mfma_f32_32x32x16_bf16 v[48:63], v[108:111], v[100:103], v[48:63]
    ds_read_b64_tr_b16 v[96:97], v75 offset:36864
    ds_read_b64_tr_b16 v[98:99], v75 offset:37888
    s_waitcnt lgkmcnt(10)
    v_mfma_f32_32x32x16_bf16 v[32:47], v[116:119], v[112:115], v[32:47]
    ds_read_b128 v[100:103], v70 offset:8192
    ds_read_b64_tr_b16 v[104:105], v74 offset:40960
    ds_read_b64_tr_b16 v[106:107], v74 offset:41984
    v_mfma_f32_32x32x16_bf16 v[48:63], v[120:123], v[112:115], v[48:63]
    ds_read_b64_tr_b16 v[108:109], v75 offset:40960
    ds_read_b64_tr_b16 v[110:111], v75 offset:41984
    s_waitcnt lgkmcnt(10)
    v_mfma_f32_32x32x16_bf16 v[32:47], v[80:83], v[76:79], v[32:47]
    ds_read_b128 v[112:115], v71 offset:8192
    ds_read_b64_tr_b16 v[116:117], v74 offset:45056
    ds_read_b64_tr_b16 v[118:119], v74 offset:46080
    v_mfma_f32_32x32x16_bf16 v[48:63], v[84:87], v[76:79], v[48:63]
    ds_read_b64_tr_b16 v[120:121], v75 offset:45056
    ds_read_b64_tr_b16 v[122:123], v75 offset:46080
    s_waitcnt lgkmcnt(10)
    v_mfma_f32_32x32x16_bf16 v[32:47], v[92:95], v[88:91], v[32:47]
    v_mfma_f32_32x32x16_bf16 v[48:63], v[96:99], v[88:91], v[48:63]
    s_waitcnt lgkmcnt(5)
    v_mfma_f32_32x32x16_bf16 v[32:47], v[104:107], v[100:103], v[32:47]
    v_mfma_f32_32x32x16_bf16 v[48:63], v[108:111], v[100:103], v[48:63]
    s_waitcnt lgkmcnt(0)
    v_mfma_f32_32x32x16_bf16 v[32:47], v[116:119], v[112:115], v[32:47]
    v_mfma_f32_32x32x16_bf16 v[48:63], v[120:123], v[112:115], v[48:63]
    s_nop 10
    s_cmp_lt_u32 s32, 4
    s_cbranch_scc1 k1_nm0
    v_mul_f32 v32, s44, v32
    v_mul_f32 v33, s44, v33
    v_mul_f32 v34, s44, v34
    v_mul_f32 v35, s44, v35
    v_mul_f32 v36, s44, v36
    v_mul_f32 v37, s44, v37
    v_mul_f32 v38, s44, v38
    v_mul_f32 v39, s44, v39
    v_mul_f32 v40, s44, v40
    v_mul_f32 v41, s44, v41
    v_mul_f32 v42, s44, v42
    v_mul_f32 v43, s44, v43
    v_mul_f32 v44, s44, v44
    v_mul_f32 v45, s44, v45
    v_mul_f32 v46, s44, v46
    v_mul_f32 v47, s44, v47
k1_nm0:
    v_cvt_pk_bf16_f32 v208, v32, v33
    v_cvt_pk_bf16_f32 v209, v34, v35
    v_cvt_pk_bf16_f32 v210, v36, v37
    v_cvt_pk_bf16_f32 v211, v38, v39
    v_cvt_pk_bf16_f32 v212, v40, v41
    v_cvt_pk_bf16_f32 v213, v42, v43
    v_cvt_pk_bf16_f32 v214, v44, v45
    v_cvt_pk_bf16_f32 v215, v46, v47
    v_cndmask_b32 v214, v214, v178, vcc
    v_cndmask_b32 v215, v215, v179, vcc
    buffer_store_dwordx4 v[208:211], v189, s[16:19], s35 offen offset:0 sc1
    buffer_store_dwordx4 v[212:215], v189, s[16:19], s35 offen offset:1024 sc1
    s_nop 0
    s_cmp_lt_u32 s32, 4
    s_cbranch_scc1 k1_nm1
    v_mul_f32 v48, s44, v48
    v_mul_f32 v49, s44, v49
    v_mul_f32 v50, s44, v50
    v_mul_f32 v51, s44, v51
    v_mul_f32 v52, s44, v52
    v_mul_f32 v53, s44, v53
    v_mul_f32 v54, s44, v54
    v_mul_f32 v55, s44, v55
    v_mul_f32 v56, s44, v56
    v_mul_f32 v57, s44, v57
    v_mul_f32 v58, s44, v58
    v_mul_f32 v59, s44, v59
    v_mul_f32 v60, s44, v60
    v_mul_f32 v61, s44, v61
    v_mul_f32 v62, s44, v62
    v_mul_f32 v63, s44, v63
k1_nm1:
    v_cvt_pk_bf16_f32 v216, v48, v49
    v_cvt_pk_bf16_f32 v217, v50, v51
    v_cvt_pk_bf16_f32 v218, v52, v53
    v_cvt_pk_bf16_f32 v219, v54, v55
    v_cvt_pk_bf16_f32 v220, v56, v57
    v_cvt_pk_bf16_f32 v221, v58, v59
    v_cvt_pk_bf16_f32 v222, v60, v61
    v_cvt_pk_bf16_f32 v223, v62, v63
    v_cndmask_b32 v222, v222, v178, vcc
    v_cndmask_b32 v223, v223, v179, vcc
    s_add_u32 s35, s35, 131072
    buffer_store_dwordx4 v[216:219], v189, s[16:19], s35 offen offset:0 sc1
    buffer_store_dwordx4 v[220:223], v189, s[16:19], s35 offen offset:1024 sc1
    s_branch k1_pf
k1_vd:
    s_and_b32 s38, s32, 3
    s_lshl_b32 s38, s38, 2
    s_and_b32 s39, s30, 2
    s_add_u32 s38, s38, s39
    s_lshl_b32 s38, s38, 6
    s_lshl_b32 s39, s31, 1
    s_and_b32 s35, s30, 1
    s_add_u32 s39, s39, s35
    s_add_u32 s39, s39, 32
    s_cmp_ge_u32 s32, 4
    s_cselect_b32 s39, s39, s59
    s_add_u32 s35, s38, s39
    s_lshl_b32 s35, s35, 11
    s_add_u32 s35, s35, 4194304
    v_and_b32 v172, 31, v64
    v_cmp_eq_u32 vcc, 28, v172
    v_mov_b32 v178, 0x3f803f80
    s_nop 0
    v_cndmask_b32 v178, 0, v178, vcc
    v_cmp_lt_u32 vcc, 27, v172
    s_cmp_lt_u32 s32, 12
    s_cbranch_scc1 k1_vt
    s_lshl_b32 s38, s32, 1
    s_lshr_b32 s39, s30, 1
    s_add_u32 s33, s38, s39
    s_lshl_b32 s38, s33, 12
    s_mul_i32 s34, s40, 32896
    s_add_u32 s34, s34, s38
    s_add_u32 s34, s34, 6193152
    s_mul_i32 s35, s59, 32896
    s_add_u32 s35, s35, s38
    s_add_u32 s35, s35, 6193152
k1_vt:
    s_waitcnt lgkmcnt(0)
    s_barrier
    ds_read_b128 v[76:79], v68 offset:0
    ds_read_b64_tr_b16 v[80:81], v72 offset:0
    ds_read_b64_tr_b16 v[82:83], v72 offset:1024
    ds_read_b64_tr_b16 v[84:85], v73 offset:0
    ds_read_b64_tr_b16 v[86:87], v73 offset:1024
    ds_read_b128 v[88:91], v69 offset:0
    ds_read_b64_tr_b16 v[92:93], v72 offset:4096
    ds_read_b64_tr_b16 v[94:95], v72 offset:5120
    ds_read_b64_tr_b16 v[96:97], v73 offset:4096
    ds_read_b64_tr_b16 v[98:99], v73 offset:5120
    ds_read_b128 v[100:103], v70 offset:0
    ds_read_b64_tr_b16 v[104:105], v72 offset:8192
    ds_read_b64_tr_b16 v[106:107], v72 offset:9216
    ds_read_b64_tr_b16 v[108:109], v73 offset:8192
    ds_read_b64_tr_b16 v[110:111], v73 offset:9216
    s_waitcnt lgkmcnt(10)
    v_mfma_f32_32x32x16_bf16 v[0:15], v[76:79], v[80:83], 0
    ds_read_b128 v[112:115], v71 offset:0
    ds_read_b64_tr_b16 v[116:117], v72 offset:12288
    ds_read_b64_tr_b16 v[118:119], v72 offset:13312
    v_mfma_f32_32x32x16_bf16 v[16:31], v[76:79], v[84:87], 0
    ds_read_b64_tr_b16 v[120:121], v73 offset:12288
    ds_read_b64_tr_b16 v[122:123], v73 offset:13312
    s_waitcnt lgkmcnt(10)
    s_barrier
    v_mfma_f32_32x32x16_bf16 v[0:15], v[88:91], v[92:95], v[0:15]
    ds_read_b128 v[76:79], v68 offset:8192
    ds_read_b64_tr_b16 v[80:81], v72 offset:16384
    ds_read_b64_tr_b16 v[82:83], v72 offset:17408
    v_mfma_f32_32x32x16_bf16 v[16:31], v[88:91], v[96:99], v[16:31]
    ds_read_b64_tr_b16 v[84:85], v73 offset:16384
    ds_read_b64_tr_b16 v[86:87], v73 offset:17408
    s_waitcnt lgkmcnt(10)
    v_mfma_f32_32x32x16_bf16 v[0:15], v[100:103], v[104:107], v[0:15]
    ds_read_b128 v[88:91], v69 offset:8192
    ds_read_b64_tr_b16 v[92:93], v72 offset:20480
    ds_read_b64_tr_b16 v[94:95], v72 offset:21504
    v_mfma_f32_32x32x16_bf16 v[16:31], v[100:103], v[108:111], v[16:31]
    ds_read_b64_tr_b16 v[96:97], v73 offset:20480
    ds_read_b64_tr_b16 v[98:99], v73 offset:21504
    s_waitcnt lgkmcnt(10)
    v_mfma_f32_32x32x16_bf16 v[0:15], v[112:115], v[116:119], v[0:15]
    ds_read_b128 v[100:103], v70 offset:8192
    ds_read_b64_tr_b16 v[104:105], v72 offset:24576
    ds_read_b64_tr_b16 v[106:107], v72 offset:25600
    v_mfma_f32_32x32x16_bf16 v[16:31], v[112:115], v[120:123], v[16:31]
    ds_read_b64_tr_b16 v[108:109], v73 offset:24576
    ds_read_b64_tr_b16 v[110:111], v73 offset:25600
    s_waitcnt lgkmcnt(10)
    v_mfma_f32_32x32x16_bf16 v[0:15], v[76:79], v[80:83], v[0:15]
    ds_read_b128 v[112:115], v71 offset:8192
    ds_read_b64_tr_b16 v[116:117], v72 offset:28672
    ds_read_b64_tr_b16 v[118:119], v72 offset:29696
    v_mfma_f32_32x32x16_bf16 v[16:31], v[76:79], v[84:87], v[16:31]
    ds_read_b64_tr_b16 v[120:121], v73 offset:28672
    ds_read_b64_tr_b16 v[122:123], v73 offset:29696
    s_waitcnt lgkmcnt(10)
    s_barrier
    v_mfma_f32_32x32x16_bf16 v[0:15], v[88:91], v[92:95], v[0:15]
    ds_read_b128 v[76:79], v68 offset:16384
    ds_read_b64_tr_b16 v[80:81], v72 offset:32768
    ds_read_b64_tr_b16 v[82:83], v72 offset:33792
    v_mfma_f32_32x32x16_bf16 v[16:31], v[88:91], v[96:99], v[16:31]
    ds_read_b64_tr_b16 v[84:85], v73 offset:32768
    ds_read_b64_tr_b16 v[86:87], v73 offset:33792
    s_waitcnt lgkmcnt(10)
    v_mfma_f32_32x32x16_bf16 v[0:15], v[100:103], v[104:107], v[0:15]
    ds_read_b128 v[88:91], v69 offset:16384
    ds_read_b64_tr_b16 v[92:93], v72 offset:36864
    ds_read_b64_tr_b16 v[94:95], v72 offset:37888
    v_mfma_f32_32x32x16_bf16 v[16:31], v[100:103], v[108:111], v[16:31]
    ds_read_b64_tr_b16 v[96:97], v73 offset:36864
    ds_read_b64_tr_b16 v[98:99], v73 offset:37888
    s_waitcnt lgkmcnt(10)
    v_mfma_f32_32x32x16_bf16 v[0:15], v[112:115], v[116:119], v[0:15]
    ds_read_b128 v[100:103], v70 offset:16384
    ds_read_b64_tr_b16 v[104:105], v72 offset:40960
    ds_read_b64_tr_b16 v[106:107], v72 offset:41984
    v_mfma_f32_32x32x16_bf16 v[16:31], v[112:115], v[120:123], v[16:31]
    ds_read_b64_tr_b16 v[108:109], v73 offset:40960
    ds_read_b64_tr_b16 v[110:111], v73 offset:41984
    s_waitcnt lgkmcnt(10)
    v_mfma_f32_32x32x16_bf16 v[0:15], v[76:79], v[80:83], v[0:15]
    ds_read_b128 v[112:115], v71 offset:16384
    ds_read_b64_tr_b16 v[116:117], v72 offset:45056
    ds_read_b64_tr_b16 v[118:119], v72 offset:46080
    v_mfma_f32_32x32x16_bf16 v[16:31], v[76:79], v[84:87], v[16:31]
    ds_read_b64_tr_b16 v[120:121], v73 offset:45056
    ds_read_b64_tr_b16 v[122:123], v73 offset:46080
    s_waitcnt lgkmcnt(10)
    s_barrier
    v_mfma_f32_32x32x16_bf16 v[0:15], v[88:91], v[92:95], v[0:15]
    ds_read_b128 v[76:79], v68 offset:24576
    ds_read_b64_tr_b16 v[80:81], v72 offset:49152
    ds_read_b64_tr_b16 v[82:83], v72 offset:50176
    v_mfma_f32_32x32x16_bf16 v[16:31], v[88:91], v[96:99], v[16:31]
    ds_read_b64_tr_b16 v[84:85], v73 offset:49152
    ds_read_b64_tr_b16 v[86:87], v73 offset:50176
    s_waitcnt lgkmcnt(10)
    v_mfma_f32_32x32x16_bf16 v[0:15], v[100:103], v[104:107], v[0:15]
    ds_read_b128 v[88:91], v69 offset:24576
    ds_read_b64_tr_b16 v[92:93], v72 offset:53248
    ds_read_b64_tr_b16 v[94:95], v72 offset:54272
    v_mfma_f32_32x32x16_bf16 v[16:31], v[100:103], v[108:111], v[16:31]
    ds_read_b64_tr_b16 v[96:97], v73 offset:53248
    ds_read_b64_tr_b16 v[98:99], v73 offset:54272
    s_waitcnt lgkmcnt(10)
    v_mfma_f32_32x32x16_bf16 v[0:15], v[112:115], v[116:119], v[0:15]
    ds_read_b128 v[100:103], v70 offset:24576
    ds_read_b64_tr_b16 v[104:105], v72 offset:57344
    ds_read_b64_tr_b16 v[106:107], v72 offset:58368
    v_mfma_f32_32x32x16_bf16 v[16:31], v[112:115], v[120:123], v[16:31]
    ds_read_b64_tr_b16 v[108:109], v73 offset:57344
    ds_read_b64_tr_b16 v[110:111], v73 offset:58368
    s_waitcnt lgkmcnt(10)
    v_mfma_f32_32x32x16_bf16 v[0:15], v[76:79], v[80:83], v[0:15]
    ds_read_b128 v[112:115], v71 offset:24576
    ds_read_b64_tr_b16 v[116:117], v72 offset:61440
    ds_read_b64_tr_b16 v[118:119], v72 offset:62464
    v_mfma_f32_32x32x16_bf16 v[16:31], v[76:79], v[84:87], v[16:31]
    ds_read_b64_tr_b16 v[120:121], v73 offset:61440
    ds_read_b64_tr_b16 v[122:123], v73 offset:62464
    s_waitcnt lgkmcnt(10)
    s_barrier
    v_mfma_f32_32x32x16_bf16 v[0:15], v[88:91], v[92:95], v[0:15]
    ds_read_b128 v[76:79], v68 offset:32768
    ds_read_b64_tr_b16 v[80:81], v74 offset:0
    ds_read_b64_tr_b16 v[82:83], v74 offset:1024
    v_mfma_f32_32x32x16_bf16 v[16:31], v[88:91], v[96:99], v[16:31]
    ds_read_b64_tr_b16 v[84:85], v75 offset:0
    ds_read_b64_tr_b16 v[86:87], v75 offset:1024
    s_waitcnt lgkmcnt(10)
    v_mfma_f32_32x32x16_bf16 v[0:15], v[100:103], v[104:107], v[0:15]
    ds_read_b128 v[88:91], v69 offset:32768
    ds_read_b64_tr_b16 v[92:93], v74 offset:4096
    ds_read_b64_tr_b16 v[94:95], v74 offset:5120
    v_mfma_f32_32x32x16_bf16 v[16:31], v[100:103], v[108:111], v[16:31]
    ds_read_b64_tr_b16 v[96:97], v75 offset:4096
    ds_read_b64_tr_b16 v[98:99], v75 offset:5120
    s_waitcnt lgkmcnt(10)
    v_mfma_f32_32x32x16_bf16 v[0:15], v[112:115], v[116:119], v[0:15]
    ds_read_b128 v[100:103], v70 offset:32768
    ds_read_b64_tr_b16 v[104:105], v74 offset:8192
    ds_read_b64_tr_b16 v[106:107], v74 offset:9216
    v_mfma_f32_32x32x16_bf16 v[16:31], v[112:115], v[120:123], v[16:31]
    ds_read_b64_tr_b16 v[108:109], v75 offset:8192
    ds_read_b64_tr_b16 v[110:111], v75 offset:9216
    s_waitcnt lgkmcnt(10)
    v_mfma_f32_32x32x16_bf16 v[0:15], v[76:79], v[80:83], v[0:15]
    ds_read_b128 v[112:115], v71 offset:32768
    ds_read_b64_tr_b16 v[116:117], v74 offset:12288
    ds_read_b64_tr_b16 v[118:119], v74 offset:13312
    v_mfma_f32_32x32x16_bf16 v[16:31], v[76:79], v[84:87], v[16:31]
    ds_read_b64_tr_b16 v[120:121], v75 offset:12288
    ds_read_b64_tr_b16 v[122:123], v75 offset:13312
    s_waitcnt lgkmcnt(10)
    s_barrier
    v_mfma_f32_32x32x16_bf16 v[0:15], v[88:91], v[92:95], v[0:15]
    ds_read_b128 v[76:79], v68 offset:40960
    ds_read_b64_tr_b16 v[80:81], v74 offset:16384
    ds_read_b64_tr_b16 v[82:83], v74 offset:17408
    v_mfma_f32_32x32x16_bf16 v[16:31], v[88:91], v[96:99], v[16:31]
    ds_read_b64_tr_b16 v[84:85], v75 offset:16384
    ds_read_b64_tr_b16 v[86:87], v75 offset:17408
    s_waitcnt lgkmcnt(10)
    v_mfma_f32_32x32x16_bf16 v[0:15], v[100:103], v[104:107], v[0:15]
    ds_read_b128 v[88:91], v69 offset:40960
    ds_read_b64_tr_b16 v[92:93], v74 offset:20480
    ds_read_b64_tr_b16 v[94:95], v74 offset:21504
    v_mfma_f32_32x32x16_bf16 v[16:31], v[100:103], v[108:111], v[16:31]
    ds_read_b64_tr_b16 v[96:97], v75 offset:20480
    ds_read_b64_tr_b16 v[98:99], v75 offset:21504
    s_waitcnt lgkmcnt(10)
    v_mfma_f32_32x32x16_bf16 v[0:15], v[112:115], v[116:119], v[0:15]
    ds_read_b128 v[100:103], v70 offset:40960
    ds_read_b64_tr_b16 v[104:105], v74 offset:24576
    ds_read_b64_tr_b16 v[106:107], v74 offset:25600
    v_mfma_f32_32x32x16_bf16 v[16:31], v[112:115], v[120:123], v[16:31]
    ds_read_b64_tr_b16 v[108:109], v75 offset:24576
    ds_read_b64_tr_b16 v[110:111], v75 offset:25600
    s_waitcnt lgkmcnt(10)
    v_mfma_f32_32x32x16_bf16 v[0:15], v[76:79], v[80:83], v[0:15]
    ds_read_b128 v[112:115], v71 offset:40960
    ds_read_b64_tr_b16 v[116:117], v74 offset:28672
    ds_read_b64_tr_b16 v[118:119], v74 offset:29696
    v_mfma_f32_32x32x16_bf16 v[16:31], v[76:79], v[84:87], v[16:31]
    ds_read_b64_tr_b16 v[120:121], v75 offset:28672
    ds_read_b64_tr_b16 v[122:123], v75 offset:29696
    s_waitcnt lgkmcnt(10)
    s_barrier
    v_mfma_f32_32x32x16_bf16 v[0:15], v[88:91], v[92:95], v[0:15]
    ds_read_b128 v[76:79], v68 offset:0
    ds_read_b64_tr_b16 v[80:81], v74 offset:32768
    ds_read_b64_tr_b16 v[82:83], v74 offset:33792
    v_mfma_f32_32x32x16_bf16 v[16:31], v[88:91], v[96:99], v[16:31]
    ds_read_b64_tr_b16 v[84:85], v75 offset:32768
    ds_read_b64_tr_b16 v[86:87], v75 offset:33792
    s_waitcnt lgkmcnt(10)
    v_mfma_f32_32x32x16_bf16 v[0:15], v[100:103], v[104:107], v[0:15]
    ds_read_b128 v[88:91], v69 offset:0
    ds_read_b64_tr_b16 v[92:93], v74 offset:36864
    ds_read_b64_tr_b16 v[94:95], v74 offset:37888
    v_mfma_f32_32x32x16_bf16 v[16:31], v[100:103], v[108:111], v[16:31]
    ds_read_b64_tr_b16 v[96:97], v75 offset:36864
    ds_read_b64_tr_b16 v[98:99], v75 offset:37888
    s_waitcnt lgkmcnt(10)
    v_mfma_f32_32x32x16_bf16 v[0:15], v[112:115], v[116:119], v[0:15]
    ds_read_b128 v[100:103], v70 offset:0
    ds_read_b64_tr_b16 v[104:105], v74 offset:40960
    ds_read_b64_tr_b16 v[106:107], v74 offset:41984
    v_mfma_f32_32x32x16_bf16 v[16:31], v[112:115], v[120:123], v[16:31]
    ds_read_b64_tr_b16 v[108:109], v75 offset:40960
    ds_read_b64_tr_b16 v[110:111], v75 offset:41984
    s_waitcnt lgkmcnt(10)
    v_mfma_f32_32x32x16_bf16 v[0:15], v[76:79], v[80:83], v[0:15]
    ds_read_b128 v[112:115], v71 offset:0
    ds_read_b64_tr_b16 v[116:117], v74 offset:45056
    ds_read_b64_tr_b16 v[118:119], v74 offset:46080
    v_mfma_f32_32x32x16_bf16 v[16:31], v[76:79], v[84:87], v[16:31]
    ds_read_b64_tr_b16 v[120:121], v75 offset:45056
    ds_read_b64_tr_b16 v[122:123], v75 offset:46080
    s_waitcnt lgkmcnt(10)
    s_barrier
    v_mfma_f32_32x32x16_bf16 v[0:15], v[88:91], v[92:95], v[0:15]
    ds_read_b128 v[76:79], v68 offset:8192
    ds_read_b64_tr_b16 v[80:81], v72 offset:0
    ds_read_b64_tr_b16 v[82:83], v72 offset:1024
    v_mfma_f32_32x32x16_bf16 v[16:31], v[88:91], v[96:99], v[16:31]
    ds_read_b64_tr_b16 v[84:85], v73 offset:0
    ds_read_b64_tr_b16 v[86:87], v73 offset:1024
    s_waitcnt lgkmcnt(10)
    v_mfma_f32_32x32x16_bf16 v[0:15], v[100:103], v[104:107], v[0:15]
    ds_read_b128 v[88:91], v69 offset:8192
    ds_read_b64_tr_b16 v[92:93], v72 offset:4096
    ds_read_b64_tr_b16 v[94:95], v72 offset:5120
    v_mfma_f32_32x32x16_bf16 v[16:31], v[100:103], v[108:111], v[16:31]
    ds_read_b64_tr_b16 v[96:97], v73 offset:4096
    ds_read_b64_tr_b16 v[98:99], v73 offset:5120
    s_waitcnt lgkmcnt(10)
    v_mfma_f32_32x32x16_bf16 v[0:15], v[112:115], v[116:119], v[0:15]
    ds_read_b128 v[100:103], v70 offset:8192
    ds_read_b64_tr_b16 v[104:105], v72 offset:8192
    ds_read_b64_tr_b16 v[106:107], v72 offset:9216
    v_mfma_f32_32x32x16_bf16 v[16:31], v[112:115], v[120:123], v[16:31]
    ds_read_b64_tr_b16 v[108:109], v73 offset:8192
    ds_read_b64_tr_b16 v[110:111], v73 offset:9216
    s_cmp_ge_u32 s32, 12
    s_cbranch_scc1 k1_dft
    s_lshl_b32 s38, s30, 12
    v_add_u32 v180, s38, v189
    s_waitcnt lgkmcnt(10)
    v_mfma_f32_32x32x16_bf16 v[32:47], v[76:79], v[80:83], 0
    ds_read_b128 v[112:115], v71 offset:8192
    ds_read_b64_tr_b16 v[116:117], v72 offset:12288
    ds_read_b64_tr_b16 v[118:119], v72 offset:13312
    v_mfma_f32_32x32x16_bf16 v[48:63], v[76:79], v[84:87], 0
    ds_read_b64_tr_b16 v[120:121], v73 offset:12288
    ds_read_b64_tr_b16 v[122:123], v73 offset:13312
    s_waitcnt lgkmcnt(10)
    s_barrier
    v_mfma_f32_32x32x16_bf16 v[32:47], v[88:91], v[92:95], v[32:47]
    ds_read_b128 v[76:79], v68 offset:16384
    ds_read_b64_tr_b16 v[80:81], v72 offset:16384
    ds_read_b64_tr_b16 v[82:83], v72 offset:17408
    v_mfma_f32_32x32x16_bf16 v[48:63], v[88:91], v[96:99], v[48:63]
    ds_read_b64_tr_b16 v[84:85], v73 offset:16384
    ds_read_b64_tr_b16 v[86:87], v73 offset:17408
    s_waitcnt lgkmcnt(10)
    v_mfma_f32_32x32x16_bf16 v[32:47], v[100:103], v[104:107], v[32:47]
    v_cvt_pk_bf16_f32 v192, v0, v1
    v_cvt_pk_bf16_f32 v193, v2, v3
    ds_read_b128 v[88:91], v69 offset:16384
    ds_read_b64_tr_b16 v[92:93], v72 offset:20480
    ds_read_b64_tr_b16 v[94:95], v72 offset:21504
    v_mfma_f32_32x32x16_bf16 v[48:63], v[100:103], v[108:111], v[48:63]
    v_cvt_pk_bf16_f32 v194, v4, v5
    v_cvt_pk_bf16_f32 v195, v6, v7
    ds_read_b64_tr_b16 v[96:97], v73 offset:20480
    ds_read_b64_tr_b16 v[98:99], v73 offset:21504
    s_waitcnt lgkmcnt(10)
    v_mfma_f32_32x32x16_bf16 v[32:47], v[112:115], v[116:119], v[32:47]
    v_cvt_pk_bf16_f32 v196, v8, v9
    v_cvt_pk_bf16_f32 v197, v10, v11
    ds_read_b128 v[100:103], v70 offset:16384
    ds_read_b64_tr_b16 v[104:105], v72 offset:24576
    ds_read_b64_tr_b16 v[106:107], v72 offset:25600
    v_mfma_f32_32x32x16_bf16 v[48:63], v[112:115], v[120:123], v[48:63]
    v_cvt_pk_bf16_f32 v198, v12, v13
    v_cvt_pk_bf16_f32 v199, v14, v15
    ds_read_b64_tr_b16 v[108:109], v73 offset:24576
    ds_read_b64_tr_b16 v[110:111], v73 offset:25600
    s_waitcnt lgkmcnt(10)
    v_mfma_f32_32x32x16_bf16 v[32:47], v[76:79], v[80:83], v[32:47]
    v_cndmask_b32 v192, v192, v178, vcc
    ds_read_b128 v[112:115], v71 offset:16384
    ds_read_b64_tr_b16 v[116:117], v72 offset:28672
    ds_read_b64_tr_b16 v[118:119], v72 offset:29696
    v_mfma_f32_32x32x16_bf16 v[48:63], v[76:79], v[84:87], v[48:63]
    v_cndmask_b32 v193, v193, v178, vcc
    v_cndmask_b32 v194, v194, v178, vcc
    ds_read_b64_tr_b16 v[120:121], v73 offset:28672
    ds_read_b64_tr_b16 v[122:123], v73 offset:29696
    s_waitcnt lgkmcnt(10)
    s_barrier
    v_mfma_f32_32x32x16_bf16 v[32:47], v[88:91], v[92:95], v[32:47]
    v_cndmask_b32 v195, v195, v178, vcc
    v_cndmask_b32 v196, v196, v178, vcc
    ds_read_b128 v[76:79], v68 offset:24576
    ds_read_b64_tr_b16 v[80:81], v72 offset:32768
    ds_read_b64_tr_b16 v[82:83], v72 offset:33792
    v_mfma_f32_32x32x16_bf16 v[48:63], v[88:91], v[96:99], v[48:63]
    v_cndmask_b32 v197, v197, v178, vcc
    v_cndmask_b32 v198, v198, v178, vcc
    ds_read_b64_tr_b16 v[84:85], v73 offset:32768
    ds_read_b64_tr_b16 v[86:87], v73 offset:33792
    s_waitcnt lgkmcnt(10)
    v_mfma_f32_32x32x16_bf16 v[32:47], v[100:103], v[104:107], v[32:47]
    v_cndmask_b32 v199, v199, v178, vcc
    v_cvt_pk_bf16_f32 v200, v16, v17
    ds_read_b128 v[88:91], v69 offset:24576
    ds_read_b64_tr_b16 v[92:93], v72 offset:36864
    ds_read_b64_tr_b16 v[94:95], v72 offset:37888
    v_mfma_f32_32x32x16_bf16 v[48:63], v[100:103], v[108:111], v[48:63]
    v_cvt_pk_bf16_f32 v201, v18, v19
    ds_read_b64_tr_b16 v[96:97], v73 offset:36864
    ds_read_b64_tr_b16 v[98:99], v73 offset:37888
    s_waitcnt lgkmcnt(10)
    v_mfma_f32_32x32x16_bf16 v[32:47], v[112:115], v[116:119], v[32:47]
    v_cvt_pk_bf16_f32 v202, v20, v21
    v_cvt_pk_bf16_f32 v203, v22, v23
    ds_read_b128 v[100:103], v70 offset:24576
    ds_read_b64_tr_b16 v[104:105], v72 offset:40960
    ds_read_b64_tr_b16 v[106:107], v72 offset:41984
    v_mfma_f32_32x32x16_bf16 v[48:63], v[112:115], v[120:123], v[48:63]
    v_cvt_pk_bf16_f32 v204, v24, v25
    v_cvt_pk_bf16_f32 v205, v26, v27
    ds_read_b64_tr_b16 v[108:109], v73 offset:40960
    ds_read_b64_tr_b16 v[110:111], v73 offset:41984
    s_waitcnt lgkmcnt(10)
    v_mfma_f32_32x32x16_bf16 v[32:47], v[76:79], v[80:83], v[32:47]
    v_cvt_pk_bf16_f32 v206, v28, v29
    v_cvt_pk_bf16_f32 v207, v30, v31
    ds_read_b128 v[112:115], v71 offset:24576
    ds_read_b64_tr_b16 v[116:117], v72 offset:45056
    ds_read_b64_tr_b16 v[118:119], v72 offset:46080
    v_mfma_f32_32x32x16_bf16 v[48:63], v[76:79], v[84:87], v[48:63]
    v_cndmask_b32 v200, v200, v178, vcc
    v_cndmask_b32 v201, v201, v178, vcc
    ds_read_b64_tr_b16 v[120:121], v73 offset:45056
    ds_read_b64_tr_b16 v[122:123], v73 offset:46080
    s_waitcnt lgkmcnt(10)
    s_barrier
    v_mfma_f32_32x32x16_bf16 v[32:47], v[88:91], v[92:95], v[32:47]
    v_cndmask_b32 v202, v202, v178, vcc
    ds_read_b128 v[76:79], v68 offset:32768
    ds_read_b64_tr_b16 v[80:81], v72 offset:49152
    ds_read_b64_tr_b16 v[82:83], v72 offset:50176
    v_mfma_f32_32x32x16_bf16 v[48:63], v[88:91], v[96:99], v[48:63]
    v_cndmask_b32 v203, v203, v178, vcc
    v_cndmask_b32 v204, v204, v178, vcc
    ds_read_b64_tr_b16 v[84:85], v73 offset:49152
    ds_read_b64_tr_b16 v[86:87], v73 offset:50176
    s_waitcnt lgkmcnt(10)
    v_mfma_f32_32x32x16_bf16 v[32:47], v[100:103], v[104:107], v[32:47]
    v_cndmask_b32 v205, v205, v178, vcc
    v_cndmask_b32 v206, v206, v178, vcc
    ds_read_b128 v[88:91], v69 offset:32768
    ds_read_b64_tr_b16 v[92:93], v72 offset:53248
    ds_read_b64_tr_b16 v[94:95], v72 offset:54272
    v_mfma_f32_32x32x16_bf16 v[48:63], v[100:103], v[108:111], v[48:63]
    v_cndmask_b32 v207, v207, v178, vcc
    ds_write_b128 v180, v[192:195] offset:0
    ds_read_b64_tr_b16 v[96:97], v73 offset:53248
    ds_read_b64_tr_b16 v[98:99], v73 offset:54272
    s_waitcnt lgkmcnt(10)
    v_mfma_f32_32x32x16_bf16 v[32:47], v[112:115], v[116:119], v[32:47]
    ds_write_b128 v180, v[196:199] offset:1024
    ds_write_b128 v180, v[200:203] offset:2048
    ds_read_b128 v[100:103], v70 offset:32768
    ds_read_b64_tr_b16 v[104:105], v72 offset:57344
    ds_read_b64_tr_b16 v[106:107], v72 offset:58368
    v_mfma_f32_32x32x16_bf16 v[48:63], v[112:115], v[120:123], v[48:63]
    ds_write_b128 v180, v[204:207] offset:3072
    ds_read_b64_tr_b16 v[108:109], v73 offset:57344
    ds_read_b64_tr_b16 v[110:111], v73 offset:58368
    s_waitcnt lgkmcnt(10)
    v_mfma_f32_32x32x16_bf16 v[32:47], v[76:79], v[80:83], v[32:47]
    ds_read_b128 v[112:115], v71 offset:32768
    ds_read_b64_tr_b16 v[116:117], v72 offset:61440
    ds_read_b64_tr_b16 v[118:119], v72 offset:62464
    v_mfma_f32_32x32x16_bf16 v[48:63], v[76:79], v[84:87], v[48:63]
    ds_read_b64_tr_b16 v[120:121], v73 offset:61440
    ds_read_b64_tr_b16 v[122:123], v73 offset:62464
    s_waitcnt lgkmcnt(10)
    s_waitcnt lgkmcnt(5)
    s_barrier
    v_mfma_f32_32x32x16_bf16 v[32:47], v[88:91], v[92:95], v[32:47]
    ds_read_b128 v[76:79], v68 offset:40960
    ds_read_b64_tr_b16 v[80:81], v74 offset:0
    ds_read_b64_tr_b16 v[82:83], v74 offset:1024
    v_mfma_f32_32x32x16_bf16 v[48:63], v[88:91], v[96:99], v[48:63]
    ds_read_b64_tr_b16 v[84:85], v75 offset:0
    ds_read_b64_tr_b16 v[86:87], v75 offset:1024
    s_waitcnt lgkmcnt(10)
    v_mfma_f32_32x32x16_bf16 v[32:47], v[100:103], v[104:107], v[32:47]
    ds_read_b128 v[88:91], v69 offset:40960
    ds_read_b64_tr_b16 v[92:93], v74 offset:4096
    ds_read_b64_tr_b16 v[94:95], v74 offset:5120
    v_mfma_f32_32x32x16_bf16 v[48:63], v[100:103], v[108:111], v[48:63]
    ds_read_b64_tr_b16 v[96:97], v75 offset:4096
    ds_read_b64_tr_b16 v[98:99], v75 offset:5120
    s_waitcnt lgkmcnt(10)
    v_mfma_f32_32x32x16_bf16 v[32:47], v[112:115], v[116:119], v[32:47]
    ds_read_b128 v[100:103], v70 offset:40960
    ds_read_b64_tr_b16 v[104:105], v74 offset:8192
    ds_read_b64_tr_b16 v[106:107], v74 offset:9216
    v_mfma_f32_32x32x16_bf16 v[48:63], v[112:115], v[120:123], v[48:63]
    ds_read_b64_tr_b16 v[108:109], v75 offset:8192
    ds_read_b64_tr_b16 v[110:111], v75 offset:9216
    s_waitcnt lgkmcnt(10)
    v_mfma_f32_32x32x16_bf16 v[32:47], v[76:79], v[80:83], v[32:47]
    ds_read_b128 v[112:115], v71 offset:40960
    ds_read_b64_tr_b16 v[116:117], v74 offset:12288
    ds_read_b64_tr_b16 v[118:119], v74 offset:13312
    v_mfma_f32_32x32x16_bf16 v[48:63], v[76:79], v[84:87], v[48:63]
    ds_read_b64_tr_b16 v[120:121], v75 offset:12288
    ds_read_b64_tr_b16 v[122:123], v75 offset:13312
    s_waitcnt lgkmcnt(10)
    v_mfma_f32_32x32x16_bf16 v[32:47], v[88:91], v[92:95], v[32:47]
    ds_read_b128 v[76:79], v68 offset:0
    ds_read_b64_tr_b16 v[80:81], v74 offset:16384
    ds_read_b64_tr_b16 v[82:83], v74 offset:17408
    v_mfma_f32_32x32x16_bf16 v[48:63], v[88:91], v[96:99], v[48:63]
    ds_read_b64_tr_b16 v[84:85], v75 offset:16384
    ds_read_b64_tr_b16 v[86:87], v75 offset:17408
    s_waitcnt lgkmcnt(10)
    v_mfma_f32_32x32x16_bf16 v[32:47], v[100:103], v[104:107], v[32:47]
    ds_read_b128 v[88:91], v69 offset:0
    ds_read_b64_tr_b16 v[92:93], v74 offset:20480
    ds_read_b64_tr_b16 v[94:95], v74 offset:21504
    v_mfma_f32_32x32x16_bf16 v[48:63], v[100:103], v[108:111], v[48:63]
    ds_read_b64_tr_b16 v[96:97], v75 offset:20480
    ds_read_b64_tr_b16 v[98:99], v75 offset:21504
    s_waitcnt lgkmcnt(10)
    v_mfma_f32_32x32x16_bf16 v[32:47], v[112:115], v[116:119], v[32:47]
    ds_read_b128 v[100:103], v70 offset:0
    ds_read_b64_tr_b16 v[104:105], v74 offset:24576
    ds_read_b64_tr_b16 v[106:107], v74 offset:25600
    v_mfma_f32_32x32x16_bf16 v[48:63], v[112:115], v[120:123], v[48:63]
    ds_read_b64_tr_b16 v[108:109], v75 offset:24576
    ds_read_b64_tr_b16 v[110:111], v75 offset:25600
    s_waitcnt lgkmcnt(10)
    v_mfma_f32_32x32x16_bf16 v[32:47], v[76:79], v[80:83], v[32:47]
    ds_read_b128 v[112:115], v71 offset:0
    ds_read_b64_tr_b16 v[116:117], v74 offset:28672
    ds_read_b64_tr_b16 v[118:119], v74 offset:29696
    v_mfma_f32_32x32x16_bf16 v[48:63], v[76:79], v[84:87], v[48:63]
    ds_read_b64_tr_b16 v[120:121], v75 offset:28672
    ds_read_b64_tr_b16 v[122:123], v75 offset:29696
    s_waitcnt lgkmcnt(10)
    v_mfma_f32_32x32x16_bf16 v[32:47], v[88:91], v[92:95], v[32:47]
    ds_read_b128 v[76:79], v68 offset:8192
    ds_read_b64_tr_b16 v[80:81], v74 offset:32768
    ds_read_b64_tr_b16 v[82:83], v74 offset:33792
    v_mfma_f32_32x32x16_bf16 v[48:63], v[88:91], v[96:99], v[48:63]
    ds_read_b64_tr_b16 v[84:85], v75 offset:32768
    ds_read_b64_tr_b16 v[86:87], v75 offset:33792
    s_waitcnt lgkmcnt(10)
    v_mfma_f32_32x32x16_bf16 v[32:47], v[100:103], v[104:107], v[32:47]
    ds_read_b128 v[88:91], v69 offset:8192
    ds_read_b64_tr_b16 v[92:93], v74 offset:36864
    ds_read_b64_tr_b16 v[94:95], v74 offset:37888
    v_mfma_f32_32x32x16_bf16 v[48:63], v[100:103], v[108:111], v[48:63]
    ds_read_b64_tr_b16 v[96:97], v75 offset:36864
    ds_read_b64_tr_b16 v[98:99], v75 offset:37888
    s_waitcnt lgkmcnt(10)
    v_mfma_f32_32x32x16_bf16 v[32:47], v[112:115], v[116:119], v[32:47]
    ds_read_b128 v[100:103], v70 offset:8192
    ds_read_b64_tr_b16 v[104:105], v74 offset:40960
    ds_read_b64_tr_b16 v[106:107], v74 offset:41984
    v_mfma_f32_32x32x16_bf16 v[48:63], v[112:115], v[120:123], v[48:63]
    ds_read_b64_tr_b16 v[108:109], v75 offset:40960
    ds_read_b64_tr_b16 v[110:111], v75 offset:41984
    s_waitcnt lgkmcnt(10)
    v_mfma_f32_32x32x16_bf16 v[32:47], v[76:79], v[80:83], v[32:47]
    ds_read_b128 v[112:115], v71 offset:8192
    ds_read_b64_tr_b16 v[116:117], v74 offset:45056
    ds_read_b64_tr_b16 v[118:119], v74 offset:46080
    v_mfma_f32_32x32x16_bf16 v[48:63], v[76:79], v[84:87], v[48:63]
    ds_read_b64_tr_b16 v[120:121], v75 offset:45056
    ds_read_b64_tr_b16 v[122:123], v75 offset:46080
    s_waitcnt lgkmcnt(10)
    v_mfma_f32_32x32x16_bf16 v[32:47], v[88:91], v[92:95], v[32:47]
    v_mfma_f32_32x32x16_bf16 v[48:63], v[88:91], v[96:99], v[48:63]
    s_waitcnt lgkmcnt(5)
    v_mfma_f32_32x32x16_bf16 v[32:47], v[100:103], v[104:107], v[32:47]
    v_mfma_f32_32x32x16_bf16 v[48:63], v[100:103], v[108:111], v[48:63]
    s_waitcnt lgkmcnt(0)
    v_mfma_f32_32x32x16_bf16 v[32:47], v[112:115], v[116:119], v[32:47]
    v_mfma_f32_32x32x16_bf16 v[48:63], v[112:115], v[120:123], v[48:63]
    s_nop 10
    v_cvt_pk_bf16_f32 v208, v32, v33
    v_cvt_pk_bf16_f32 v209, v34, v35
    v_cvt_pk_bf16_f32 v210, v36, v37
    v_cvt_pk_bf16_f32 v211, v38, v39
    v_cvt_pk_bf16_f32 v212, v40, v41
    v_cvt_pk_bf16_f32 v213, v42, v43
    v_cvt_pk_bf16_f32 v214, v44, v45
    v_cvt_pk_bf16_f32 v215, v46, v47
    v_cndmask_b32 v208, v208, v178, vcc
    v_cndmask_b32 v209, v209, v178, vcc
    v_cndmask_b32 v210, v210, v178, vcc
    v_cndmask_b32 v211, v211, v178, vcc
    v_cndmask_b32 v212, v212, v178, vcc
    v_cndmask_b32 v213, v213, v178, vcc
    v_cndmask_b32 v214, v214, v178, vcc
    v_cndmask_b32 v215, v215, v178, vcc
    buffer_store_dwordx4 v[208:211], v189, s[16:19], s35 offen offset:0 sc1
    buffer_store_dwordx4 v[212:215], v189, s[16:19], s35 offen offset:1024 sc1
    v_cvt_pk_bf16_f32 v216, v48, v49
    v_cvt_pk_bf16_f32 v217, v50, v51
    v_cvt_pk_bf16_f32 v218, v52, v53
    v_cvt_pk_bf16_f32 v219, v54, v55
    v_cvt_pk_bf16_f32 v220, v56, v57
    v_cvt_pk_bf16_f32 v221, v58, v59
    v_cvt_pk_bf16_f32 v222, v60, v61
    v_cvt_pk_bf16_f32 v223, v62, v63
    v_cndmask_b32 v216, v216, v178, vcc
    v_cndmask_b32 v217, v217, v178, vcc
    v_cndmask_b32 v218, v218, v178, vcc
    v_cndmask_b32 v219, v219, v178, vcc
    v_cndmask_b32 v220, v220, v178, vcc
    v_cndmask_b32 v221, v221, v178, vcc
    v_cndmask_b32 v222, v222, v178, vcc
    v_cndmask_b32 v223, v223, v178, vcc
    s_add_u32 s35, s35, 131072
    buffer_store_dwordx4 v[216:219], v189, s[16:19], s35 offen offset:0 sc1
    buffer_store_dwordx4 v[220:223], v189, s[16:19], s35 offen offset:1024 sc1
    s_branch k1_pf
k1_dft:
    s_cmp_eq_u32 s33, 31
    s_cselect_b64 s[54:55], 0xff, -1
    s_cselect_b64 s[56:57], 0xff, -1
    s_lshl_b32 s39, s30, 12
    v_lshlrev_b32 v172, 6, v172
    v_lshl_add_u32 v172, v173, 4, v172
    v_add_u32 v172, s39, v172
    v_add_u32 v174, s39, v189
    v_lshlrev_b32 v175, 4, v173
    s_waitcnt lgkmcnt(10)
    v_mfma_f32_32x32x16_bf16 v[32:47], v[76:79], v[80:83], 0
    ds_read_b128 v[112:115], v71 offset:8192
    ds_read_b64_tr_b16 v[116:117], v72 offset:12288
    ds_read_b64_tr_b16 v[118:119], v72 offset:13312
    v_mfma_f32_32x32x16_bf16 v[48:63], v[76:79], v[84:87], 0
    ds_read_b64_tr_b16 v[120:121], v73 offset:12288
    ds_read_b64_tr_b16 v[122:123], v73 offset:13312
    s_waitcnt lgkmcnt(10)
    s_barrier
    v_mfma_f32_32x32x16_bf16 v[32:47], v[88:91], v[92:95], v[32:47]
    ds_read_b128 v[76:79], v68 offset:16384
    ds_read_b64_tr_b16 v[80:81], v72 offset:16384
    ds_read_b64_tr_b16 v[82:83], v72 offset:17408
    v_mfma_f32_32x32x16_bf16 v[48:63], v[88:91], v[96:99], v[48:63]
    ds_read_b64_tr_b16 v[84:85], v73 offset:16384
    ds_read_b64_tr_b16 v[86:87], v73 offset:17408
    s_waitcnt lgkmcnt(10)
    v_mfma_f32_32x32x16_bf16 v[32:47], v[100:103], v[104:107], v[32:47]
    v_cvt_pk_bf16_f32 v192, v0, v1
    v_cvt_pk_bf16_f32 v193, v2, v3
    v_cvt_pk_bf16_f32 v194, v4, v5
    v_cvt_pk_bf16_f32 v195, v6, v7
    ds_read_b128 v[88:91], v69 offset:16384
    ds_read_b64_tr_b16 v[92:93], v72 offset:20480
    ds_read_b64_tr_b16 v[94:95], v72 offset:21504
    v_mfma_f32_32x32x16_bf16 v[48:63], v[100:103], v[108:111], v[48:63]
    v_cvt_pk_bf16_f32 v196, v8, v9
    v_cvt_pk_bf16_f32 v197, v10, v11
    v_cvt_pk_bf16_f32 v198, v12, v13
    ds_read_b64_tr_b16 v[96:97], v73 offset:20480
    ds_read_b64_tr_b16 v[98:99], v73 offset:21504
    s_waitcnt lgkmcnt(10)
    v_mfma_f32_32x32x16_bf16 v[32:47], v[112:115], v[116:119], v[32:47]
    v_cvt_pk_bf16_f32 v199, v14, v15
    v_cvt_pk_bf16_f32 v200, v16, v17
    v_cvt_pk_bf16_f32 v201, v18, v19
    ds_read_b128 v[100:103], v70 offset:16384
    ds_read_b64_tr_b16 v[104:105], v72 offset:24576
    ds_read_b64_tr_b16 v[106:107], v72 offset:25600
    v_mfma_f32_32x32x16_bf16 v[48:63], v[112:115], v[120:123], v[48:63]
    v_cvt_pk_bf16_f32 v202, v20, v21
    v_cvt_pk_bf16_f32 v203, v22, v23
    v_cvt_pk_bf16_f32 v204, v24, v25
    ds_read_b64_tr_b16 v[108:109], v73 offset:24576
    ds_read_b64_tr_b16 v[110:111], v73 offset:25600
    s_waitcnt lgkmcnt(10)
    v_mfma_f32_32x32x16_bf16 v[32:47], v[76:79], v[80:83], v[32:47]
    v_cvt_pk_bf16_f32 v205, v26, v27
    v_cvt_pk_bf16_f32 v206, v28, v29
    v_cvt_pk_bf16_f32 v207, v30, v31
    ds_read_b128 v[112:115], v71 offset:16384
    ds_read_b64_tr_b16 v[116:117], v72 offset:28672
    ds_read_b64_tr_b16 v[118:119], v72 offset:29696
    v_mfma_f32_32x32x16_bf16 v[48:63], v[76:79], v[84:87], v[48:63]
    s_cmp_lg_u32 s33, 31
    s_cbranch_scc1 k1_ngs0
    v_mov_b32 v228, v16
    v_mov_b32 v229, v17
    v_mov_b32 v230, v18
    v_mov_b32 v231, v19
    v_mov_b32 v232, v20
    v_mov_b32 v233, v21
    v_mov_b32 v234, v22
    v_mov_b32 v235, v23
    v_mov_b32 v236, v24
    v_mov_b32 v237, v25
    v_mov_b32 v238, v26
    v_mov_b32 v239, v27
    v_mov_b32 v240, v28
    v_mov_b32 v241, v29
    v_mov_b32 v242, v30
    v_mov_b32 v243, v31
    v_mov_b32 v200, 0
    v_mov_b32 v201, 0
    v_mov_b32 v202, 0
    v_mov_b32 v203, 0
    v_mov_b32 v204, 0
    v_mov_b32 v205, 0
    v_mov_b32 v206, 0
    v_mov_b32 v207, 0
    s_nop 1
k1_ngs0:
    v_mfma_f32_32x32x16_bf16 v[0:15], v[124:127], v[192:195], 0
    v_mfma_f32_32x32x16_bf16 v[0:15], v[128:131], v[196:199], v[0:15]
    ds_read_b64_tr_b16 v[120:121], v73 offset:28672
    ds_read_b64_tr_b16 v[122:123], v73 offset:29696
    s_waitcnt lgkmcnt(10)
    s_barrier
    v_mfma_f32_32x32x16_bf16 v[32:47], v[88:91], v[92:95], v[32:47]
    v_mfma_f32_32x32x16_bf16 v[0:15], v[132:135], v[200:203], v[0:15]
    v_mfma_f32_32x32x16_bf16 v[0:15], v[136:139], v[204:207], v[0:15]
    v_mfma_f32_32x32x16_bf16 v[16:31], v[124:127], v[200:203], 0
    ds_read_b128 v[76:79], v68 offset:24576
    ds_read_b64_tr_b16 v[80:81], v72 offset:32768
    ds_read_b64_tr_b16 v[82:83], v72 offset:33792
    v_mfma_f32_32x32x16_bf16 v[48:63], v[88:91], v[96:99], v[48:63]
    v_mfma_f32_32x32x16_bf16 v[16:31], v[128:131], v[204:207], v[16:31]
    v_mfma_f32_32x32x16_bf16 v[16:31], v[140:143], v[192:195], v[16:31]
    v_mfma_f32_32x32x16_bf16 v[16:31], v[144:147], v[196:199], v[16:31]
    ds_read_b64_tr_b16 v[84:85], v73 offset:32768
    ds_read_b64_tr_b16 v[86:87], v73 offset:33792
    s_waitcnt lgkmcnt(10)
    v_mfma_f32_32x32x16_bf16 v[32:47], v[100:103], v[104:107], v[32:47]
    s_nop 0
    s_nop 0
    s_nop 0
    ds_read_b128 v[88:91], v69 offset:24576
    ds_read_b64_tr_b16 v[92:93], v72 offset:36864
    ds_read_b64_tr_b16 v[94:95], v72 offset:37888
    v_mfma_f32_32x32x16_bf16 v[48:63], v[100:103], v[108:111], v[48:63]
    s_nop 0
    s_nop 0
    s_nop 0
    ds_read_b64_tr_b16 v[96:97], v73 offset:36864
    ds_read_b64_tr_b16 v[98:99], v73 offset:37888
    s_waitcnt lgkmcnt(10)
    v_mfma_f32_32x32x16_bf16 v[32:47], v[112:115], v[116:119], v[32:47]
    v_cvt_pk_bf16_f32 v208, v0, v1
    v_cvt_pk_bf16_f32 v209, v2, v3
    v_cvt_pk_bf16_f32 v210, v4, v5
    v_cvt_pk_bf16_f32 v211, v6, v7
    ds_read_b128 v[100:103], v70 offset:24576
    ds_read_b64_tr_b16 v[104:105], v72 offset:40960
    ds_read_b64_tr_b16 v[106:107], v72 offset:41984
    v_mfma_f32_32x32x16_bf16 v[48:63], v[112:115], v[120:123], v[48:63]
    v_cvt_pk_bf16_f32 v212, v8, v9
    v_cvt_pk_bf16_f32 v213, v10, v11
    v_cvt_pk_bf16_f32 v214, v12, v13
    ds_read_b64_tr_b16 v[108:109], v73 offset:40960
    ds_read_b64_tr_b16 v[110:111], v73 offset:41984
    s_waitcnt lgkmcnt(10)
    v_mfma_f32_32x32x16_bf16 v[32:47], v[76:79], v[80:83], v[32:47]
    v_cvt_pk_bf16_f32 v215, v14, v15
    s_nop 0
    v_permlane32_swap_b32 v208, v210
    ds_read_b128 v[112:115], v71 offset:24576
    ds_read_b64_tr_b16 v[116:117], v72 offset:45056
    ds_read_b64_tr_b16 v[118:119], v72 offset:46080
    v_mfma_f32_32x32x16_bf16 v[48:63], v[76:79], v[84:87], v[48:63]
    v_permlane32_swap_b32 v209, v211
    v_permlane32_swap_b32 v212, v214
    v_permlane32_swap_b32 v213, v215
    ds_read_b64_tr_b16 v[120:121], v73 offset:45056
    ds_read_b64_tr_b16 v[122:123], v73 offset:46080
    s_waitcnt lgkmcnt(10)
    s_barrier
    v_mfma_f32_32x32x16_bf16 v[32:47], v[88:91], v[92:95], v[32:47]
    ds_write_b128 v172, v[208:211] offset:0
    ds_write_b128 v172, v[212:215] offset:32
    s_cmp_lg_u32 s33, 31
    s_cbranch_scc1 k1_ngw0
    s_mov_b32 exec_lo, 1
    s_mov_b32 exec_hi, 1
    ds_write_b128 v172, v[228:231] offset:1024
    ds_write_b128 v172, v[232:235] offset:1056
    ds_write_b128 v172, v[236:239] offset:1088
    ds_write_b128 v172, v[240:243] offset:1120
    s_mov_b64 exec, -1
k1_ngw0:
    ds_read_b128 v[76:79], v68 offset:32768
    ds_read_b64_tr_b16 v[80:81], v72 offset:49152
    ds_read_b64_tr_b16 v[82:83], v72 offset:50176
    v_mfma_f32_32x32x16_bf16 v[48:63], v[88:91], v[96:99], v[48:63]
    v_cvt_pk_bf16_f32 v216, v16, v17
    v_cvt_pk_bf16_f32 v217, v18, v19
    v_cvt_pk_bf16_f32 v218, v20, v21
    ds_read_b64_tr_b16 v[84:85], v73 offset:49152
    ds_read_b64_tr_b16 v[86:87], v73 offset:50176
    s_waitcnt lgkmcnt(10)
    v_mfma_f32_32x32x16_bf16 v[32:47], v[100:103], v[104:107], v[32:47]
    v_cvt_pk_bf16_f32 v219, v22, v23
    v_cvt_pk_bf16_f32 v220, v24, v25
    v_cvt_pk_bf16_f32 v221, v26, v27
    ds_read_b128 v[88:91], v69 offset:32768
    ds_read_b64_tr_b16 v[92:93], v72 offset:53248
    ds_read_b64_tr_b16 v[94:95], v72 offset:54272
    v_mfma_f32_32x32x16_bf16 v[48:63], v[100:103], v[108:111], v[48:63]
    v_cvt_pk_bf16_f32 v222, v28, v29
    v_cvt_pk_bf16_f32 v223, v30, v31
    s_nop 0
    ds_read_b64_tr_b16 v[96:97], v73 offset:53248
    ds_read_b64_tr_b16 v[98:99], v73 offset:54272
    s_waitcnt lgkmcnt(10)
    v_mfma_f32_32x32x16_bf16 v[32:47], v[112:115], v[116:119], v[32:47]
    v_permlane32_swap_b32 v216, v218
    v_permlane32_swap_b32 v217, v219
    v_permlane32_swap_b32 v220, v222
    ds_read_b128 v[100:103], v70 offset:32768
    ds_read_b64_tr_b16 v[104:105], v72 offset:57344
    ds_read_b64_tr_b16 v[106:107], v72 offset:58368
    v_mfma_f32_32x32x16_bf16 v[48:63], v[112:115], v[120:123], v[48:63]
    v_permlane32_swap_b32 v221, v223
    ds_write_b128 v172, v[216:219] offset:2048
    ds_write_b128 v172, v[220:223] offset:2080
    ds_read_b64_tr_b16 v[108:109], v73 offset:57344
    ds_read_b64_tr_b16 v[110:111], v73 offset:58368
    s_waitcnt lgkmcnt(10)
    v_mfma_f32_32x32x16_bf16 v[32:47], v[76:79], v[80:83], v[32:47]
    ds_read_b128 v[112:115], v71 offset:32768
    ds_read_b64_tr_b16 v[116:117], v72 offset:61440
    ds_read_b64_tr_b16 v[118:119], v72 offset:62464
    v_mfma_f32_32x32x16_bf16 v[48:63], v[76:79], v[84:87], v[48:63]
    ds_read_b64_tr_b16 v[120:121], v73 offset:61440
    ds_read_b64_tr_b16 v[122:123], v73 offset:62464
    s_waitcnt lgkmcnt(10)
    s_waitcnt lgkmcnt(5)
    s_barrier
    v_mfma_f32_32x32x16_bf16 v[32:47], v[88:91], v[92:95], v[32:47]
    ds_read_b128 v[76:79], v68 offset:40960
    ds_read_b64_tr_b16 v[80:81], v74 offset:0
    ds_read_b64_tr_b16 v[82:83], v74 offset:1024
    v_mfma_f32_32x32x16_bf16 v[48:63], v[88:91], v[96:99], v[48:63]
    ds_read_b64_tr_b16 v[84:85], v75 offset:0
    ds_read_b64_tr_b16 v[86:87], v75 offset:1024
    s_waitcnt lgkmcnt(10)
    v_mfma_f32_32x32x16_bf16 v[32:47], v[100:103], v[104:107], v[32:47]
    ds_read_b128 v[88:91], v69 offset:40960
    ds_read_b64_tr_b16 v[92:93], v74 offset:4096
    ds_read_b64_tr_b16 v[94:95], v74 offset:5120
    v_mfma_f32_32x32x16_bf16 v[48:63], v[100:103], v[108:111], v[48:63]
    ds_read_b64_tr_b16 v[96:97], v75 offset:4096
    ds_read_b64_tr_b16 v[98:99], v75 offset:5120
    s_waitcnt lgkmcnt(10)
    v_mfma_f32_32x32x16_bf16 v[32:47], v[112:115], v[116:119], v[32:47]
    ds_read_b128 v[100:103], v70 offset:40960
    ds_read_b64_tr_b16 v[104:105], v74 offset:8192
    ds_read_b64_tr_b16 v[106:107], v74 offset:9216
    v_mfma_f32_32x32x16_bf16 v[48:63], v[112:115], v[120:123], v[48:63]
    ds_read_b64_tr_b16 v[108:109], v75 offset:8192
    ds_read_b64_tr_b16 v[110:111], v75 offset:9216
    s_waitcnt lgkmcnt(10)
    v_mfma_f32_32x32x16_bf16 v[32:47], v[76:79], v[80:83], v[32:47]
    ds_read_b128 v[112:115], v71 offset:40960
    ds_read_b64_tr_b16 v[116:117], v74 offset:12288
    ds_read_b64_tr_b16 v[118:119], v74 offset:13312
    v_mfma_f32_32x32x16_bf16 v[48:63], v[76:79], v[84:87], v[48:63]
    ds_read_b64_tr_b16 v[120:121], v75 offset:12288
    ds_read_b64_tr_b16 v[122:123], v75 offset:13312
    s_waitcnt lgkmcnt(10)
    v_mfma_f32_32x32x16_bf16 v[32:47], v[88:91], v[92:95], v[32:47]
    ds_read_b128 v[76:79], v68 offset:0
    ds_read_b64_tr_b16 v[80:81], v74 offset:16384
    ds_read_b64_tr_b16 v[82:83], v74 offset:17408
    v_mfma_f32_32x32x16_bf16 v[48:63], v[88:91], v[96:99], v[48:63]
    ds_read_b64_tr_b16 v[84:85], v75 offset:16384
    ds_read_b64_tr_b16 v[86:87], v75 offset:17408
    s_waitcnt lgkmcnt(10)
    v_mfma_f32_32x32x16_bf16 v[32:47], v[100:103], v[104:107], v[32:47]
    ds_read_b128 v[88:91], v69 offset:0
    ds_read_b64_tr_b16 v[92:93], v74 offset:20480
    ds_read_b64_tr_b16 v[94:95], v74 offset:21504
    v_mfma_f32_32x32x16_bf16 v[48:63], v[100:103], v[108:111], v[48:63]
    ds_read_b64_tr_b16 v[96:97], v75 offset:20480
    ds_read_b64_tr_b16 v[98:99], v75 offset:21504
    s_waitcnt lgkmcnt(10)
    v_mfma_f32_32x32x16_bf16 v[32:47], v[112:115], v[116:119], v[32:47]
    ds_read_b128 v[100:103], v70 offset:0
    ds_read_b64_tr_b16 v[104:105], v74 offset:24576
    ds_read_b64_tr_b16 v[106:107], v74 offset:25600
    v_mfma_f32_32x32x16_bf16 v[48:63], v[112:115], v[120:123], v[48:63]
    ds_read_b64_tr_b16 v[108:109], v75 offset:24576
    ds_read_b64_tr_b16 v[110:111], v75 offset:25600
    s_waitcnt lgkmcnt(10)
    v_mfma_f32_32x32x16_bf16 v[32:47], v[76:79], v[80:83], v[32:47]
    ds_read_b128 v[112:115], v71 offset:0
    ds_read_b64_tr_b16 v[116:117], v74 offset:28672
    ds_read_b64_tr_b16 v[118:119], v74 offset:29696
    v_mfma_f32_32x32x16_bf16 v[48:63], v[76:79], v[84:87], v[48:63]
    ds_read_b64_tr_b16 v[120:121], v75 offset:28672
    ds_read_b64_tr_b16 v[122:123], v75 offset:29696
    s_waitcnt lgkmcnt(10)
    v_mfma_f32_32x32x16_bf16 v[32:47], v[88:91], v[92:95], v[32:47]
    ds_read_b128 v[76:79], v68 offset:8192
    ds_read_b64_tr_b16 v[80:81], v74 offset:32768
    ds_read_b64_tr_b16 v[82:83], v74 offset:33792
    v_mfma_f32_32x32x16_bf16 v[48:63], v[88:91], v[96:99], v[48:63]
    ds_read_b64_tr_b16 v[84:85], v75 offset:32768
    ds_read_b64_tr_b16 v[86:87], v75 offset:33792
    s_waitcnt lgkmcnt(10)
    v_mfma_f32_32x32x16_bf16 v[32:47], v[100:103], v[104:107], v[32:47]
    ds_read_b128 v[88:91], v69 offset:8192
    ds_read_b64_tr_b16 v[92:93], v74 offset:36864
    ds_read_b64_tr_b16 v[94:95], v74 offset:37888
    v_mfma_f32_32x32x16_bf16 v[48:63], v[100:103], v[108:111], v[48:63]
    ds_read_b64_tr_b16 v[96:97], v75 offset:36864
    ds_read_b64_tr_b16 v[98:99], v75 offset:37888
    s_waitcnt lgkmcnt(10)
    v_mfma_f32_32x32x16_bf16 v[32:47], v[112:115], v[116:119], v[32:47]
    ds_read_b128 v[100:103], v70 offset:8192
    ds_read_b64_tr_b16 v[104:105], v74 offset:40960
    ds_read_b64_tr_b16 v[106:107], v74 offset:41984
    v_mfma_f32_32x32x16_bf16 v[48:63], v[112:115], v[120:123], v[48:63]
    ds_read_b64_tr_b16 v[108:109], v75 offset:40960
    ds_read_b64_tr_b16 v[110:111], v75 offset:41984
    s_waitcnt lgkmcnt(10)
    v_mfma_f32_32x32x16_bf16 v[32:47], v[76:79], v[80:83], v[32:47]
    ds_read_b128 v[112:115], v71 offset:8192
    ds_read_b64_tr_b16 v[116:117], v74 offset:45056
    ds_read_b64_tr_b16 v[118:119], v74 offset:46080
    v_mfma_f32_32x32x16_bf16 v[48:63], v[76:79], v[84:87], v[48:63]
    ds_read_b64_tr_b16 v[120:121], v75 offset:45056
    ds_read_b64_tr_b16 v[122:123], v75 offset:46080
    s_waitcnt lgkmcnt(10)
    v_mfma_f32_32x32x16_bf16 v[32:47], v[88:91], v[92:95], v[32:47]
    v_mfma_f32_32x32x16_bf16 v[48:63], v[88:91], v[96:99], v[48:63]
    s_waitcnt lgkmcnt(5)
    v_mfma_f32_32x32x16_bf16 v[32:47], v[100:103], v[104:107], v[32:47]
    v_mfma_f32_32x32x16_bf16 v[48:63], v[100:103], v[108:111], v[48:63]
    s_waitcnt lgkmcnt(0)
    v_mfma_f32_32x32x16_bf16 v[32:47], v[112:115], v[116:119], v[32:47]
    v_mfma_f32_32x32x16_bf16 v[48:63], v[112:115], v[120:123], v[48:63]
    s_nop 10
    v_cvt_pk_bf16_f32 v208, v32, v33
    v_cvt_pk_bf16_f32 v209, v34, v35
    v_cvt_pk_bf16_f32 v210, v36, v37
    v_cvt_pk_bf16_f32 v211, v38, v39
    v_cvt_pk_bf16_f32 v212, v40, v41
    v_cvt_pk_bf16_f32 v213, v42, v43
    v_cvt_pk_bf16_f32 v214, v44, v45
    v_cvt_pk_bf16_f32 v215, v46, v47
    v_cvt_pk_bf16_f32 v216, v48, v49
    v_cvt_pk_bf16_f32 v217, v50, v51
    v_cvt_pk_bf16_f32 v218, v52, v53
    v_cvt_pk_bf16_f32 v219, v54, v55
    v_cvt_pk_bf16_f32 v220, v56, v57
    v_cvt_pk_bf16_f32 v221, v58, v59
    v_cvt_pk_bf16_f32 v222, v60, v61
    v_cvt_pk_bf16_f32 v223, v62, v63
    s_cmp_lg_u32 s33, 31
    s_cbranch_scc1 k1_ngs1
    v_mov_b32 v228, v48
    v_mov_b32 v229, v49
    v_mov_b32 v230, v50
    v_mov_b32 v231, v51
    v_mov_b32 v232, v52
    v_mov_b32 v233, v53
    v_mov_b32 v234, v54
    v_mov_b32 v235, v55
    v_mov_b32 v236, v56
    v_mov_b32 v237, v57
    v_mov_b32 v238, v58
    v_mov_b32 v239, v59
    v_mov_b32 v240, v60
    v_mov_b32 v241, v61
    v_mov_b32 v242, v62
    v_mov_b32 v243, v63
    v_mov_b32 v216, 0
    v_mov_b32 v217, 0
    v_mov_b32 v218, 0
    v_mov_b32 v219, 0
    v_mov_b32 v220, 0
    v_mov_b32 v221, 0
    v_mov_b32 v222, 0
    v_mov_b32 v223, 0
    s_nop 1
k1_ngs1:
    v_mfma_f32_32x32x16_bf16 v[32:47], v[148:151], v[208:211], 0
    v_mfma_f32_32x32x16_bf16 v[32:47], v[152:155], v[212:215], v[32:47]
    v_mfma_f32_32x32x16_bf16 v[32:47], v[156:159], v[216:219], v[32:47]
    v_mfma_f32_32x32x16_bf16 v[32:47], v[160:163], v[220:223], v[32:47]
    v_mfma_f32_32x32x16_bf16 v[48:63], v[148:151], v[216:219], 0
    v_mfma_f32_32x32x16_bf16 v[48:63], v[152:155], v[220:223], v[48:63]
    v_mfma_f32_32x32x16_bf16 v[48:63], v[164:167], v[208:211], v[48:63]
    v_mfma_f32_32x32x16_bf16 v[48:63], v[168:171], v[212:215], v[48:63]
    s_nop 7
    v_cvt_pk_bf16_f32 v192, v32, v33
    v_cvt_pk_bf16_f32 v193, v34, v35
    v_cvt_pk_bf16_f32 v194, v36, v37
    v_cvt_pk_bf16_f32 v195, v38, v39
    v_cvt_pk_bf16_f32 v196, v40, v41
    v_cvt_pk_bf16_f32 v197, v42, v43
    v_cvt_pk_bf16_f32 v198, v44, v45
    v_cvt_pk_bf16_f32 v199, v46, v47
    s_nop 0
    v_permlane32_swap_b32 v192, v194
    v_permlane32_swap_b32 v193, v195
    v_permlane32_swap_b32 v196, v198
    v_permlane32_swap_b32 v197, v199
    ds_write_b128 v172, v[192:195] offset:16384
    ds_write_b128 v172, v[196:199] offset:16416
    s_cmp_lg_u32 s33, 31
    s_cbranch_scc1 k1_ngw1
    s_mov_b32 exec_lo, 1
    s_mov_b32 exec_hi, 1
    ds_write_b128 v172, v[228:231] offset:17408
    ds_write_b128 v172, v[232:235] offset:17440
    ds_write_b128 v172, v[236:239] offset:17472
    ds_write_b128 v172, v[240:243] offset:17504
    s_mov_b64 exec, -1
k1_ngw1:
    s_waitcnt lgkmcnt(0)
    ds_read_b128 v[192:195], v174 offset:16384
    ds_read_b128 v[196:199], v174 offset:17408
    v_cvt_pk_bf16_f32 v200, v48, v49
    v_cvt_pk_bf16_f32 v201, v50, v51
    v_cvt_pk_bf16_f32 v202, v52, v53
    v_cvt_pk_bf16_f32 v203, v54, v55
    v_cvt_pk_bf16_f32 v204, v56, v57
    v_cvt_pk_bf16_f32 v205, v58, v59
    v_cvt_pk_bf16_f32 v206, v60, v61
    v_cvt_pk_bf16_f32 v207, v62, v63
    s_nop 0
    v_permlane32_swap_b32 v200, v202
    v_permlane32_swap_b32 v201, v203
    v_permlane32_swap_b32 v204, v206
    v_permlane32_swap_b32 v205, v207
    ds_write_b128 v172, v[200:203] offset:18432
    ds_write_b128 v172, v[204:207] offset:18464
    s_waitcnt lgkmcnt(0)
    ds_read_b128 v[200:203], v174 offset:18432
    ds_read_b128 v[204:207], v174 offset:19456
    s_waitcnt lgkmcnt(2)
    s_mov_b64 exec, s[54:55]
    buffer_store_dwordx4 v[192:195], v189, s[16:19], s35 offen offset:0 sc1
    s_waitcnt lgkmcnt(2)
    s_mov_b64 exec, s[56:57]
    buffer_store_dwordx4 v[196:199], v189, s[16:19], s35 offen offset:1024 sc1
    s_waitcnt lgkmcnt(1)
    s_mov_b64 exec, s[54:55]
    buffer_store_dwordx4 v[200:203], v189, s[16:19], s35 offen offset:2048 sc1
    s_waitcnt lgkmcnt(0)
    s_mov_b64 exec, s[56:57]
    buffer_store_dwordx4 v[204:207], v189, s[16:19], s35 offen offset:3072 sc1
    s_mov_b64 exec, -1
k1_pf:
    s_load_dwordx2 s[6:7], s[4:5], 0
    s_mov_b32 s38, 200000
    s_waitcnt lgkmcnt(0)
    s_cmp_lg_u32 s6, 0
    s_cbranch_scc1 k1_tagl_done
    v_mov_b32 v172, 0
k1_tagl:
    global_load_dwordx2 v[174:175], v172, s[4:5] sc1
    s_sub_u32 s38, s38, 1
    s_waitcnt vmcnt(0)
    v_readfirstlane_b32 s6, v174
    v_readfirstlane_b32 s7, v175
    s_nop 0
    s_cmp_lg_u32 s6, 0
    s_cbranch_scc1 k1_tagl_done
    s_sleep 4
    s_cmp_lg_u32 s38, 0
    s_cbranch_scc1 k1_tagl
k1_tagl_done:
    s_lshl_b32 s38, s2, 3
    s_add_u32 s38, s38, s47
    s_lshl_b32 s38, s38, 7
    s_add_u32 s38, s38, 15335424
    v_mov_b32 v172, 0
    v_mov_b32 v174, s6
    v_mov_b32 v175, s7
    s_mov_b64 exec, 1
    s_waitcnt vmcnt(0)
    buffer_store_dwordx2 v[174:175], v172, s[16:19], s38 offen sc1
    s_mov_b64 exec, -1
    s_barrier
k2_start:
    s_load_dwordx2 s[12:13], s[0:1], 40
    s_load_dwordx2 s[48:49], s[0:1], 56
    s_mov_b32 s8, s16
    s_mov_b32 s9, s17
    s_mov_b32 s10, 16777216
    s_mov_b32 s11, 0x20000
    s_mov_b32 s20, s47
    v_mov_b32 v208, v64
    v_mov_b32 v240, s6
    v_mov_b32 v241, s7
    v_lshlrev_b32 v209, 4, v208
    v_and_b32 v221, 31, v208
    v_lshlrev_b32 v221, 2, v221
    s_and_b32 s22, s2, 7
    s_lshr_b32 s21, s2, 3
    s_and_b32 s25, s21, 3
    s_lshl_b32 s52, s22, 2
    s_add_u32 s52, s52, s25
    s_lshr_b32 s53, s21, 2
    s_getpc_b64 s[16:17]
    s_add_u32 s16, s16, tab_inv@rel32@lo+4
    s_addc_u32 s17, s17, tab_inv@rel32@hi+12
    s_mov_b32 s18, 401408
    s_mov_b32 s19, 0x20000
    s_cmp_ge_u32 s20, 4
    s_cbranch_scc1 k2_aux
    s_lshr_b32 s23, s21, 4
    s_lshl_b32 s23, s23, 3
    s_add_u32 s23, s23, s22
    s_and_b32 s24, s21, 15
    s_cmp_eq_u32 s20, 0
    s_cselect_b32 s27, 13, 17
    s_mul_i32 s25, s20, 17
    s_sub_u32 s25, s25, 4
    s_max_i32 s25, s25, 0
    s_lshl_b32 s26, s20, 4
    s_cmp_le_u32 s2, 224
    s_cselect_b32 s27, s27, 16
    s_cselect_b32 s25, s25, s26
    s_mul_i32 s34, s20, 3
    s_sub_u32 s30, s25, s34
    s_add_u32 s30, s30, 9
    v_lshrrev_b32 v2, 1, v208
    s_sub_u32 s26, s27, 1
    v_min_u32 v2, s26, v2
    v_add_u32 v3, s34, v2
    v_add_u32 v4, s30, v2
    v_cmp_gt_u32 vcc, 3, v2
    s_lshr_b32 s26, s23, 2
    s_and_b32 s28, s26, 1
    v_cndmask_b32 v3, v4, v3, vcc
    v_lshrrev_b32 v4, 5, v3
    v_bfe_u32 v5, v3, 1, 4
    v_and_b32 v6, 1, v3
    v_and_b32 v7, 1, v208
    v_lshl_add_u32 v7, v7, 2, s26
    v_add_u32 v7, 4, v7
    v_cmp_lt_u32 vcc, 33, v208
    s_lshr_b32 s29, s20, 1
    s_xor_b32 s29, s29, s28
    s_and_b32 s32, s20, 1
    v_mov_b32 v8, s29
    v_mov_b32 v9, s24
    v_mov_b32 v10, s32
    v_mov_b32 v11, s26
    v_cndmask_b32 v4, v4, v8, vcc
    v_cndmask_b32 v5, v5, v9, vcc
    v_cndmask_b32 v6, v6, v10, vcc
    v_cndmask_b32 v7, v7, v11, vcc
    s_bfe_u32 s28, s23, 0x10001
    v_and_b32 v2, 7, v7
    v_lshlrev_b32 v2, 2, v2
    v_and_or_b32 v2, v5, 3, v2
    v_lshrrev_b32 v3, 2, v5
    v_lshl_add_u32 v2, v2, 2, v3
    v_lshrrev_b32 v3, 3, v7
    v_lshl_add_u32 v2, v2, 1, v3
    v_xor_b32 v3, 1, v4
    v_lshl_add_u32 v2, v2, 1, v3
    v_and_b32 v3, s28, v4
    v_lshl_add_u32 v2, v2, 1, v3
    v_lshl_add_u32 v2, v2, 1, v6
    v_lshlrev_b32 v2, 7, v2
    s_lshl_b32 s26, s23, 6
    s_add_u32 s34, s34, s26
    s_lshl_b32 s34, s34, 11
    s_add_u32 s34, s34, 2097152
    s_add_u32 s58, s30, s26
    s_add_u32 s31, s58, s27
    s_add_u32 s58, s58, 3
    s_lshl_b32 s58, s58, 11
    s_add_u32 s58, s58, 2097152
    s_lshl_b32 s31, s31, 11
    s_add_u32 s31, s31, 2097152
    s_lshl_b32 s25, s24, 2
    s_add_u32 s25, s25, s26
    s_add_u32 s40, s20, 1
    s_and_b32 s40, s40, 3
    s_add_u32 s26, s40, s25
    s_lshl_b32 s44, s26, 11
    s_add_u32 s41, s20, 2
    s_and_b32 s41, s41, 3
    s_add_u32 s26, s41, s25
    s_lshl_b32 s45, s26, 11
    s_add_u32 s42, s20, 3
    s_and_b32 s42, s42, 3
    s_add_u32 s26, s42, s25
    s_lshl_b32 s46, s26, 11
    s_add_u32 s43, s20, 4
    s_and_b32 s43, s43, 3
    s_add_u32 s26, s43, s25
    s_lshl_b32 s47, s26, 11
    s_mov_b32 s29, s34
    s_add_u32 s32, s29, 2097152
    s_mov_b32 s28, 200000
    s_mov_b32 s25, 15335424
    s_mov_b32 exec_lo, 0x3f
    s_mov_b32 exec_hi, 4
    s_sleep 10
k2_pa:
    buffer_load_dwordx2 v[4:5], v2, s[8:11], s25 offen sc1
    s_waitcnt vmcnt(0)
    v_cmp_ne_u64 vcc, s[6:7], v[4:5]
    s_nop 1
    s_and_b64 exec, exec, vcc
    s_cbranch_scc0 k2_pa_done
    s_sub_u32 s28, s28, 1
    s_sleep 1
    s_cmp_gt_i32 s28, 0
    s_cbranch_scc1 k2_pa
k2_pa_done:
    s_mov_b64 exec, -1
    s_lshl_b32 s25, s20, 11
    s_add_u32 m0, s25, 122880
    buffer_load_dwordx4 v[160:163], v209, s[8:11], s29 offen offset:0 sc1
    buffer_load_dwordx4 v209, s[8:11], s47 offen sc1 lds
    buffer_load_dwordx4 v209, s[8:11], s47 offen offset:1024 sc1 lds
    buffer_load_dwordx4 v[164:167], v209, s[8:11], s29 offen offset:1024 sc1
    v_mov_b32 v0, 0
    v_mov_b32 v1, 0
    v_mov_b32 v3, 0
    v_mov_b32 v4, 0
    v_mov_b32 v5, 0
    v_mov_b32 v6, 0
    v_mov_b32 v7, 0
    v_mov_b32 v8, 0
    v_mov_b32 v9, 0
    v_mov_b32 v10, 0
    v_mov_b32 v11, 0
    v_mov_b32 v12, 0
    v_mov_b32 v13, 0
    v_mov_b32 v14, 0
    v_mov_b32 v15, 0
    v_mov_b32 v16, 0
    v_mov_b32 v17, 0
    v_mov_b32 v18, 0
    v_mov_b32 v19, 0
    v_mov_b32 v20, 0
    v_mov_b32 v21, 0
    v_mov_b32 v22, 0
    v_mov_b32 v23, 0
    v_mov_b32 v24, 0
    v_mov_b32 v25, 0
    v_mov_b32 v26, 0
    v_mov_b32 v27, 0
    v_mov_b32 v28, 0
    v_mov_b32 v29, 0
    v_mov_b32 v30, 0
    v_mov_b32 v31, 0
    v_mov_b32 v32, 0
    v_mov_b32 v33, 0
    v_mov_b32 v34, 0
    v_mov_b32 v35, 0
    v_mov_b32 v36, 0
    v_mov_b32 v37, 0
    v_mov_b32 v38, 0
    v_mov_b32 v39, 0
    v_mov_b32 v40, 0
    v_mov_b32 v41, 0
    v_mov_b32 v42, 0
    v_mov_b32 v43, 0
    v_mov_b32 v44, 0
    v_mov_b32 v45, 0
    v_mov_b32 v46, 0
    v_mov_b32 v47, 0
    v_mov_b32 v48, 0
    v_mov_b32 v49, 0
    v_mov_b32 v50, 0
    v_mov_b32 v51, 0
    v_mov_b32 v52, 0
    v_mov_b32 v53, 0
    v_mov_b32 v54, 0
    v_mov_b32 v55, 0
    v_mov_b32 v56, 0
    v_mov_b32 v57, 0
    v_mov_b32 v58, 0
    v_mov_b32 v59, 0
    v_mov_b32 v60, 0
    v_mov_b32 v61, 0
    v_mov_b32 v62, 0
    v_mov_b32 v63, 0
    buffer_load_dwordx4 v[168:171], v209, s[8:11], s32 offen offset:0 sc1
    buffer_load_dwordx4 v[172:175], v209, s[8:11], s32 offen offset:1024 sc1
    s_mov_b32 s33, 0
    s_mov_b32 s35, 0
    s_branch k2_first
k2_pass:
    s_mov_b32 s29, s34
    s_add_u32 s32, s29, 2097152
    buffer_load_dwordx4 v[160:163], v209, s[8:11], s29 offen offset:0 sc1
    buffer_load_dwordx4 v[164:167], v209, s[8:11], s29 offen offset:1024 sc1
    buffer_load_dwordx4 v[168:171], v209, s[8:11], s32 offen offset:0 sc1
    buffer_load_dwordx4 v[172:175], v209, s[8:11], s32 offen offset:1024 sc1
    s_waitcnt vmcnt(0)
k2_first:
    s_add_u32 s29, s29, 2048
    s_add_u32 s32, s29, 2097152
    buffer_load_dwordx4 v[176:179], v209, s[8:11], s29 offen offset:0 sc1
    buffer_load_dwordx4 v[180:183], v209, s[8:11], s29 offen offset:1024 sc1
    buffer_load_dwordx4 v[184:187], v209, s[8:11], s32 offen offset:0 sc1
    buffer_load_dwordx4 v[188:191], v209, s[8:11], s32 offen offset:1024 sc1
    s_add_u32 s29, s29, 2048
    s_add_u32 s32, s29, 2097152
    buffer_load_dwordx4 v[192:195], v209, s[8:11], s29 offen offset:0 sc1
    buffer_load_dwordx4 v[196:199], v209, s[8:11], s29 offen offset:1024 sc1
    buffer_load_dwordx4 v[200:203], v209, s[8:11], s32 offen offset:0 sc1
    buffer_load_dwordx4 v[204:207], v209, s[8:11], s32 offen offset:1024 sc1
    s_sub_u32 s25, s27, 3
    s_mul_i32 s25, s25, s24
    s_lshr_b32 s25, s25, 4
    s_lshl_b32 s25, s25, 11
    s_add_u32 s29, s58, s25
    s_cmp_lg_u32 s33, 0
    s_cbranch_scc1 k2_nobar
    v_mov_b32 v224, v2
    s_mov_b32 s25, 15335424
    buffer_load_dwordx2 v[222:223], v2, s[8:11], s25 offen sc1
    v_mov_b32 v2, 0
    v_mov_b32 v210, 0xdddddddd
    s_lshl_b32 s25, s40, 11
    s_add_u32 s25, s25, 122880
    v_add_u32 v214, s25, v209
    s_lshl_b32 s25, s41, 11
    s_add_u32 s25, s25, 122880
    v_add_u32 v215, s25, v209
    s_lshl_b32 s25, s42, 11
    s_add_u32 s25, s25, 122880
    v_add_u32 v216, s25, v209
    s_lshl_b32 s25, s43, 11
    s_add_u32 s25, s25, 122880
    v_add_u32 v217, s25, v209
    s_waitcnt vmcnt(12)
    s_barrier
    ds_read_b128 v[128:131], v214 offset:0
    ds_read_b128 v[132:135], v214 offset:1024
    ds_read_b128 v[136:139], v215 offset:0
    ds_read_b128 v[140:143], v215 offset:1024
    ds_read_b128 v[144:147], v216 offset:0
    ds_read_b128 v[148:151], v216 offset:1024
    ds_read_b128 v[152:155], v217 offset:0
    ds_read_b128 v[156:159], v217 offset:1024
    s_branch k2_go
k2_nobar:
    s_waitcnt vmcnt(0)
    v_mov_b32 v222, s6
    v_mov_b32 v223, s7
    v_mov_b32 v0, 0
    v_mov_b32 v1, 0
    v_mov_b32 v2, 0
    v_mov_b32 v3, 0
    v_mov_b32 v4, 0
    v_mov_b32 v5, 0
    v_mov_b32 v6, 0
    v_mov_b32 v7, 0
    v_mov_b32 v8, 0
    v_mov_b32 v9, 0
    v_mov_b32 v10, 0
    v_mov_b32 v11, 0
    v_mov_b32 v12, 0
    v_mov_b32 v13, 0
    v_mov_b32 v14, 0
    v_mov_b32 v15, 0
    v_mov_b32 v16, 0
    v_mov_b32 v17, 0
    v_mov_b32 v18, 0
    v_mov_b32 v19, 0
    v_mov_b32 v20, 0
    v_mov_b32 v21, 0
    v_mov_b32 v22, 0
    v_mov_b32 v23, 0
    v_mov_b32 v24, 0
    v_mov_b32 v25, 0
    v_mov_b32 v26, 0
    v_mov_b32 v27, 0
    v_mov_b32 v28, 0
    v_mov_b32 v29, 0
    v_mov_b32 v30, 0
    v_mov_b32 v31, 0
    v_mov_b32 v32, 0
    v_mov_b32 v33, 0
    v_mov_b32 v34, 0
    v_mov_b32 v35, 0
    v_mov_b32 v36, 0
    v_mov_b32 v37, 0
    v_mov_b32 v38, 0
    v_mov_b32 v39, 0
    v_mov_b32 v40, 0
    v_mov_b32 v41, 0
    v_mov_b32 v42, 0
    v_mov_b32 v43, 0
    v_mov_b32 v44, 0
    v_mov_b32 v45, 0
    v_mov_b32 v46, 0
    v_mov_b32 v47, 0
    v_mov_b32 v48, 0
    v_mov_b32 v49, 0
    v_mov_b32 v50, 0
    v_mov_b32 v51, 0
    v_mov_b32 v52, 0
    v_mov_b32 v53, 0
    v_mov_b32 v54, 0
    v_mov_b32 v55, 0
    v_mov_b32 v56, 0
    v_mov_b32 v57, 0
    v_mov_b32 v58, 0
    v_mov_b32 v59, 0
    v_mov_b32 v60, 0
    v_mov_b32 v61, 0
    v_mov_b32 v62, 0
    v_mov_b32 v63, 0
k2_go:
    s_mul_i32 s25, s40, 12288
    s_add_u32 s25, s25, 114688
    v_add_u32 v212, s25, v209
    s_mul_i32 s25, s41, 12288
    s_add_u32 s25, s25, 114688
    v_add_u32 v213, s25, v209
    s_mul_i32 s25, s42, 12288
    s_add_u32 s25, s25, 114688
    v_add_u32 v214, s25, v209
    s_mov_b32 s28, s27
    s_waitcnt vmcnt(11) lgkmcnt(6)
    v_mfma_f32_32x32x16_bf16 v[64:79], v[160:163], v[128:131], 0
    v_mfma_f32_32x32x16_bf16 v[64:79], v[164:167], v[132:135], v[64:79]
    s_nop 9
    s_waitcnt lgkmcnt(0)
    v_mfma_f32_32x32x16_bf16 v[80:95], v[160:163], v[136:139], 0
    v_exp_f32 v64, v64
    v_exp_f32 v65, v65
    v_exp_f32 v66, v66
    v_exp_f32 v67, v67
    v_mfma_f32_32x32x16_bf16 v[80:95], v[164:167], v[140:143], v[80:95]
    v_exp_f32 v68, v68
    v_exp_f32 v69, v69
    v_exp_f32 v70, v70
    v_exp_f32 v71, v71
    v_exp_f32 v72, v72
    v_exp_f32 v73, v73
    v_exp_f32 v74, v74
    v_exp_f32 v75, v75
    v_exp_f32 v76, v76
    v_exp_f32 v77, v77
    v_exp_f32 v78, v78
    v_exp_f32 v79, v79
    v_mfma_f32_32x32x16_bf16 v[96:111], v[160:163], v[144:147], 0
    v_exp_f32 v80, v80
    v_exp_f32 v81, v81
    v_exp_f32 v82, v82
    v_exp_f32 v83, v83
    v_mfma_f32_32x32x16_bf16 v[96:111], v[164:167], v[148:151], v[96:111]
    s_waitcnt vmcnt(9)
    v_exp_f32 v84, v84
    v_exp_f32 v85, v85
    v_exp_f32 v86, v86
    v_exp_f32 v87, v87
    v_smfmac_f32_32x32x32_bf16 v[0:15], v[168:171], v[64:71], v210
    v_exp_f32 v88, v88
    v_exp_f32 v89, v89
    v_exp_f32 v90, v90
    v_exp_f32 v91, v91
    v_smfmac_f32_32x32x32_bf16 v[0:15], v[172:175], v[72:79], v210
    v_exp_f32 v92, v92
    v_exp_f32 v93, v93
    v_exp_f32 v94, v94
    v_exp_f32 v95, v95
    v_mfma_f32_32x32x16_bf16 v[112:127], v[160:163], v[152:155], 0
    v_exp_f32 v96, v96
    v_exp_f32 v97, v97
    v_exp_f32 v98, v98
    v_exp_f32 v99, v99
    v_mfma_f32_32x32x16_bf16 v[112:127], v[164:167], v[156:159], v[112:127]
    v_exp_f32 v100, v100
    v_exp_f32 v101, v101
    v_exp_f32 v102, v102
    v_exp_f32 v103, v103
    v_smfmac_f32_32x32x32_bf16 v[16:31], v[168:171], v[80:87], v210
    v_exp_f32 v104, v104
    v_exp_f32 v105, v105
    v_exp_f32 v106, v106
    v_exp_f32 v107, v107
    v_smfmac_f32_32x32x32_bf16 v[16:31], v[172:175], v[88:95], v210
    s_sub_u32 s28, s28, 1
    s_waitcnt vmcnt(7)
    v_exp_f32 v108, v108
    v_exp_f32 v109, v109
    v_exp_f32 v110, v110
    v_exp_f32 v111, v111
    v_mfma_f32_32x32x16_bf16 v[64:79], v[176:179], v[128:131], 0
    v_exp_f32 v112, v112
    v_exp_f32 v113, v113
    v_exp_f32 v114, v114
    v_exp_f32 v115, v115
    v_mfma_f32_32x32x16_bf16 v[64:79], v[180:183], v[132:135], v[64:79]
    v_exp_f32 v116, v116
    v_exp_f32 v117, v117
    v_exp_f32 v118, v118
    v_exp_f32 v119, v119
    v_smfmac_f32_32x32x32_bf16 v[32:47], v[168:171], v[96:103], v210
    s_waitcnt vmcnt(0)
    v_exp_f32 v120, v120
    v_exp_f32 v121, v121
    v_exp_f32 v122, v122
    v_exp_f32 v123, v123
    v_smfmac_f32_32x32x32_bf16 v[32:47], v[172:175], v[104:111], v210
    v_cmp_eq_u64 vcc, s[6:7], v[222:223]
    v_exp_f32 v124, v124
    v_exp_f32 v125, v125
    v_exp_f32 v126, v126
    v_exp_f32 v127, v127
    s_cmp_lg_u64 vcc, -1
    s_cbranch_scc1 k2_pb0
k2_loop:
    v_mfma_f32_32x32x16_bf16 v[80:95], v[176:179], v[136:139], 0
    v_exp_f32 v64, v64
    v_exp_f32 v65, v65
    v_exp_f32 v66, v66
    v_exp_f32 v67, v67
    v_mfma_f32_32x32x16_bf16 v[80:95], v[180:183], v[140:143], v[80:95]
    v_exp_f32 v68, v68
    v_exp_f32 v69, v69
    v_exp_f32 v70, v70
    v_exp_f32 v71, v71
    v_smfmac_f32_32x32x32_bf16 v[48:63], v[168:171], v[112:119], v210
    buffer_load_dwordx4 v[160:163], v209, s[8:11], s29 offen offset:0 sc1
    v_exp_f32 v72, v72
    v_exp_f32 v73, v73
    v_exp_f32 v74, v74
    v_exp_f32 v75, v75
    v_smfmac_f32_32x32x32_bf16 v[48:63], v[172:175], v[120:127], v210
    s_add_u32 s32, s29, 2097152
    v_exp_f32 v76, v76
    v_exp_f32 v77, v77
    v_exp_f32 v78, v78
    v_exp_f32 v79, v79
    v_mfma_f32_32x32x16_bf16 v[96:111], v[176:179], v[144:147], 0
    v_exp_f32 v80, v80
    v_exp_f32 v81, v81
    v_exp_f32 v82, v82
    v_exp_f32 v83, v83
    v_mfma_f32_32x32x16_bf16 v[96:111], v[180:183], v[148:151], v[96:111]
    s_waitcnt vmcnt(5)
    v_exp_f32 v84, v84
    v_exp_f32 v85, v85
    v_exp_f32 v86, v86
    v_exp_f32 v87, v87
    v_smfmac_f32_32x32x32_bf16 v[0:15], v[184:187], v[64:71], v210
    buffer_load_dwordx4 v[164:167], v209, s[8:11], s29 offen offset:1024 sc1
    v_exp_f32 v88, v88
    v_exp_f32 v89, v89
    v_exp_f32 v90, v90
    v_exp_f32 v91, v91
    v_smfmac_f32_32x32x32_bf16 v[0:15], v[188:191], v[72:79], v210
    s_add_u32 s29, s29, 2048
    s_cmp_ge_u32 s29, s31
    v_exp_f32 v92, v92
    v_exp_f32 v93, v93
    v_exp_f32 v94, v94
    v_exp_f32 v95, v95
    v_mfma_f32_32x32x16_bf16 v[112:127], v[176:179], v[152:155], 0
    s_cselect_b32 s29, s58, s29
    v_exp_f32 v96, v96
    v_exp_f32 v97, v97
    v_exp_f32 v98, v98
    v_exp_f32 v99, v99
    v_mfma_f32_32x32x16_bf16 v[112:127], v[180:183], v[156:159], v[112:127]
    v_exp_f32 v100, v100
    v_exp_f32 v101, v101
    v_exp_f32 v102, v102
    v_exp_f32 v103, v103
    v_smfmac_f32_32x32x32_bf16 v[16:31], v[184:187], v[80:87], v210
    buffer_load_dwordx4 v[168:171], v209, s[8:11], s32 offen offset:0 sc1
    v_exp_f32 v104, v104
    v_exp_f32 v105, v105
    v_exp_f32 v106, v106
    v_exp_f32 v107, v107
    v_smfmac_f32_32x32x32_bf16 v[16:31], v[188:191], v[88:95], v210
    s_sub_u32 s28, s28, 1
    s_waitcnt vmcnt(5)
    v_exp_f32 v108, v108
    v_exp_f32 v109, v109
    v_exp_f32 v110, v110
    v_exp_f32 v111, v111
    v_mfma_f32_32x32x16_bf16 v[64:79], v[192:195], v[128:131], 0
    v_exp_f32 v112, v112
    v_exp_f32 v113, v113
    v_exp_f32 v114, v114
    v_exp_f32 v115, v115
    v_mfma_f32_32x32x16_bf16 v[64:79], v[196:199], v[132:135], v[64:79]
    v_exp_f32 v116, v116
    v_exp_f32 v117, v117
    v_exp_f32 v118, v118
    v_exp_f32 v119, v119
    v_smfmac_f32_32x32x32_bf16 v[32:47], v[184:187], v[96:103], v210
    buffer_load_dwordx4 v[172:175], v209, s[8:11], s32 offen offset:1024 sc1
    v_exp_f32 v120, v120
    v_exp_f32 v121, v121
    v_exp_f32 v122, v122
    v_exp_f32 v123, v123
    v_smfmac_f32_32x32x32_bf16 v[32:47], v[188:191], v[104:111], v210
    s_cmp_eq_u32 s28, 1
    v_exp_f32 v124, v124
    v_exp_f32 v125, v125
    v_exp_f32 v126, v126
    v_exp_f32 v127, v127
    s_cbranch_scc1 k2_x2
    v_mfma_f32_32x32x16_bf16 v[80:95], v[192:195], v[136:139], 0
    v_exp_f32 v64, v64
    v_exp_f32 v65, v65
    v_exp_f32 v66, v66
    v_exp_f32 v67, v67
    v_mfma_f32_32x32x16_bf16 v[80:95], v[196:199], v[140:143], v[80:95]
    v_exp_f32 v68, v68
    v_exp_f32 v69, v69
    v_exp_f32 v70, v70
    v_exp_f32 v71, v71
    v_smfmac_f32_32x32x32_bf16 v[48:63], v[184:187], v[112:119], v210
    buffer_load_dwordx4 v[176:179], v209, s[8:11], s29 offen offset:0 sc1
    v_exp_f32 v72, v72
    v_exp_f32 v73, v73
    v_exp_f32 v74, v74
    v_exp_f32 v75, v75
    v_smfmac_f32_32x32x32_bf16 v[48:63], v[188:191], v[120:127], v210
    s_add_u32 s32, s29, 2097152
    v_exp_f32 v76, v76
    v_exp_f32 v77, v77
    v_exp_f32 v78, v78
    v_exp_f32 v79, v79
    v_mfma_f32_32x32x16_bf16 v[96:111], v[192:195], v[144:147], 0
    v_exp_f32 v80, v80
    v_exp_f32 v81, v81
    v_exp_f32 v82, v82
    v_exp_f32 v83, v83
    v_mfma_f32_32x32x16_bf16 v[96:111], v[196:199], v[148:151], v[96:111]
    s_waitcnt vmcnt(5)
    v_exp_f32 v84, v84
    v_exp_f32 v85, v85
    v_exp_f32 v86, v86
    v_exp_f32 v87, v87
    v_smfmac_f32_32x32x32_bf16 v[0:15], v[200:203], v[64:71], v210
    buffer_load_dwordx4 v[180:183], v209, s[8:11], s29 offen offset:1024 sc1
    v_exp_f32 v88, v88
    v_exp_f32 v89, v89
    v_exp_f32 v90, v90
    v_exp_f32 v91, v91
    v_smfmac_f32_32x32x32_bf16 v[0:15], v[204:207], v[72:79], v210
    s_add_u32 s29, s29, 2048
    s_cmp_ge_u32 s29, s31
    v_exp_f32 v92, v92
    v_exp_f32 v93, v93
    v_exp_f32 v94, v94
    v_exp_f32 v95, v95
    v_mfma_f32_32x32x16_bf16 v[112:127], v[192:195], v[152:155], 0
    s_cselect_b32 s29, s58, s29
    v_exp_f32 v96, v96
    v_exp_f32 v97, v97
    v_exp_f32 v98, v98
    v_exp_f32 v99, v99
    v_mfma_f32_32x32x16_bf16 v[112:127], v[196:199], v[156:159], v[112:127]
    v_exp_f32 v100, v100
    v_exp_f32 v101, v101
    v_exp_f32 v102, v102
    v_exp_f32 v103, v103
    v_smfmac_f32_32x32x32_bf16 v[16:31], v[200:203], v[80:87], v210
    buffer_load_dwordx4 v[184:187], v209, s[8:11], s32 offen offset:0 sc1
    v_exp_f32 v104, v104
    v_exp_f32 v105, v105
    v_exp_f32 v106, v106
    v_exp_f32 v107, v107
    v_smfmac_f32_32x32x32_bf16 v[16:31], v[204:207], v[88:95], v210
    s_sub_u32 s28, s28, 1
    s_waitcnt vmcnt(5)
    v_exp_f32 v108, v108
    v_exp_f32 v109, v109
    v_exp_f32 v110, v110
    v_exp_f32 v111, v111
    v_mfma_f32_32x32x16_bf16 v[64:79], v[160:163], v[128:131], 0
    v_exp_f32 v112, v112
    v_exp_f32 v113, v113
    v_exp_f32 v114, v114
    v_exp_f32 v115, v115
    v_mfma_f32_32x32x16_bf16 v[64:79], v[164:167], v[132:135], v[64:79]
    v_exp_f32 v116, v116
    v_exp_f32 v117, v117
    v_exp_f32 v118, v118
    v_exp_f32 v119, v119
    v_smfmac_f32_32x32x32_bf16 v[32:47], v[200:203], v[96:103], v210
    buffer_load_dwordx4 v[188:191], v209, s[8:11], s32 offen offset:1024 sc1
    v_exp_f32 v120, v120
    v_exp_f32 v121, v121
    v_exp_f32 v122, v122
    v_exp_f32 v123, v123
    v_smfmac_f32_32x32x32_bf16 v[32:47], v[204:207], v[104:111], v210
    s_cmp_eq_u32 s28, 1
    v_exp_f32 v124, v124
    v_exp_f32 v125, v125
    v_exp_f32 v126, v126
    v_exp_f32 v127, v127
    s_cbranch_scc1 k2_x0
    v_mfma_f32_32x32x16_bf16 v[80:95], v[160:163], v[136:139], 0
    v_exp_f32 v64, v64
    v_exp_f32 v65, v65
    v_exp_f32 v66, v66
    v_exp_f32 v67, v67
    v_mfma_f32_32x32x16_bf16 v[80:95], v[164:167], v[140:143], v[80:95]
    v_exp_f32 v68, v68
    v_exp_f32 v69, v69
    v_exp_f32 v70, v70
    v_exp_f32 v71, v71
    v_smfmac_f32_32x32x32_bf16 v[48:63], v[200:203], v[112:119], v210
    buffer_load_dwordx4 v[192:195], v209, s[8:11], s29 offen offset:0 sc1
    v_exp_f32 v72, v72
    v_exp_f32 v73, v73
    v_exp_f32 v74, v74
    v_exp_f32 v75, v75
    v_smfmac_f32_32x32x32_bf16 v[48:63], v[204:207], v[120:127], v210
    s_add_u32 s32, s29, 2097152
    v_exp_f32 v76, v76
    v_exp_f32 v77, v77
    v_exp_f32 v78, v78
    v_exp_f32 v79, v79
    v_mfma_f32_32x32x16_bf16 v[96:111], v[160:163], v[144:147], 0
    v_exp_f32 v80, v80
    v_exp_f32 v81, v81
    v_exp_f32 v82, v82
    v_exp_f32 v83, v83
    v_mfma_f32_32x32x16_bf16 v[96:111], v[164:167], v[148:151], v[96:111]
    s_waitcnt vmcnt(5)
    v_exp_f32 v84, v84
    v_exp_f32 v85, v85
    v_exp_f32 v86, v86
    v_exp_f32 v87, v87
    v_smfmac_f32_32x32x32_bf16 v[0:15], v[168:171], v[64:71], v210
    buffer_load_dwordx4 v[196:199], v209, s[8:11], s29 offen offset:1024 sc1
    v_exp_f32 v88, v88
    v_exp_f32 v89, v89
    v_exp_f32 v90, v90
    v_exp_f32 v91, v91
    v_smfmac_f32_32x32x32_bf16 v[0:15], v[172:175], v[72:79], v210
    s_add_u32 s29, s29, 2048
    s_cmp_ge_u32 s29, s31
    v_exp_f32 v92, v92
    v_exp_f32 v93, v93
    v_exp_f32 v94, v94
    v_exp_f32 v95, v95
    v_mfma_f32_32x32x16_bf16 v[112:127], v[160:163], v[152:155], 0
    s_cselect_b32 s29, s58, s29
    v_exp_f32 v96, v96
    v_exp_f32 v97, v97
    v_exp_f32 v98, v98
    v_exp_f32 v99, v99
    v_mfma_f32_32x32x16_bf16 v[112:127], v[164:167], v[156:159], v[112:127]
    v_exp_f32 v100, v100
    v_exp_f32 v101, v101
    v_exp_f32 v102, v102
    v_exp_f32 v103, v103
    v_smfmac_f32_32x32x32_bf16 v[16:31], v[168:171], v[80:87], v210
    buffer_load_dwordx4 v[200:203], v209, s[8:11], s32 offen offset:0 sc1
    v_exp_f32 v104, v104
    v_exp_f32 v105, v105
    v_exp_f32 v106, v106
    v_exp_f32 v107, v107
    v_smfmac_f32_32x32x32_bf16 v[16:31], v[172:175], v[88:95], v210
    s_sub_u32 s28, s28, 1
    s_waitcnt vmcnt(5)
    v_exp_f32 v108, v108
    v_exp_f32 v109, v109
    v_exp_f32 v110, v110
    v_exp_f32 v111, v111
    v_mfma_f32_32x32x16_bf16 v[64:79], v[176:179], v[128:131], 0
    v_exp_f32 v112, v112
    v_exp_f32 v113, v113
    v_exp_f32 v114, v114
    v_exp_f32 v115, v115
    v_mfma_f32_32x32x16_bf16 v[64:79], v[180:183], v[132:135], v[64:79]
    v_exp_f32 v116, v116
    v_exp_f32 v117, v117
    v_exp_f32 v118, v118
    v_exp_f32 v119, v119
    v_smfmac_f32_32x32x32_bf16 v[32:47], v[168:171], v[96:103], v210
    buffer_load_dwordx4 v[204:207], v209, s[8:11], s32 offen offset:1024 sc1
    v_exp_f32 v120, v120
    v_exp_f32 v121, v121
    v_exp_f32 v122, v122
    v_exp_f32 v123, v123
    v_smfmac_f32_32x32x32_bf16 v[32:47], v[172:175], v[104:111], v210
    s_cmp_eq_u32 s28, 1
    v_exp_f32 v124, v124
    v_exp_f32 v125, v125
    v_exp_f32 v126, v126
    v_exp_f32 v127, v127
    s_cbranch_scc0 k2_loop
k2_x1:
    v_mfma_f32_32x32x16_bf16 v[80:95], v[176:179], v[136:139], 0
    v_exp_f32 v64, v64
    v_exp_f32 v65, v65
    v_exp_f32 v66, v66
    v_exp_f32 v67, v67
    v_mfma_f32_32x32x16_bf16 v[80:95], v[180:183], v[140:143], v[80:95]
    v_exp_f32 v68, v68
    v_exp_f32 v69, v69
    v_exp_f32 v70, v70
    v_exp_f32 v71, v71
    v_smfmac_f32_32x32x32_bf16 v[48:63], v[168:171], v[112:119], v210
    v_exp_f32 v72, v72
    v_exp_f32 v73, v73
    v_exp_f32 v74, v74
    v_exp_f32 v75, v75
    v_smfmac_f32_32x32x32_bf16 v[48:63], v[172:175], v[120:127], v210
    v_exp_f32 v76, v76
    v_exp_f32 v77, v77
    v_exp_f32 v78, v78
    v_exp_f32 v79, v79
    v_mfma_f32_32x32x16_bf16 v[96:111], v[176:179], v[144:147], 0
    v_exp_f32 v80, v80
    v_exp_f32 v81, v81
    v_exp_f32 v82, v82
    v_exp_f32 v83, v83
    v_mfma_f32_32x32x16_bf16 v[96:111], v[180:183], v[148:151], v[96:111]
    s_waitcnt vmcnt(4)
    v_exp_f32 v84, v84
    v_exp_f32 v85, v85
    v_exp_f32 v86, v86
    v_exp_f32 v87, v87
    v_smfmac_f32_32x32x32_bf16 v[0:15], v[184:187], v[64:71], v210
    v_exp_f32 v88, v88
    v_exp_f32 v89, v89
    v_exp_f32 v90, v90
    v_exp_f32 v91, v91
    v_smfmac_f32_32x32x32_bf16 v[0:15], v[188:191], v[72:79], v210
    v_exp_f32 v92, v92
    v_exp_f32 v93, v93
    v_exp_f32 v94, v94
    v_exp_f32 v95, v95
    v_mfma_f32_32x32x16_bf16 v[112:127], v[176:179], v[152:155], 0
    v_exp_f32 v96, v96
    v_exp_f32 v97, v97
    v_exp_f32 v98, v98
    v_exp_f32 v99, v99
    v_mfma_f32_32x32x16_bf16 v[112:127], v[180:183], v[156:159], v[112:127]
    v_exp_f32 v100, v100
    v_exp_f32 v101, v101
    v_exp_f32 v102, v102
    v_exp_f32 v103, v103
    v_smfmac_f32_32x32x32_bf16 v[16:31], v[184:187], v[80:87], v210
    ds_write_b128 v212, v[0:3] offset:0
    v_exp_f32 v104, v104
    v_exp_f32 v105, v105
    v_exp_f32 v106, v106
    v_exp_f32 v107, v107
    v_smfmac_f32_32x32x32_bf16 v[16:31], v[188:191], v[88:95], v210
    ds_write_b128 v212, v[4:7] offset:1024
    v_exp_f32 v108, v108
    v_exp_f32 v109, v109
    v_exp_f32 v110, v110
    v_exp_f32 v111, v111
    ds_write_b128 v212, v[8:11] offset:2048
    v_exp_f32 v112, v112
    v_exp_f32 v113, v113
    v_exp_f32 v114, v114
    v_exp_f32 v115, v115
    ds_write_b128 v212, v[12:15] offset:3072
    v_exp_f32 v116, v116
    v_exp_f32 v117, v117
    v_exp_f32 v118, v118
    v_exp_f32 v119, v119
    v_smfmac_f32_32x32x32_bf16 v[32:47], v[184:187], v[96:103], v210
    ds_write_b128 v213, v[16:19] offset:4096
    v_exp_f32 v120, v120
    v_exp_f32 v121, v121
    v_exp_f32 v122, v122
    v_exp_f32 v123, v123
    v_smfmac_f32_32x32x32_bf16 v[32:47], v[188:191], v[104:111], v210
    ds_write_b128 v213, v[20:23] offset:5120
    v_exp_f32 v124, v124
    v_exp_f32 v125, v125
    v_exp_f32 v126, v126
    v_exp_f32 v127, v127
    ds_write_b128 v213, v[24:27] offset:6144
    v_smfmac_f32_32x32x32_bf16 v[48:63], v[184:187], v[112:119], v210
    ds_write_b128 v213, v[28:31] offset:7168
    v_smfmac_f32_32x32x32_bf16 v[48:63], v[188:191], v[120:127], v210
    s_branch k2_red
k2_x2:
    v_mfma_f32_32x32x16_bf16 v[80:95], v[192:195], v[136:139], 0
    v_exp_f32 v64, v64
    v_exp_f32 v65, v65
    v_exp_f32 v66, v66
    v_exp_f32 v67, v67
    v_mfma_f32_32x32x16_bf16 v[80:95], v[196:199], v[140:143], v[80:95]
    v_exp_f32 v68, v68
    v_exp_f32 v69, v69
    v_exp_f32 v70, v70
    v_exp_f32 v71, v71
    v_smfmac_f32_32x32x32_bf16 v[48:63], v[184:187], v[112:119], v210
    v_exp_f32 v72, v72
    v_exp_f32 v73, v73
    v_exp_f32 v74, v74
    v_exp_f32 v75, v75
    v_smfmac_f32_32x32x32_bf16 v[48:63], v[188:191], v[120:127], v210
    v_exp_f32 v76, v76
    v_exp_f32 v77, v77
    v_exp_f32 v78, v78
    v_exp_f32 v79, v79
    v_mfma_f32_32x32x16_bf16 v[96:111], v[192:195], v[144:147], 0
    v_exp_f32 v80, v80
    v_exp_f32 v81, v81
    v_exp_f32 v82, v82
    v_exp_f32 v83, v83
    v_mfma_f32_32x32x16_bf16 v[96:111], v[196:199], v[148:151], v[96:111]
    s_waitcnt vmcnt(4)
    v_exp_f32 v84, v84
    v_exp_f32 v85, v85
    v_exp_f32 v86, v86
    v_exp_f32 v87, v87
    v_smfmac_f32_32x32x32_bf16 v[0:15], v[200:203], v[64:71], v210
    v_exp_f32 v88, v88
    v_exp_f32 v89, v89
    v_exp_f32 v90, v90
    v_exp_f32 v91, v91
    v_smfmac_f32_32x32x32_bf16 v[0:15], v[204:207], v[72:79], v210
    v_exp_f32 v92, v92
    v_exp_f32 v93, v93
    v_exp_f32 v94, v94
    v_exp_f32 v95, v95
    v_mfma_f32_32x32x16_bf16 v[112:127], v[192:195], v[152:155], 0
    v_exp_f32 v96, v96
    v_exp_f32 v97, v97
    v_exp_f32 v98, v98
    v_exp_f32 v99, v99
    v_mfma_f32_32x32x16_bf16 v[112:127], v[196:199], v[156:159], v[112:127]
    v_exp_f32 v100, v100
    v_exp_f32 v101, v101
    v_exp_f32 v102, v102
    v_exp_f32 v103, v103
    v_smfmac_f32_32x32x32_bf16 v[16:31], v[200:203], v[80:87], v210
    ds_write_b128 v212, v[0:3] offset:0
    v_exp_f32 v104, v104
    v_exp_f32 v105, v105
    v_exp_f32 v106, v106
    v_exp_f32 v107, v107
    v_smfmac_f32_32x32x32_bf16 v[16:31], v[204:207], v[88:95], v210
    ds_write_b128 v212, v[4:7] offset:1024
    v_exp_f32 v108, v108
    v_exp_f32 v109, v109
    v_exp_f32 v110, v110
    v_exp_f32 v111, v111
    ds_write_b128 v212, v[8:11] offset:2048
    v_exp_f32 v112, v112
    v_exp_f32 v113, v113
    v_exp_f32 v114, v114
    v_exp_f32 v115, v115
    ds_write_b128 v212, v[12:15] offset:3072
    v_exp_f32 v116, v116
    v_exp_f32 v117, v117
    v_exp_f32 v118, v118
    v_exp_f32 v119, v119
    v_smfmac_f32_32x32x32_bf16 v[32:47], v[200:203], v[96:103], v210
    ds_write_b128 v213, v[16:19] offset:4096
    v_exp_f32 v120, v120
    v_exp_f32 v121, v121
    v_exp_f32 v122, v122
    v_exp_f32 v123, v123
    v_smfmac_f32_32x32x32_bf16 v[32:47], v[204:207], v[104:111], v210
    ds_write_b128 v213, v[20:23] offset:5120
    v_exp_f32 v124, v124
    v_exp_f32 v125, v125
    v_exp_f32 v126, v126
    v_exp_f32 v127, v127
    ds_write_b128 v213, v[24:27] offset:6144
    v_smfmac_f32_32x32x32_bf16 v[48:63], v[200:203], v[112:119], v210
    ds_write_b128 v213, v[28:31] offset:7168
    v_smfmac_f32_32x32x32_bf16 v[48:63], v[204:207], v[120:127], v210
    s_branch k2_red
k2_x0:
    v_mfma_f32_32x32x16_bf16 v[80:95], v[160:163], v[136:139], 0
    v_exp_f32 v64, v64
    v_exp_f32 v65, v65
    v_exp_f32 v66, v66
    v_exp_f32 v67, v67
    v_mfma_f32_32x32x16_bf16 v[80:95], v[164:167], v[140:143], v[80:95]
    v_exp_f32 v68, v68
    v_exp_f32 v69, v69
    v_exp_f32 v70, v70
    v_exp_f32 v71, v71
    v_smfmac_f32_32x32x32_bf16 v[48:63], v[200:203], v[112:119], v210
    v_exp_f32 v72, v72
    v_exp_f32 v73, v73
    v_exp_f32 v74, v74
    v_exp_f32 v75, v75
    v_smfmac_f32_32x32x32_bf16 v[48:63], v[204:207], v[120:127], v210
    v_exp_f32 v76, v76
    v_exp_f32 v77, v77
    v_exp_f32 v78, v78
    v_exp_f32 v79, v79
    v_mfma_f32_32x32x16_bf16 v[96:111], v[160:163], v[144:147], 0
    v_exp_f32 v80, v80
    v_exp_f32 v81, v81
    v_exp_f32 v82, v82
    v_exp_f32 v83, v83
    v_mfma_f32_32x32x16_bf16 v[96:111], v[164:167], v[148:151], v[96:111]
    s_waitcnt vmcnt(4)
    v_exp_f32 v84, v84
    v_exp_f32 v85, v85
    v_exp_f32 v86, v86
    v_exp_f32 v87, v87
    v_smfmac_f32_32x32x32_bf16 v[0:15], v[168:171], v[64:71], v210
    v_exp_f32 v88, v88
    v_exp_f32 v89, v89
    v_exp_f32 v90, v90
    v_exp_f32 v91, v91
    v_smfmac_f32_32x32x32_bf16 v[0:15], v[172:175], v[72:79], v210
    v_exp_f32 v92, v92
    v_exp_f32 v93, v93
    v_exp_f32 v94, v94
    v_exp_f32 v95, v95
    v_mfma_f32_32x32x16_bf16 v[112:127], v[160:163], v[152:155], 0
    v_exp_f32 v96, v96
    v_exp_f32 v97, v97
    v_exp_f32 v98, v98
    v_exp_f32 v99, v99
    v_mfma_f32_32x32x16_bf16 v[112:127], v[164:167], v[156:159], v[112:127]
    v_exp_f32 v100, v100
    v_exp_f32 v101, v101
    v_exp_f32 v102, v102
    v_exp_f32 v103, v103
    v_smfmac_f32_32x32x32_bf16 v[16:31], v[168:171], v[80:87], v210
    ds_write_b128 v212, v[0:3] offset:0
    v_exp_f32 v104, v104
    v_exp_f32 v105, v105
    v_exp_f32 v106, v106
    v_exp_f32 v107, v107
    v_smfmac_f32_32x32x32_bf16 v[16:31], v[172:175], v[88:95], v210
    ds_write_b128 v212, v[4:7] offset:1024
    v_exp_f32 v108, v108
    v_exp_f32 v109, v109
    v_exp_f32 v110, v110
    v_exp_f32 v111, v111
    ds_write_b128 v212, v[8:11] offset:2048
    v_exp_f32 v112, v112
    v_exp_f32 v113, v113
    v_exp_f32 v114, v114
    v_exp_f32 v115, v115
    ds_write_b128 v212, v[12:15] offset:3072
    v_exp_f32 v116, v116
    v_exp_f32 v117, v117
    v_exp_f32 v118, v118
    v_exp_f32 v119, v119
    v_smfmac_f32_32x32x32_bf16 v[32:47], v[168:171], v[96:103], v210
    ds_write_b128 v213, v[16:19] offset:4096
    v_exp_f32 v120, v120
    v_exp_f32 v121, v121
    v_exp_f32 v122, v122
    v_exp_f32 v123, v123
    v_smfmac_f32_32x32x32_bf16 v[32:47], v[172:175], v[104:111], v210
    ds_write_b128 v213, v[20:23] offset:5120
    v_exp_f32 v124, v124
    v_exp_f32 v125, v125
    v_exp_f32 v126, v126
    v_exp_f32 v127, v127
    ds_write_b128 v213, v[24:27] offset:6144
    v_smfmac_f32_32x32x32_bf16 v[48:63], v[168:171], v[112:119], v210
    ds_write_b128 v213, v[28:31] offset:7168
    v_smfmac_f32_32x32x32_bf16 v[48:63], v[172:175], v[120:127], v210
k2_red:
    s_lshl_b32 s26, s24, 2
    s_add_u32 s26, s26, s20
    s_nop 0
    ds_write_b128 v214, v[32:35] offset:8192
    ds_write_b128 v214, v[36:39] offset:9216
    ds_write_b128 v214, v[40:43] offset:10240
    ds_write_b128 v214, v[44:47] offset:11264
    s_mul_i32 s25, s20, 12288
    s_add_u32 s25, s25, 114688
    v_add_u32 v213, s25, v209
    s_lshl_b32 s25, s20, 2
    s_add_u32 s25, s25, 163712
    v_mov_b32 v226, s25
    s_lshl_b32 s26, s26, 4
    s_add_u32 s26, s26, s23
    s_lshl_b32 s29, s26, 11
    s_add_u32 s29, s29, 11010048
    s_lshl_b32 s32, s26, 7
    s_add_u32 s32, s32, 15073280
    s_waitcnt vmcnt(0) lgkmcnt(0)
    s_barrier
    ds_read_b128 v[76:79], v213 offset:3072
    ds_read_b128 v[92:95], v213 offset:7168
    ds_read_b128 v[108:111], v213 offset:11264
    ds_read_b128 v[64:67], v213 offset:0
    ds_read_b128 v[80:83], v213 offset:4096
    ds_read_b128 v[96:99], v213 offset:8192
    ds_read_b128 v[68:71], v213 offset:1024
    ds_read_b128 v[84:87], v213 offset:5120
    ds_read_b128 v[100:103], v213 offset:9216
    ds_read_b128 v[72:75], v213 offset:2048
    ds_read_b128 v[88:91], v213 offset:6144
    ds_read_b128 v[104:107], v213 offset:10240
    v_cmp_lt_u32 s[38:39], 31, v208
    s_waitcnt lgkmcnt(9)
    v_add_f32 v76, v76, v92
    v_add_f32 v77, v77, v93
    v_add_f32 v78, v78, v94
    v_add_f32 v79, v79, v95
    v_add_f32 v60, v60, v108
    v_add_f32 v61, v61, v109
    v_add_f32 v62, v62, v110
    v_add_f32 v63, v63, v111
    v_add_f32 v60, v60, v76
    v_add_f32 v61, v61, v77
    v_add_f32 v62, v62, v78
    v_add_f32 v63, v63, v79
    v_mov_b32 v216, v60
    v_mov_b32 v217, v60
    s_waitcnt lgkmcnt(6)
    s_nop 0
    v_permlane32_swap_b32 v216, v217
    v_rcp_f32 v218, v217
    v_add_f32 v64, v64, v80
    v_add_f32 v65, v65, v81
    v_add_f32 v66, v66, v82
    v_add_f32 v67, v67, v83
    v_add_f32 v48, v48, v96
    v_add_f32 v49, v49, v97
    v_add_f32 v50, v50, v98
    v_add_f32 v51, v51, v99
    v_add_f32 v48, v48, v64
    v_add_f32 v49, v49, v65
    v_add_f32 v50, v50, v66
    v_add_f32 v51, v51, v67
    s_waitcnt lgkmcnt(3)
    v_add_f32 v68, v68, v84
    v_add_f32 v69, v69, v85
    v_add_f32 v70, v70, v86
    v_add_f32 v71, v71, v87
    v_add_f32 v52, v52, v100
    v_add_f32 v53, v53, v101
    v_add_f32 v54, v54, v102
    v_add_f32 v55, v55, v103
    v_add_f32 v52, v52, v68
    v_add_f32 v53, v53, v69
    v_add_f32 v54, v54, v70
    v_add_f32 v55, v55, v71
    s_waitcnt lgkmcnt(0)
    v_add_f32 v72, v72, v88
    v_add_f32 v73, v73, v89
    v_add_f32 v74, v74, v90
    v_add_f32 v75, v75, v91
    v_add_f32 v56, v56, v104
    v_add_f32 v57, v57, v105
    v_add_f32 v58, v58, v106
    v_add_f32 v59, v59, v107
    v_add_f32 v56, v56, v72
    v_add_f32 v57, v57, v73
    v_add_f32 v58, v58, v74
    v_add_f32 v59, v59, v75
    s_cmp_lg_u32 s35, 0
    s_mov_b32 s57, 0
    s_cbranch_scc1 k2_apart
    v_mul_f32 v64, v48, v218
    v_mul_f32 v65, v49, v218
    v_mul_f32 v66, v50, v218
    v_mul_f32 v67, v51, v218
    v_mul_f32 v68, v52, v218
    v_mul_f32 v69, v53, v218
    v_mul_f32 v70, v54, v218
    v_mul_f32 v71, v55, v218
    v_cvt_pk_bf16_f32 v80, v64, v65
    v_cvt_pk_bf16_f32 v81, v66, v67
    v_cvt_pk_bf16_f32 v82, v68, v69
    v_cvt_pk_bf16_f32 v83, v70, v71
    buffer_store_dwordx4 v[80:83], v209, s[8:11], s29 offen offset:0 sc1
    v_mul_f32 v72, v56, v218
    v_mul_f32 v73, v57, v218
    v_mul_f32 v74, v58, v218
    v_mul_f32 v75, v59, v218
    v_mul_f32 v76, v60, v218
    v_mul_f32 v77, v61, v218
    v_mul_f32 v78, v62, v218
    v_mul_f32 v79, v63, v218
    v_cvt_pk_bf16_f32 v84, v72, v73
    v_cvt_pk_bf16_f32 v85, v74, v75
    v_cvt_pk_bf16_f32 v86, v76, v77
    v_cvt_pk_bf16_f32 v87, v78, v79
    v_cndmask_b32 v86, v86, 0, s[38:39]
    v_cndmask_b32 v87, v87, 0, s[38:39]
    buffer_store_dwordx4 v[84:87], v209, s[8:11], s29 offen offset:1024 sc1
    v_add_f32 v219, abs(v48), abs(v49)
    v_add_f32 v219, v219, abs(v50)
    v_add_f32 v219, v219, abs(v51)
    v_add_f32 v219, v219, abs(v52)
    v_add_f32 v219, v219, abs(v53)
    v_add_f32 v219, v219, abs(v54)
    v_add_f32 v219, v219, abs(v55)
    v_add_f32 v219, v219, abs(v56)
    v_add_f32 v219, v219, abs(v57)
    v_add_f32 v219, v219, abs(v58)
    v_add_f32 v219, v219, abs(v59)
    v_add_f32 v219, v219, abs(v60)
    v_add_f32 v219, v219, abs(v61)
    v_add_f32 v219, v219, abs(v62)
    v_add_f32 v219, v219, abs(v63)
    v_cmp_nle_f32 vcc, 0x21800000, v217
    s_nop 1
    s_mov_b64 s[36:37], vcc
    v_cmp_nge_f32 vcc, 0x5d800000, v217
    s_nop 1
    s_or_b64 s[36:37], s[36:37], vcc
    v_cmp_nge_f32 vcc, 0x7b800000, v219
    s_nop 1
    s_or_b64 s[36:37], s[36:37], vcc
    s_cselect_b32 s35, 0, 1
    s_or_b32 s35, s35, s33
    s_mov_b32 s57, s35
k2_apart:
    s_barrier
    s_lshr_b32 s54, s20, 1
    s_and_b32 s55, s20, 1
    v_lshrrev_b32 v222, 5, v208
    v_bfe_u32 v223, v208, 2, 2
    v_bfe_u32 v224, v208, 4, 1
    v_lshlrev_b32 v224, 5, v224
    v_and_b32 v225, 3, v208
    v_lshl_add_u32 v224, v225, 3, v224
    v_lshl_add_u32 v224, v223, 7, v224
    v_lshrrev_b32 v223, 1, v223
    v_lshl_add_u32 v224, v223, 6, v224
    s_lshl_b32 s25, s55, 6
    v_xor_b32 v229, s25, v224
    v_lshl_add_u32 v229, v222, 10, v229
    s_mul_i32 s26, s54, 28672
    s_add_u32 s25, s26, 57344
    v_add_u32 v229, s25, v229
    s_lshl_b32 s25, s54, 10
    s_add_u32 s25, s25, s26
    v_add_u32 v230, s25, v209
    v_xor_b32 v231, 1024, v230
    s_lshl_b32 s25, s52, 1
    s_add_u32 s56, s25, s55
    s_mul_i32 s25, s56, 32896
    s_add_u32 s25, s25, 6321152
    buffer_load_dword v228, v221, s[8:11], s25 offen sc1
    s_lshl_b32 s25, s54, 6
    v_xor_b32 v232, s25, v224
    v_lshl_add_u32 v232, v222, 9, v232
    s_mul_i32 s25, s54, 28672
    s_add_u32 s25, s25, 106496
    v_add_u32 v232, s25, v232
    v_xor_b32 v233, 64, v232
    s_lshl_b32 s25, s20, 12
    v_add_u32 v235, s25, v209
    v_xor_b32 v236, 8192, v235
    s_lshl_b32 s25, s56, 1
    s_add_u32 s25, s25, s54
    s_lshl_b32 s25, s25, 14
    s_add_u32 s61, s25, 11010048
    v_lshrrev_b32 v215, 2, v221
    v_mul_u32_u24 v234, 57344, v215
    v_lshl_add_u32 v234, v222, 4, v234
    s_mul_i32 s62, s56, 896
    s_lshl_b32 s25, s53, 7
    s_add_u32 s62, s62, s25
    s_lshl_b32 s25, s54, 6
    s_add_u32 s62, s62, s25
    s_mov_b32 s50, 1835008
    s_mov_b32 s51, 0x20000
    s_cmp_eq_u32 s57, 0
    v_mov_b32 v216, 0
    s_waitcnt vmcnt(0)
    s_cbranch_scc1 k2_np0
    s_mov_b64 exec, 1
    buffer_store_dwordx2 v[240:241], v216, s[8:11], s32 offen sc1
    s_mov_b64 exec, -1
k2_np0:
k2_pub:
    v_mov_b32 v217, s35
    ds_write_b32 v226, v217
k2_chk:
    v_mov_b32 v220, 163712
    s_waitcnt lgkmcnt(0)
    s_barrier
    ds_read_b128 v[216:219], v220
    s_waitcnt lgkmcnt(0)
    s_barrier
    v_and_b32 v216, v216, v217
    v_and_b32 v218, v218, v219
    v_and_b32 v216, v216, v218
    s_nop 0
    v_readfirstlane_b32 s25, v216
    s_nop 1
    s_cmp_eq_u32 s25, 0
    s_cbranch_scc1 k2_fail
k2_p3:
    s_cmp_ge_u32 s2, 224
    s_cbranch_scc1 k2_end
    s_cmp_ge_u32 s20, 4
    s_cbranch_scc1 k2_auxp3
    ds_read_b64_tr_b16 v[32:33], v229 offset:0
    ds_read_b64_tr_b16 v[34:35], v229 offset:512
    ds_read_b128 v[36:39], v230 offset:0
    ds_read_b128 v[40:43], v231 offset:0
    ds_read_b64_tr_b16 v[44:45], v229 offset:2048
    ds_read_b64_tr_b16 v[46:47], v229 offset:2560
    ds_read_b128 v[48:51], v230 offset:2048
    ds_read_b128 v[52:55], v231 offset:2048
    ds_read_b64_tr_b16 v[56:57], v229 offset:4096
    ds_read_b64_tr_b16 v[58:59], v229 offset:4608
    ds_read_b128 v[60:63], v230 offset:4096
    ds_read_b128 v[64:67], v231 offset:4096
    v_mul_f32 v228, 0xbfb8aa3b, v228
    v_exp_f32 v228, v228
    s_nop 0
    v_add_f32 v228, 1.0, v228
    v_rcp_f32 v228, v228
    s_nop 0
    v_sub_f32 v238, 1.0, v228
    s_waitcnt lgkmcnt(8)
    v_mfma_f32_32x32x16_bf16 v[0:15], v[36:39], v[32:35], 0
    ds_read_b64_tr_b16 v[68:69], v229 offset:6144
    ds_read_b64_tr_b16 v[70:71], v229 offset:6656
    v_mfma_f32_32x32x16_bf16 v[16:31], v[40:43], v[32:35], 0
    ds_read_b128 v[72:75], v230 offset:6144
    ds_read_b128 v[76:79], v231 offset:6144
    s_waitcnt lgkmcnt(8)
    v_mfma_f32_32x32x16_bf16 v[0:15], v[48:51], v[44:47], v[0:15]
    ds_read_b64_tr_b16 v[32:33], v229 offset:8192
    ds_read_b64_tr_b16 v[34:35], v229 offset:8704
    v_mfma_f32_32x32x16_bf16 v[16:31], v[52:55], v[44:47], v[16:31]
    ds_read_b128 v[36:39], v230 offset:8192
    ds_read_b128 v[40:43], v231 offset:8192
    s_waitcnt lgkmcnt(8)
    v_mfma_f32_32x32x16_bf16 v[0:15], v[60:63], v[56:59], v[0:15]
    ds_read_b64_tr_b16 v[44:45], v229 offset:10240
    ds_read_b64_tr_b16 v[46:47], v229 offset:10752
    v_mfma_f32_32x32x16_bf16 v[16:31], v[64:67], v[56:59], v[16:31]
    ds_read_b128 v[48:51], v230 offset:10240
    ds_read_b128 v[52:55], v231 offset:10240
    s_waitcnt lgkmcnt(8)
    v_mfma_f32_32x32x16_bf16 v[0:15], v[72:75], v[68:71], v[0:15]
    ds_read_b64_tr_b16 v[56:57], v229 offset:12288
    ds_read_b64_tr_b16 v[58:59], v229 offset:12800
    v_mfma_f32_32x32x16_bf16 v[16:31], v[76:79], v[68:71], v[16:31]
    ds_read_b128 v[60:63], v230 offset:12288
    ds_read_b128 v[64:67], v231 offset:12288
    s_waitcnt lgkmcnt(8)
    v_mfma_f32_32x32x16_bf16 v[0:15], v[36:39], v[32:35], v[0:15]
    ds_read_b64_tr_b16 v[68:69], v229 offset:14336
    ds_read_b64_tr_b16 v[70:71], v229 offset:14848
    v_mfma_f32_32x32x16_bf16 v[16:31], v[40:43], v[32:35], v[16:31]
    ds_read_b128 v[72:75], v230 offset:14336
    ds_read_b128 v[76:79], v231 offset:14336
    s_waitcnt lgkmcnt(8)
    v_mfma_f32_32x32x16_bf16 v[0:15], v[48:51], v[44:47], v[0:15]
    ds_read_b64_tr_b16 v[32:33], v229 offset:16384
    ds_read_b64_tr_b16 v[34:35], v229 offset:16896
    v_mfma_f32_32x32x16_bf16 v[16:31], v[52:55], v[44:47], v[16:31]
    ds_read_b128 v[36:39], v230 offset:16384
    ds_read_b128 v[40:43], v231 offset:16384
    s_waitcnt lgkmcnt(8)
    v_mfma_f32_32x32x16_bf16 v[0:15], v[60:63], v[56:59], v[0:15]
    ds_read_b64_tr_b16 v[44:45], v229 offset:18432
    ds_read_b64_tr_b16 v[46:47], v229 offset:18944
    v_mfma_f32_32x32x16_bf16 v[16:31], v[64:67], v[56:59], v[16:31]
    ds_read_b128 v[48:51], v230 offset:18432
    ds_read_b128 v[52:55], v231 offset:18432
    s_waitcnt lgkmcnt(8)
    v_mfma_f32_32x32x16_bf16 v[0:15], v[72:75], v[68:71], v[0:15]
    ds_read_b64_tr_b16 v[56:57], v229 offset:20480
    ds_read_b64_tr_b16 v[58:59], v229 offset:20992
    v_mfma_f32_32x32x16_bf16 v[16:31], v[76:79], v[68:71], v[16:31]
    ds_read_b128 v[60:63], v230 offset:20480
    ds_read_b128 v[64:67], v231 offset:20480
    s_waitcnt lgkmcnt(8)
    v_mfma_f32_32x32x16_bf16 v[0:15], v[36:39], v[32:35], v[0:15]
    ds_read_b64_tr_b16 v[68:69], v229 offset:22528
    ds_read_b64_tr_b16 v[70:71], v229 offset:23040
    v_mfma_f32_32x32x16_bf16 v[16:31], v[40:43], v[32:35], v[16:31]
    ds_read_b128 v[72:75], v230 offset:22528
    ds_read_b128 v[76:79], v231 offset:22528
    s_waitcnt lgkmcnt(8)
    v_mfma_f32_32x32x16_bf16 v[0:15], v[48:51], v[44:47], v[0:15]
    ds_read_b64_tr_b16 v[32:33], v229 offset:24576
    ds_read_b64_tr_b16 v[34:35], v229 offset:25088
    v_mfma_f32_32x32x16_bf16 v[16:31], v[52:55], v[44:47], v[16:31]
    ds_read_b128 v[36:39], v230 offset:24576
    ds_read_b128 v[40:43], v231 offset:24576
    s_waitcnt lgkmcnt(8)
    v_mfma_f32_32x32x16_bf16 v[0:15], v[60:63], v[56:59], v[0:15]
    ds_read_b64_tr_b16 v[44:45], v229 offset:26624
    ds_read_b64_tr_b16 v[46:47], v229 offset:27136
    v_mfma_f32_32x32x16_bf16 v[16:31], v[64:67], v[56:59], v[16:31]
    ds_read_b128 v[48:51], v230 offset:26624
    ds_read_b128 v[52:55], v231 offset:26624
    s_waitcnt lgkmcnt(8)
    v_mfma_f32_32x32x16_bf16 v[0:15], v[72:75], v[68:71], v[0:15]
    v_mfma_f32_32x32x16_bf16 v[16:31], v[76:79], v[68:71], v[16:31]
    s_waitcnt lgkmcnt(4)
    v_mfma_f32_32x32x16_bf16 v[0:15], v[36:39], v[32:35], v[0:15]
    v_mfma_f32_32x32x16_bf16 v[16:31], v[40:43], v[32:35], v[16:31]
    s_waitcnt lgkmcnt(0)
    v_mfma_f32_32x32x16_bf16 v[0:15], v[48:51], v[44:47], v[0:15]
    v_mfma_f32_32x32x16_bf16 v[16:31], v[52:55], v[44:47], v[16:31]
    s_barrier
    s_add_u32 s28, s61, 4096
    buffer_load_dwordx4 v[160:163], v209, s[8:11], s28 offen offset:2048 sc1
    buffer_load_dwordx4 v[164:167], v209, s[8:11], s28 offen offset:3072 sc1
    s_add_u32 s28, s61, 8192
    buffer_load_dwordx4 v[168:171], v209, s[8:11], s28 offen offset:0 sc1
    buffer_load_dwordx4 v[172:175], v209, s[8:11], s28 offen offset:1024 sc1
    buffer_load_dwordx4 v[176:179], v209, s[8:11], s28 offen offset:2048 sc1
    buffer_load_dwordx4 v[180:183], v209, s[8:11], s28 offen offset:3072 sc1
    s_add_u32 s28, s61, 12288
    buffer_load_dwordx4 v[184:187], v209, s[8:11], s28 offen offset:0 sc1
    buffer_load_dwordx4 v[188:191], v209, s[8:11], s28 offen offset:1024 sc1
    buffer_load_dwordx4 v[192:195], v209, s[8:11], s28 offen offset:2048 sc1
    buffer_load_dwordx4 v[196:199], v209, s[8:11], s28 offen offset:3072 sc1
    ds_read_b64_tr_b16 v[60:61], v232 offset:10752
    ds_read_b64_tr_b16 v[62:63], v232 offset:11776
    ds_read_b64_tr_b16 v[64:65], v233 offset:10752
    ds_read_b64_tr_b16 v[66:67], v233 offset:11776
    ds_read_b64_tr_b16 v[72:73], v232 offset:12800
    ds_read_b64_tr_b16 v[74:75], v232 offset:13824
    ds_read_b64_tr_b16 v[76:77], v233 offset:12800
    ds_read_b64_tr_b16 v[78:79], v233 offset:13824
    ds_read_b64_tr_b16 v[36:37], v232 offset:14336
    ds_read_b64_tr_b16 v[38:39], v232 offset:15360
    ds_read_b64_tr_b16 v[40:41], v233 offset:14336
    ds_read_b64_tr_b16 v[42:43], v233 offset:15360
    s_lshl_b32 s25, s55, 12
    s_add_u32 s25, s25, 16384
    v_and_b32 v212, 31, v208
    v_lshl_add_u32 v213, s54, 2, v222
    v_and_b32 v217, 7, v208
    v_xor_b32 v213, v213, v217
    v_lshlrev_b32 v213, 4, v213
    v_lshl_add_u32 v214, v212, 7, v213
    v_add_u32 v214, s25, v214
    v_xor_b32 v215, 32, v214
    v_lshrrev_b32 v212, 3, v208
    v_xor_b32 v213, v212, v217
    v_lshlrev_b32 v213, 4, v213
    v_lshl_add_u32 v216, v212, 7, v213
    s_lshl_b32 s26, s54, 11
    s_add_u32 s25, s25, s26
    v_add_u32 v216, s25, v216
    v_mul_u32_u24 v234, 57344, v212
    v_lshl_add_u32 v234, v217, 4, v234
    s_mul_i32 s25, s54, 917440
    s_add_u32 s62, s62, s25
    v_mul_f32 v0, v228, v0
    v_mul_f32 v1, v228, v1
    v_mul_f32 v2, v228, v2
    v_mul_f32 v3, v228, v3
    v_mul_f32 v4, v228, v4
    v_mul_f32 v5, v228, v5
    v_mul_f32 v6, v228, v6
    v_mul_f32 v7, v228, v7
    v_mul_f32 v8, v228, v8
    v_mul_f32 v9, v228, v9
    v_mul_f32 v10, v228, v10
    v_mul_f32 v11, v228, v11
    v_mul_f32 v12, v228, v12
    v_mul_f32 v13, v228, v13
    v_mul_f32 v14, v228, v14
    v_mul_f32 v15, v228, v15
    v_mul_f32 v16, v228, v16
    v_mul_f32 v17, v228, v17
    v_mul_f32 v18, v228, v18
    v_mul_f32 v19, v228, v19
    v_mul_f32 v20, v228, v20
    v_mul_f32 v21, v228, v21
    v_mul_f32 v22, v228, v22
    v_mul_f32 v23, v228, v23
    v_mul_f32 v24, v228, v24
    v_mul_f32 v25, v228, v25
    v_mul_f32 v26, v228, v26
    v_mul_f32 v27, v228, v27
    v_mul_f32 v28, v228, v28
    v_mul_f32 v29, v228, v29
    v_mul_f32 v30, v228, v30
    v_mul_f32 v31, v228, v31
    s_add_u32 s28, s61, 0
    buffer_load_dwordx4 v[200:203], v209, s[8:11], s28 offen offset:0 sc1
    s_waitcnt vmcnt(10) lgkmcnt(8)
    v_mfma_f32_32x32x16_bf16 v[112:127], v[64:67], v[160:163], 0
    ds_read_b64_tr_b16 v[48:49], v232 offset:16384
    ds_read_b64_tr_b16 v[50:51], v232 offset:17408
    v_mfma_f32_32x32x16_bf16 v[96:111], v[60:63], v[160:163], 0
    ds_read_b64_tr_b16 v[52:53], v233 offset:16384
    ds_read_b64_tr_b16 v[54:55], v233 offset:17408
    buffer_load_dwordx4 v[204:207], v209, s[8:11], s28 offen offset:1024 sc1
    s_waitcnt vmcnt(10) lgkmcnt(8)
    v_mfma_f32_32x32x16_bf16 v[112:127], v[76:79], v[164:167], v[112:127]
    ds_read_b64_tr_b16 v[60:61], v232 offset:17920
    ds_read_b64_tr_b16 v[62:63], v232 offset:18944
    v_mfma_f32_32x32x16_bf16 v[96:111], v[72:75], v[164:167], v[96:111]
    ds_read_b64_tr_b16 v[64:65], v233 offset:17920
    ds_read_b64_tr_b16 v[66:67], v233 offset:18944
    buffer_load_dwordx4 v[128:131], v209, s[8:11], s28 offen offset:2048 sc1
    s_waitcnt vmcnt(10) lgkmcnt(8)
    v_mfma_f32_32x32x16_bf16 v[112:127], v[40:43], v[168:171], v[112:127]
    ds_read_b64_tr_b16 v[72:73], v232 offset:19968
    ds_read_b64_tr_b16 v[74:75], v232 offset:20992
    v_mfma_f32_32x32x16_bf16 v[96:111], v[36:39], v[168:171], v[96:111]
    ds_read_b64_tr_b16 v[76:77], v233 offset:19968
    ds_read_b64_tr_b16 v[78:79], v233 offset:20992
    buffer_load_dwordx4 v[132:135], v209, s[8:11], s28 offen offset:3072 sc1
    s_waitcnt vmcnt(10) lgkmcnt(8)
    v_mfma_f32_32x32x16_bf16 v[112:127], v[52:55], v[172:175], v[112:127]
    ds_read_b64_tr_b16 v[36:37], v232 offset:21504
    ds_read_b64_tr_b16 v[38:39], v232 offset:22528
    v_mfma_f32_32x32x16_bf16 v[96:111], v[48:51], v[172:175], v[96:111]
    ds_read_b64_tr_b16 v[40:41], v233 offset:21504
    ds_read_b64_tr_b16 v[42:43], v233 offset:22528
    s_add_u32 s28, s61, 4096
    buffer_load_dwordx4 v[136:139], v209, s[8:11], s28 offen offset:0 sc1
    s_waitcnt vmcnt(10) lgkmcnt(8)
    v_mfma_f32_32x32x16_bf16 v[112:127], v[64:67], v[176:179], v[112:127]
    ds_read_b64_tr_b16 v[48:49], v232 offset:23552
    ds_read_b64_tr_b16 v[50:51], v232 offset:24576
    v_mfma_f32_32x32x16_bf16 v[96:111], v[60:63], v[176:179], v[96:111]
    ds_read_b64_tr_b16 v[52:53], v233 offset:23552
    ds_read_b64_tr_b16 v[54:55], v233 offset:24576
    buffer_load_dwordx4 v[140:143], v209, s[8:11], s28 offen offset:1024 sc1
    s_waitcnt vmcnt(10) lgkmcnt(8)
    v_mfma_f32_32x32x16_bf16 v[112:127], v[76:79], v[180:183], v[112:127]
    ds_read_b64_tr_b16 v[60:61], v232 offset:25088
    ds_read_b64_tr_b16 v[62:63], v232 offset:26112
    v_mfma_f32_32x32x16_bf16 v[96:111], v[72:75], v[180:183], v[96:111]
    ds_read_b64_tr_b16 v[64:65], v233 offset:25088
    ds_read_b64_tr_b16 v[66:67], v233 offset:26112
    s_waitcnt vmcnt(9) lgkmcnt(8)
    v_mfma_f32_32x32x16_bf16 v[112:127], v[40:43], v[184:187], v[112:127]
    ds_read_b64_tr_b16 v[72:73], v232 offset:27136
    ds_read_b64_tr_b16 v[74:75], v232 offset:28160
    v_mfma_f32_32x32x16_bf16 v[96:111], v[36:39], v[184:187], v[96:111]
    ds_read_b64_tr_b16 v[76:77], v233 offset:27136
    ds_read_b64_tr_b16 v[78:79], v233 offset:28160
    s_barrier
    s_waitcnt vmcnt(8) lgkmcnt(8)
    v_mfma_f32_32x32x16_bf16 v[112:127], v[52:55], v[188:191], v[112:127]
    ds_read_b64_tr_b16 v[36:37], v232 offset:0
    ds_read_b64_tr_b16 v[38:39], v232 offset:1024
    v_mfma_f32_32x32x16_bf16 v[96:111], v[48:51], v[188:191], v[96:111]
    ds_read_b64_tr_b16 v[40:41], v233 offset:0
    ds_read_b64_tr_b16 v[42:43], v233 offset:1024
    s_waitcnt vmcnt(7) lgkmcnt(8)
    v_mfma_f32_32x32x16_bf16 v[112:127], v[64:67], v[192:195], v[112:127]
    ds_read_b64_tr_b16 v[48:49], v232 offset:2048
    ds_read_b64_tr_b16 v[50:51], v232 offset:3072
    v_mfma_f32_32x32x16_bf16 v[96:111], v[60:63], v[192:195], v[96:111]
    ds_read_b64_tr_b16 v[52:53], v233 offset:2048
    ds_read_b64_tr_b16 v[54:55], v233 offset:3072
    s_waitcnt vmcnt(6) lgkmcnt(8)
    v_mfma_f32_32x32x16_bf16 v[112:127], v[76:79], v[196:199], v[112:127]
    ds_read_b64_tr_b16 v[60:61], v232 offset:3584
    ds_read_b64_tr_b16 v[62:63], v232 offset:4608
    v_mfma_f32_32x32x16_bf16 v[96:111], v[72:75], v[196:199], v[96:111]
    ds_read_b64_tr_b16 v[64:65], v233 offset:3584
    ds_read_b64_tr_b16 v[66:67], v233 offset:4608
    s_waitcnt vmcnt(5) lgkmcnt(8)
    v_mfma_f32_32x32x16_bf16 v[112:127], v[40:43], v[200:203], v[112:127]
    ds_read_b64_tr_b16 v[72:73], v232 offset:5632
    ds_read_b64_tr_b16 v[74:75], v232 offset:6656
    v_mfma_f32_32x32x16_bf16 v[96:111], v[36:39], v[200:203], v[96:111]
    ds_read_b64_tr_b16 v[76:77], v233 offset:5632
    ds_read_b64_tr_b16 v[78:79], v233 offset:6656
    s_waitcnt vmcnt(4) lgkmcnt(8)
    v_mfma_f32_32x32x16_bf16 v[112:127], v[52:55], v[204:207], v[112:127]
    ds_read_b64_tr_b16 v[36:37], v232 offset:7168
    ds_read_b64_tr_b16 v[38:39], v232 offset:8192
    v_mfma_f32_32x32x16_bf16 v[96:111], v[48:51], v[204:207], v[96:111]
    ds_read_b64_tr_b16 v[40:41], v233 offset:7168
    ds_read_b64_tr_b16 v[42:43], v233 offset:8192
    s_waitcnt vmcnt(3) lgkmcnt(8)
    v_mfma_f32_32x32x16_bf16 v[112:127], v[64:67], v[128:131], v[112:127]
    ds_read_b64_tr_b16 v[48:49], v232 offset:9216
    ds_read_b64_tr_b16 v[50:51], v232 offset:10240
    ds_read_b64_tr_b16 v[52:53], v233 offset:9216
    ds_read_b64_tr_b16 v[54:55], v233 offset:10240
    s_waitcnt vmcnt(2) lgkmcnt(8)
    v_mfma_f32_32x32x16_bf16 v[112:127], v[76:79], v[132:135], v[112:127]
    s_waitcnt vmcnt(1) lgkmcnt(4)
    v_mfma_f32_32x32x16_bf16 v[112:127], v[40:43], v[136:139], v[112:127]
    s_waitcnt vmcnt(0) lgkmcnt(0)
    v_mfma_f32_32x32x16_bf16 v[112:127], v[52:55], v[140:143], v[112:127]
    v_mfma_f32_32x32x16_bf16 v[96:111], v[60:63], v[128:131], v[96:111]
    v_mfma_f32_32x32x16_bf16 v[96:111], v[72:75], v[132:135], v[96:111]
    s_nop 8
    s_nop 0
    v_fma_f32 v112, v238, v112, v16
    v_fma_f32 v113, v238, v113, v17
    v_fma_f32 v114, v238, v114, v18
    v_fma_f32 v115, v238, v115, v19
    v_mfma_f32_32x32x16_bf16 v[96:111], v[36:39], v[136:139], v[96:111]
    ds_write_b128 v235, v[112:115] offset:0
    v_fma_f32 v116, v238, v116, v20
    v_fma_f32 v117, v238, v117, v21
    v_fma_f32 v118, v238, v118, v22
    v_fma_f32 v119, v238, v119, v23
    v_mfma_f32_32x32x16_bf16 v[96:111], v[48:51], v[140:143], v[96:111]
    ds_write_b128 v235, v[116:119] offset:1024
    v_fma_f32 v120, v238, v120, v24
    v_fma_f32 v121, v238, v121, v25
    v_fma_f32 v122, v238, v122, v26
    v_fma_f32 v123, v238, v123, v27
    ds_write_b128 v235, v[120:123] offset:2048
    v_fma_f32 v124, v238, v124, v28
    v_fma_f32 v125, v238, v125, v29
    v_fma_f32 v126, v238, v126, v30
    v_fma_f32 v127, v238, v127, v31
    ds_write_b128 v235, v[124:127] offset:3072
    s_waitcnt lgkmcnt(0)
    s_barrier
    ds_read_b128 v[16:19], v236 offset:0
    ds_read_b128 v[20:23], v236 offset:1024
    ds_read_b128 v[24:27], v236 offset:2048
    ds_read_b128 v[28:31], v236 offset:3072
    v_fma_f32 v96, v238, v96, v0
    v_fma_f32 v97, v238, v97, v1
    v_fma_f32 v98, v238, v98, v2
    v_fma_f32 v99, v238, v99, v3
    v_fma_f32 v100, v238, v100, v4
    v_fma_f32 v101, v238, v101, v5
    v_fma_f32 v102, v238, v102, v6
    v_fma_f32 v103, v238, v103, v7
    v_fma_f32 v104, v238, v104, v8
    v_fma_f32 v105, v238, v105, v9
    v_fma_f32 v106, v238, v106, v10
    v_fma_f32 v107, v238, v107, v11
    v_fma_f32 v108, v238, v108, v12
    v_fma_f32 v109, v238, v109, v13
    v_fma_f32 v110, v238, v110, v14
    v_fma_f32 v111, v238, v111, v15
    s_waitcnt lgkmcnt(3)
    v_add_f32 v96, v96, v16
    v_add_f32 v97, v97, v17
    v_add_f32 v98, v98, v18
    v_add_f32 v99, v99, v19
    v_cvt_pk_bf16_f32 v32, v96, v97
    v_cvt_pk_bf16_f32 v33, v98, v99
    s_waitcnt lgkmcnt(2)
    v_add_f32 v100, v100, v20
    v_add_f32 v101, v101, v21
    v_add_f32 v102, v102, v22
    v_add_f32 v103, v103, v23
    v_cvt_pk_bf16_f32 v34, v100, v101
    v_cvt_pk_bf16_f32 v35, v102, v103
    s_nop 0
    v_permlane32_swap_b32 v32, v34
    v_permlane32_swap_b32 v33, v35
    ds_write_b128 v214, v[32:35]
    s_waitcnt lgkmcnt(1)
    v_add_f32 v104, v104, v24
    v_add_f32 v105, v105, v25
    v_add_f32 v106, v106, v26
    v_add_f32 v107, v107, v27
    v_cvt_pk_bf16_f32 v36, v104, v105
    v_cvt_pk_bf16_f32 v37, v106, v107
    s_waitcnt lgkmcnt(0)
    v_add_f32 v108, v108, v28
    v_add_f32 v109, v109, v29
    v_add_f32 v110, v110, v30
    v_add_f32 v111, v111, v31
    v_cvt_pk_bf16_f32 v38, v108, v109
    v_cvt_pk_bf16_f32 v39, v110, v111
    s_nop 0
    v_permlane32_swap_b32 v36, v38
    v_permlane32_swap_b32 v37, v39
    ds_write_b128 v215, v[36:39]
    s_waitcnt lgkmcnt(0)
    s_barrier
    ds_read_b128 v[40:43], v216 offset:0
    ds_read_b128 v[44:47], v216 offset:1024
    s_add_u32 s25, s62, 458752
    s_waitcnt lgkmcnt(1)
    buffer_store_dwordx4 v[40:43], v234, s[48:51], s62 offen sc1
    s_waitcnt lgkmcnt(0)
    buffer_store_dwordx4 v[44:47], v234, s[48:51], s25 offen sc1
    s_endpgm
k2_fail:
    s_cmp_ge_u32 s20, 4
    s_cbranch_scc1 k2_auxfb
    s_branch k2_fb
k2_pb0:
    s_mov_b32 s26, 200000
    s_mov_b32 s25, 15335424
k2_pb:
    buffer_load_dwordx2 v[222:223], v224, s[8:11], s25 offen sc1
    s_waitcnt vmcnt(0)
    v_cmp_eq_u64 vcc, s[6:7], v[222:223]
    s_nop 1
    s_cmp_eq_u64 vcc, -1
    s_cbranch_scc1 k2_loop
    s_sub_u32 s26, s26, 1
    s_sleep 2
    s_cmp_lg_u32 s26, 0
    s_cbranch_scc1 k2_pb
    s_branch k2_loop
k2_fb:
    s_mov_b32 s33, 1
    s_waitcnt vmcnt(0)
    s_barrier
    v_mov_b32 v0, 0xff800000
    v_mov_b32 v1, 0xff800000
    v_mov_b32 v2, 0xff800000
    v_mov_b32 v3, 0xff800000
    s_mov_b32 s29, s34
    s_add_u32 s26, s34, 6144
    s_mov_b32 s28, s27
k2_maxloop:
    buffer_load_dwordx4 v[160:163], v209, s[8:11], s29 offen offset:0 sc1
    buffer_load_dwordx4 v[164:167], v209, s[8:11], s29 offen offset:1024 sc1
    s_waitcnt vmcnt(0)
    v_mfma_f32_32x32x16_bf16 v[64:79], v[160:163], v[128:131], 0
    v_mfma_f32_32x32x16_bf16 v[64:79], v[164:167], v[132:135], v[64:79]
    v_mfma_f32_32x32x16_bf16 v[80:95], v[160:163], v[136:139], 0
    v_mfma_f32_32x32x16_bf16 v[80:95], v[164:167], v[140:143], v[80:95]
    v_mfma_f32_32x32x16_bf16 v[96:111], v[160:163], v[144:147], 0
    v_mfma_f32_32x32x16_bf16 v[96:111], v[164:167], v[148:151], v[96:111]
    v_mfma_f32_32x32x16_bf16 v[112:127], v[160:163], v[152:155], 0
    v_mfma_f32_32x32x16_bf16 v[112:127], v[164:167], v[156:159], v[112:127]
    s_nop 15
    v_max3_f32 v0, v0, v64, v65
    v_max3_f32 v0, v0, v66, v67
    v_max3_f32 v0, v0, v68, v69
    v_max3_f32 v0, v0, v70, v71
    v_max3_f32 v0, v0, v72, v73
    v_max3_f32 v0, v0, v74, v75
    v_max3_f32 v0, v0, v76, v77
    v_max3_f32 v0, v0, v78, v79
    v_max3_f32 v1, v1, v80, v81
    v_max3_f32 v1, v1, v82, v83
    v_max3_f32 v1, v1, v84, v85
    v_max3_f32 v1, v1, v86, v87
    v_max3_f32 v1, v1, v88, v89
    v_max3_f32 v1, v1, v90, v91
    v_max3_f32 v1, v1, v92, v93
    v_max3_f32 v1, v1, v94, v95
    v_max3_f32 v2, v2, v96, v97
    v_max3_f32 v2, v2, v98, v99
    v_max3_f32 v2, v2, v100, v101
    v_max3_f32 v2, v2, v102, v103
    v_max3_f32 v2, v2, v104, v105
    v_max3_f32 v2, v2, v106, v107
    v_max3_f32 v2, v2, v108, v109
    v_max3_f32 v2, v2, v110, v111
    v_max3_f32 v3, v3, v112, v113
    v_max3_f32 v3, v3, v114, v115
    v_max3_f32 v3, v3, v116, v117
    v_max3_f32 v3, v3, v118, v119
    v_max3_f32 v3, v3, v120, v121
    v_max3_f32 v3, v3, v122, v123
    v_max3_f32 v3, v3, v124, v125
    v_max3_f32 v3, v3, v126, v127
    s_add_u32 s29, s29, 2048
    s_cmp_eq_u32 s29, s26
    s_cselect_b32 s29, s58, s29
    s_cselect_b32 s26, 0, s26
    s_sub_u32 s28, s28, 1
    s_cmp_lg_u32 s28, 0
    s_cbranch_scc1 k2_maxloop
    s_lshl_b32 s25, s20, 8
    s_add_u32 s25, s25, 114688
    v_lshl_add_u32 v212, v208, 2, s25
    v_and_b32 v213, 31, v208
    v_lshlrev_b32 v213, 2, v213
    v_add_u32 v213, 114688, v213
    s_lshl_b32 s25, s40, 10
    v_add_u32 v214, s25, v212
    v_add_u32 v216, s25, v213
    ds_write_b32 v214, v0
    s_lshl_b32 s25, s41, 10
    v_add_u32 v214, s25, v212
    v_add_u32 v217, s25, v213
    ds_write_b32 v214, v1
    s_lshl_b32 s25, s42, 10
    v_add_u32 v214, s25, v212
    v_add_u32 v218, s25, v213
    ds_write_b32 v214, v2
    s_lshl_b32 s25, s43, 10
    v_add_u32 v214, s25, v212
    v_add_u32 v219, s25, v213
    ds_write_b32 v214, v3
    s_waitcnt lgkmcnt(0)
    s_barrier
    ds_read_b32 v64, v216 offset:0
    ds_read_b32 v65, v216 offset:128
    ds_read_b32 v66, v216 offset:256
    ds_read_b32 v67, v216 offset:384
    ds_read_b32 v68, v216 offset:512
    ds_read_b32 v69, v216 offset:640
    ds_read_b32 v70, v216 offset:768
    ds_read_b32 v71, v216 offset:896
    s_waitcnt lgkmcnt(0)
    ds_read_b32 v72, v217 offset:0
    ds_read_b32 v73, v217 offset:128
    ds_read_b32 v74, v217 offset:256
    ds_read_b32 v75, v217 offset:384
    ds_read_b32 v76, v217 offset:512
    ds_read_b32 v77, v217 offset:640
    ds_read_b32 v78, v217 offset:768
    ds_read_b32 v79, v217 offset:896
    s_waitcnt lgkmcnt(0)
    ds_read_b32 v80, v218 offset:0
    ds_read_b32 v81, v218 offset:128
    ds_read_b32 v82, v218 offset:256
    ds_read_b32 v83, v218 offset:384
    ds_read_b32 v84, v218 offset:512
    ds_read_b32 v85, v218 offset:640
    ds_read_b32 v86, v218 offset:768
    ds_read_b32 v87, v218 offset:896
    s_waitcnt lgkmcnt(0)
    ds_read_b32 v88, v219 offset:0
    ds_read_b32 v89, v219 offset:128
    ds_read_b32 v90, v219 offset:256
    ds_read_b32 v91, v219 offset:384
    ds_read_b32 v92, v219 offset:512
    ds_read_b32 v93, v219 offset:640
    ds_read_b32 v94, v219 offset:768
    ds_read_b32 v95, v219 offset:896
    s_waitcnt lgkmcnt(0)
    s_barrier
    v_cmp_lt_u32 vcc, 31, v208
    v_max3_f32 v64, v64, v65, v66
    v_max3_f32 v64, v64, v67, v68
    v_max3_f32 v64, v64, v69, v70
    v_max_f32 v64, v64, v71
    v_xor_b32 v64, 0x80000000, v64
    v_and_b32 v65, 0xffff0000, v64
    v_sub_f32 v66, v64, v65
    v_and_b32 v67, 0xffff0000, v66
    v_sub_f32 v68, v66, v67
    v_lshrrev_b32 v65, 16, v65
    v_or_b32 v65, v65, v67
    v_lshrrev_b32 v68, 16, v68
    v_cndmask_b32 v134, v134, v65, vcc
    v_cndmask_b32 v135, v135, v68, vcc
    v_max3_f32 v72, v72, v73, v74
    v_max3_f32 v72, v72, v75, v76
    v_max3_f32 v72, v72, v77, v78
    v_max_f32 v72, v72, v79
    v_xor_b32 v72, 0x80000000, v72
    v_and_b32 v73, 0xffff0000, v72
    v_sub_f32 v74, v72, v73
    v_and_b32 v75, 0xffff0000, v74
    v_sub_f32 v76, v74, v75
    v_lshrrev_b32 v73, 16, v73
    v_or_b32 v73, v73, v75
    v_lshrrev_b32 v76, 16, v76
    v_cndmask_b32 v142, v142, v73, vcc
    v_cndmask_b32 v143, v143, v76, vcc
    v_max3_f32 v80, v80, v81, v82
    v_max3_f32 v80, v80, v83, v84
    v_max3_f32 v80, v80, v85, v86
    v_max_f32 v80, v80, v87
    v_xor_b32 v80, 0x80000000, v80
    v_and_b32 v81, 0xffff0000, v80
    v_sub_f32 v82, v80, v81
    v_and_b32 v83, 0xffff0000, v82
    v_sub_f32 v84, v82, v83
    v_lshrrev_b32 v81, 16, v81
    v_or_b32 v81, v81, v83
    v_lshrrev_b32 v84, 16, v84
    v_cndmask_b32 v150, v150, v81, vcc
    v_cndmask_b32 v151, v151, v84, vcc
    v_max3_f32 v88, v88, v89, v90
    v_max3_f32 v88, v88, v91, v92
    v_max3_f32 v88, v88, v93, v94
    v_max_f32 v88, v88, v95
    v_xor_b32 v88, 0x80000000, v88
    v_and_b32 v89, 0xffff0000, v88
    v_sub_f32 v90, v88, v89
    v_and_b32 v91, 0xffff0000, v90
    v_sub_f32 v92, v90, v91
    v_lshrrev_b32 v89, 16, v89
    v_or_b32 v89, v89, v91
    v_lshrrev_b32 v92, 16, v92
    v_cndmask_b32 v158, v158, v89, vcc
    v_cndmask_b32 v159, v159, v92, vcc
    s_branch k2_pass
k2_aux:
    s_getpc_b64 s[40:41]
    s_add_u32 s40, s40, tab_small@rel32@lo+4
    s_addc_u32 s41, s41, tab_small@rel32@hi+12
    s_mov_b32 s42, 47104
    s_mov_b32 s43, 0x20000
    s_mov_b32 s14, 401408
    s_mov_b32 s15, 0x20000
    s_mul_i32 s27, s22, 28
    s_add_u32 s27, s27, s21
    s_cmp_eq_u32 s2, 224
    s_cselect_b32 s27, 224, s27
    v_lshrrev_b32 v244, 2, v208
    v_mul_u32_u24 v211, 16512, v244
    v_mul_u32_u24 v244, 32896, v244
    v_and_b32 v245, 3, v208
    v_lshl_add_u32 v210, v245, 4, v244
    v_lshl_add_u32 v211, v245, 4, v211
    s_lshr_b32 s25, s27, 5
    s_lshl_b32 s25, s25, 12
    s_and_b32 s26, s27, 31
    s_lshl_b32 s26, s26, 6
    s_add_u32 s25, s25, s26
    s_lshl_b32 s29, s27, 6
    v_lshrrev_b32 v244, 5, v208
    v_bfe_u32 v245, v208, 2, 2
    v_lshl_add_u32 v244, v244, 2, v245
    v_lshlrev_b32 v244, 6, v244
    v_bfe_u32 v245, v208, 4, 1
    v_lshl_add_u32 v244, v245, 5, v244
    v_and_b32 v245, 3, v208
    v_lshl_add_u32 v244, v245, 3, v244
    v_add_u32 v244, 57344, v244
    s_cmp_eq_u32 s20, 5
    s_cbranch_scc1 k2_help
    s_mov_b32 s26, 0
    buffer_load_dwordx4 v[0:3], v209, s[40:43], s26 offen offset:0
    buffer_load_dwordx4 v[4:7], v209, s[40:43], s26 offen offset:1024
    buffer_load_dwordx4 v[8:11], v209, s[40:43], s26 offen offset:2048
    buffer_load_dwordx4 v[12:15], v209, s[40:43], s26 offen offset:3072
    s_mov_b32 s26, 8192
    buffer_load_dwordx4 v[16:19], v209, s[40:43], s26 offen offset:0
    buffer_load_dwordx4 v[20:23], v209, s[40:43], s26 offen offset:1024
    buffer_load_dwordx4 v[24:27], v209, s[40:43], s26 offen offset:2048
    buffer_load_dwordx4 v[28:31], v209, s[40:43], s26 offen offset:3072
    s_mov_b32 s26, 16384
    buffer_load_dwordx4 v[32:35], v209, s[40:43], s26 offen offset:0
    buffer_load_dwordx4 v[36:39], v209, s[40:43], s26 offen offset:1024
    buffer_load_dwordx4 v[40:43], v209, s[40:43], s26 offen offset:2048
    buffer_load_dwordx4 v[44:47], v209, s[40:43], s26 offen offset:3072
    s_mov_b32 s26, 4096
    buffer_load_dwordx4 v[48:51], v209, s[40:43], s26 offen offset:0
    buffer_load_dwordx4 v[52:55], v209, s[40:43], s26 offen offset:1024
    buffer_load_dwordx4 v[56:59], v209, s[40:43], s26 offen offset:2048
    buffer_load_dwordx4 v[60:63], v209, s[40:43], s26 offen offset:3072
    s_mov_b32 s26, 12288
    buffer_load_dwordx4 v[64:67], v209, s[40:43], s26 offen offset:0
    buffer_load_dwordx4 v[68:71], v209, s[40:43], s26 offen offset:1024
    buffer_load_dwordx4 v[72:75], v209, s[40:43], s26 offen offset:2048
    buffer_load_dwordx4 v[76:79], v209, s[40:43], s26 offen offset:3072
    s_mov_b32 s26, 20480
    buffer_load_dwordx4 v[80:83], v209, s[40:43], s26 offen offset:0
    buffer_load_dwordx4 v[84:87], v209, s[40:43], s26 offen offset:1024
    buffer_load_dwordx4 v[88:91], v209, s[40:43], s26 offen offset:2048
    buffer_load_dwordx4 v[92:95], v209, s[40:43], s26 offen offset:3072
    s_mov_b32 m0, 65536
    s_mov_b32 s26, 24576
    buffer_load_dwordx4 v209, s[40:43], s26 offen offset:0 lds
    buffer_load_dwordx4 v209, s[40:43], s26 offen offset:1024 lds
    buffer_load_dwordx4 v209, s[40:43], s26 offen offset:2048 lds
    buffer_load_dwordx4 v209, s[40:43], s26 offen offset:3072 lds
    s_mov_b32 m0, 69632
    s_mov_b32 s26, 28672
    buffer_load_dwordx4 v209, s[40:43], s26 offen offset:0 lds
    buffer_load_dwordx4 v209, s[40:43], s26 offen offset:1024 lds
    buffer_load_dwordx4 v209, s[40:43], s26 offen offset:2048 lds
    buffer_load_dwordx4 v209, s[40:43], s26 offen offset:3072 lds
    s_mov_b32 m0, 73728
    s_mov_b32 s26, 32768
    buffer_load_dwordx4 v209, s[40:43], s26 offen offset:0 lds
    buffer_load_dwordx4 v209, s[40:43], s26 offen offset:1024 lds
    buffer_load_dwordx4 v209, s[40:43], s26 offen offset:2048 lds
    buffer_load_dwordx4 v209, s[40:43], s26 offen offset:3072 lds
    s_mov_b32 m0, 77824
    s_mov_b32 s26, 36864
    buffer_load_dwordx4 v209, s[40:43], s26 offen offset:0 lds
    buffer_load_dwordx4 v209, s[40:43], s26 offen offset:1024 lds
    buffer_load_dwordx4 v209, s[40:43], s26 offen offset:2048 lds
    buffer_load_dwordx4 v209, s[40:43], s26 offen offset:3072 lds
    s_mov_b32 m0, 81920
    s_mov_b32 s26, 40960
    buffer_load_dwordx4 v209, s[40:43], s26 offen offset:0 lds
    buffer_load_dwordx4 v209, s[40:43], s26 offen offset:1024 lds
    buffer_load_dwordx4 v209, s[40:43], s26 offen offset:2048 lds
    buffer_load_dwordx4 v209, s[40:43], s26 offen offset:3072 lds
    s_mov_b32 m0, 86016
    s_mov_b32 s26, 45056
    buffer_load_dwordx4 v209, s[40:43], s26 offen offset:0 lds
    buffer_load_dwordx4 v209, s[40:43], s26 offen offset:1024 lds
    s_lshr_b32 s28, s27, 6
    s_add_u32 s28, s28, 12
    s_and_b32 s32, s28, 1
    v_bfe_u32 v100, v208, 1, 1
    v_xor_b32 v100, s32, v100
    v_lshrrev_b32 v101, 2, v208
    v_and_b32 v102, 1, v208
    v_mov_b32 v103, s28
    s_bfe_u32 s28, s27, 0x10005
    v_and_b32 v98, 7, v103
    v_lshlrev_b32 v98, 2, v98
    v_and_or_b32 v98, v101, 3, v98
    v_lshrrev_b32 v99, 2, v101
    v_lshl_add_u32 v98, v98, 2, v99
    v_lshrrev_b32 v99, 3, v103
    v_lshl_add_u32 v98, v98, 1, v99
    v_xor_b32 v99, 1, v100
    v_lshl_add_u32 v98, v98, 1, v99
    v_and_b32 v99, s28, v100
    v_lshl_add_u32 v98, v98, 1, v99
    v_lshl_add_u32 v98, v98, 1, v102
    v_lshlrev_b32 v98, 7, v98
    s_lshr_b32 s32, s27, 6
    s_lshl_b32 s32, s32, 10
    s_add_u32 s32, s32, 15335936
    v_lshlrev_b32 v100, 12, v208
    s_waitcnt lgkmcnt(0)
    s_barrier
    s_cmp_gt_u32 s2, 224
    s_cbranch_scc1 k2_auxb1
    s_mov_b32 s28, 200000
    s_mov_b32 s26, 15335424
k2_py:
    buffer_load_dwordx2 v[104:105], v98, s[8:11], s26 offen sc1
    buffer_load_dwordx2 v[106:107], v100, s[8:11], s32 offen sc1
    buffer_load_dwordx2 v[108:109], v100, s[8:11], s32 offen offset:128 sc1
    s_waitcnt vmcnt(0)
    v_cmp_ne_u64 vcc, s[6:7], v[104:105]
    v_cmp_ne_u64 s[36:37], s[6:7], v[106:107]
    v_cmp_ne_u64 s[38:39], s[6:7], v[108:109]
    s_nop 1
    s_or_b64 vcc, vcc, s[36:37]
    s_or_b64 vcc, vcc, s[38:39]
    s_and_b64 exec, exec, vcc
    s_cbranch_scc0 k2_py_done
    s_sub_u32 s28, s28, 1
    s_sleep 4
    s_cmp_gt_i32 s28, 0
    s_cbranch_scc1 k2_py
k2_py_done:
    s_mov_b64 exec, -1
    s_setprio 3
    s_mov_b32 m0, 57344
    s_add_u32 s26, s25, 6291456
    buffer_load_dwordx4 v210, s[8:11], s26 offen sc1 lds
    s_mov_b32 m0, 58368
    s_add_u32 s26, s25, 6817792
    buffer_load_dwordx4 v210, s[8:11], s26 offen sc1 lds
    s_mov_b32 m0, 59392
    s_add_u32 s26, s25, 7344128
    buffer_load_dwordx4 v210, s[8:11], s26 offen sc1 lds
    s_mov_b32 m0, 60416
    s_add_u32 s26, s25, 7870464
    buffer_load_dwordx4 v210, s[8:11], s26 offen sc1 lds
    s_mov_b32 m0, 61440
    s_add_u32 s26, s25, 6293504
    buffer_load_dwordx4 v210, s[8:11], s26 offen sc1 lds
    s_mov_b32 m0, 62464
    s_add_u32 s26, s25, 6819840
    buffer_load_dwordx4 v210, s[8:11], s26 offen sc1 lds
    s_mov_b32 m0, 63488
    s_add_u32 s26, s25, 7346176
    buffer_load_dwordx4 v210, s[8:11], s26 offen sc1 lds
    s_mov_b32 m0, 64512
    s_add_u32 s26, s25, 7872512
    buffer_load_dwordx4 v210, s[8:11], s26 offen sc1 lds
    s_add_u32 s26, s29, 8650752
    buffer_load_dwordx4 v[212:215], v211, s[8:11], s26 offen sc1
    s_add_u32 s26, s29, 8914944
    buffer_load_dwordx4 v[216:219], v211, s[8:11], s26 offen sc1
    s_add_u32 s26, s29, 9179136
    buffer_load_dwordx4 v[220:223], v211, s[8:11], s26 offen sc1
    s_add_u32 s26, s29, 9443328
    buffer_load_dwordx4 v[224:227], v211, s[8:11], s26 offen sc1
    s_add_u32 s26, s29, 9707520
    buffer_load_dwordx4 v[228:231], v211, s[8:11], s26 offen sc1
    s_add_u32 s26, s29, 9971712
    buffer_load_dwordx4 v[232:235], v211, s[8:11], s26 offen sc1
    s_add_u32 s26, s29, 10235904
    buffer_load_dwordx4 v[236:239], v211, s[8:11], s26 offen sc1
    s_add_u32 s26, s29, 10500096
    buffer_load_dwordx4 v[240:243], v211, s[8:11], s26 offen sc1
    s_waitcnt vmcnt(8)
    ds_read_b64_tr_b16 v[160:161], v244 offset:0
    ds_read_b64_tr_b16 v[162:163], v244 offset:512
    ds_read_b64_tr_b16 v[164:165], v244 offset:1024
    ds_read_b64_tr_b16 v[166:167], v244 offset:1536
    ds_read_b64_tr_b16 v[168:169], v244 offset:2048
    ds_read_b64_tr_b16 v[170:171], v244 offset:2560
    ds_read_b64_tr_b16 v[172:173], v244 offset:3072
    ds_read_b64_tr_b16 v[174:175], v244 offset:3584
    ds_read_b64_tr_b16 v[176:177], v244 offset:4096
    ds_read_b64_tr_b16 v[178:179], v244 offset:4608
    ds_read_b64_tr_b16 v[180:181], v244 offset:5120
    ds_read_b64_tr_b16 v[182:183], v244 offset:5632
    ds_read_b64_tr_b16 v[184:185], v244 offset:6144
    ds_read_b64_tr_b16 v[186:187], v244 offset:6656
    ds_read_b64_tr_b16 v[188:189], v244 offset:7168
    ds_read_b64_tr_b16 v[190:191], v244 offset:7680
    s_waitcnt lgkmcnt(0)
    v_mfma_f32_32x32x16_bf16 v[96:111], v[0:3], v[160:163], 0
    v_mfma_f32_32x32x16_bf16 v[112:127], v[0:3], v[176:179], 0
    v_mfma_f32_32x32x16_bf16 v[96:111], v[4:7], v[164:167], v[96:111]
    v_mfma_f32_32x32x16_bf16 v[112:127], v[4:7], v[180:183], v[112:127]
    v_mfma_f32_32x32x16_bf16 v[96:111], v[8:11], v[168:171], v[96:111]
    v_mfma_f32_32x32x16_bf16 v[112:127], v[8:11], v[184:187], v[112:127]
    v_mfma_f32_32x32x16_bf16 v[96:111], v[12:15], v[172:175], v[96:111]
    v_mfma_f32_32x32x16_bf16 v[112:127], v[12:15], v[188:191], v[112:127]
    v_mfma_f32_32x32x16_bf16 v[96:111], v[16:19], v[176:179], v[96:111]
    v_mfma_f32_32x32x16_bf16 v[112:127], v[32:35], v[160:163], v[112:127]
    v_mfma_f32_32x32x16_bf16 v[96:111], v[20:23], v[180:183], v[96:111]
    v_mfma_f32_32x32x16_bf16 v[112:127], v[36:39], v[164:167], v[112:127]
    v_mfma_f32_32x32x16_bf16 v[96:111], v[24:27], v[184:187], v[96:111]
    v_mfma_f32_32x32x16_bf16 v[112:127], v[40:43], v[168:171], v[112:127]
    v_mfma_f32_32x32x16_bf16 v[96:111], v[28:31], v[188:191], v[96:111]
    v_mfma_f32_32x32x16_bf16 v[112:127], v[44:47], v[172:175], v[112:127]
    s_waitcnt vmcnt(4)
    s_nop 7
    v_mfma_f32_32x32x16_bf16 v[128:143], v[48:51], v[160:163], 0
    v_lshlrev_b32 v244, 16, v212
    v_lshlrev_b32 v248, 16, v214
    v_and_b32 v245, 0xffff0000, v212
    v_and_b32 v249, 0xffff0000, v214
    v_lshlrev_b32 v246, 16, v213
    v_lshlrev_b32 v250, 16, v215
    v_and_b32 v247, 0xffff0000, v213
    v_mfma_f32_32x32x16_bf16 v[144:159], v[48:51], v[176:179], 0
    v_and_b32 v251, 0xffff0000, v215
    v_mul_f32 v252, v96, v244
    v_mul_f32 v96, v96, v248
    v_mul_f32 v253, v97, v245
    v_mul_f32 v97, v97, v249
    v_mul_f32 v254, v98, v246
    v_mul_f32 v98, v98, v250
    v_mfma_f32_32x32x16_bf16 v[128:143], v[52:55], v[164:167], v[128:143]
    v_mul_f32 v255, v99, v247
    v_mul_f32 v99, v99, v251
    v_fma_f32 v252, -v112, v248, v252
    v_fma_f32 v96, v112, v244, v96
    v_fma_f32 v253, -v113, v249, v253
    v_fma_f32 v97, v113, v245, v97
    v_fma_f32 v254, -v114, v250, v254
    v_mfma_f32_32x32x16_bf16 v[144:159], v[52:55], v[180:183], v[144:159]
    v_fma_f32 v98, v114, v246, v98
    v_fma_f32 v255, -v115, v251, v255
    v_fma_f32 v99, v115, v247, v99
    v_cvt_pk_bf16_f32 v192, v252, v253
    v_cvt_pk_bf16_f32 v193, v254, v255
    v_cvt_pk_bf16_f32 v200, v96, v97
    v_cvt_pk_bf16_f32 v201, v98, v99
    v_mfma_f32_32x32x16_bf16 v[128:143], v[56:59], v[168:171], v[128:143]
    v_lshlrev_b32 v244, 16, v216
    v_lshlrev_b32 v248, 16, v218
    v_and_b32 v245, 0xffff0000, v216
    v_and_b32 v249, 0xffff0000, v218
    v_lshlrev_b32 v246, 16, v217
    v_lshlrev_b32 v250, 16, v219
    v_and_b32 v247, 0xffff0000, v217
    v_mfma_f32_32x32x16_bf16 v[144:159], v[56:59], v[184:187], v[144:159]
    v_and_b32 v251, 0xffff0000, v219
    v_mul_f32 v252, v100, v244
    v_mul_f32 v100, v100, v248
    v_mul_f32 v253, v101, v245
    v_mul_f32 v101, v101, v249
    v_mul_f32 v254, v102, v246
    v_mul_f32 v102, v102, v250
    v_mfma_f32_32x32x16_bf16 v[128:143], v[60:63], v[172:175], v[128:143]
    v_mul_f32 v255, v103, v247
    v_mul_f32 v103, v103, v251
    v_fma_f32 v252, -v116, v248, v252
    v_fma_f32 v100, v116, v244, v100
    v_fma_f32 v253, -v117, v249, v253
    v_fma_f32 v101, v117, v245, v101
    v_fma_f32 v254, -v118, v250, v254
    v_mfma_f32_32x32x16_bf16 v[144:159], v[60:63], v[188:191], v[144:159]
    v_fma_f32 v102, v118, v246, v102
    v_fma_f32 v255, -v119, v251, v255
    v_fma_f32 v103, v119, v247, v103
    v_cvt_pk_bf16_f32 v194, v252, v253
    v_cvt_pk_bf16_f32 v195, v254, v255
    v_cvt_pk_bf16_f32 v202, v100, v101
    v_cvt_pk_bf16_f32 v203, v102, v103
    v_mfma_f32_32x32x16_bf16 v[128:143], v[64:67], v[176:179], v[128:143]
    v_lshlrev_b32 v244, 16, v220
    v_lshlrev_b32 v248, 16, v222
    v_and_b32 v245, 0xffff0000, v220
    v_and_b32 v249, 0xffff0000, v222
    v_lshlrev_b32 v246, 16, v221
    v_lshlrev_b32 v250, 16, v223
    v_and_b32 v247, 0xffff0000, v221
    v_mfma_f32_32x32x16_bf16 v[144:159], v[80:83], v[160:163], v[144:159]
    v_and_b32 v251, 0xffff0000, v223
    v_mul_f32 v252, v104, v244
    v_mul_f32 v104, v104, v248
    v_mul_f32 v253, v105, v245
    v_mul_f32 v105, v105, v249
    v_mul_f32 v254, v106, v246
    v_mul_f32 v106, v106, v250
    v_mfma_f32_32x32x16_bf16 v[128:143], v[68:71], v[180:183], v[128:143]
    v_mul_f32 v255, v107, v247
    v_mul_f32 v107, v107, v251
    v_fma_f32 v252, -v120, v248, v252
    v_fma_f32 v104, v120, v244, v104
    v_fma_f32 v253, -v121, v249, v253
    v_fma_f32 v105, v121, v245, v105
    v_fma_f32 v254, -v122, v250, v254
    v_mfma_f32_32x32x16_bf16 v[144:159], v[84:87], v[164:167], v[144:159]
    v_fma_f32 v106, v122, v246, v106
    v_fma_f32 v255, -v123, v251, v255
    v_fma_f32 v107, v123, v247, v107
    v_cvt_pk_bf16_f32 v196, v252, v253
    v_cvt_pk_bf16_f32 v197, v254, v255
    v_cvt_pk_bf16_f32 v204, v104, v105
    v_cvt_pk_bf16_f32 v205, v106, v107
    v_mfma_f32_32x32x16_bf16 v[128:143], v[72:75], v[184:187], v[128:143]
    v_lshlrev_b32 v244, 16, v224
    v_lshlrev_b32 v248, 16, v226
    v_and_b32 v245, 0xffff0000, v224
    v_and_b32 v249, 0xffff0000, v226
    v_lshlrev_b32 v246, 16, v225
    v_lshlrev_b32 v250, 16, v227
    v_and_b32 v247, 0xffff0000, v225
    v_mfma_f32_32x32x16_bf16 v[144:159], v[88:91], v[168:171], v[144:159]
    v_and_b32 v251, 0xffff0000, v227
    v_mul_f32 v252, v108, v244
    v_mul_f32 v108, v108, v248
    v_mul_f32 v253, v109, v245
    v_mul_f32 v109, v109, v249
    v_mul_f32 v254, v110, v246
    v_mul_f32 v110, v110, v250
    v_mfma_f32_32x32x16_bf16 v[128:143], v[76:79], v[188:191], v[128:143]
    v_mul_f32 v255, v111, v247
    v_mul_f32 v111, v111, v251
    v_fma_f32 v252, -v124, v248, v252
    v_fma_f32 v108, v124, v244, v108
    v_fma_f32 v253, -v125, v249, v253
    v_fma_f32 v109, v125, v245, v109
    v_fma_f32 v254, -v126, v250, v254
    v_mfma_f32_32x32x16_bf16 v[144:159], v[92:95], v[172:175], v[144:159]
    v_fma_f32 v110, v126, v246, v110
    v_fma_f32 v255, -v127, v251, v255
    v_fma_f32 v111, v127, v247, v111
    v_cvt_pk_bf16_f32 v198, v252, v253
    v_cvt_pk_bf16_f32 v199, v254, v255
    v_cvt_pk_bf16_f32 v206, v108, v109
    v_cvt_pk_bf16_f32 v207, v110, v111
    s_waitcnt vmcnt(0)
    s_nop 7
    v_mfma_f32_32x32x16_bf16 v[96:111], v[192:195], v[0:3], 0
    v_lshlrev_b32 v244, 16, v228
    v_lshlrev_b32 v248, 16, v230
    v_and_b32 v245, 0xffff0000, v228
    v_and_b32 v249, 0xffff0000, v230
    v_lshlrev_b32 v246, 16, v229
    v_lshlrev_b32 v250, 16, v231
    v_and_b32 v247, 0xffff0000, v229
    v_and_b32 v251, 0xffff0000, v231
    v_mul_f32 v252, v128, v244
    v_mul_f32 v128, v128, v248
    v_mul_f32 v253, v129, v245
    v_mul_f32 v129, v129, v249
    v_mul_f32 v254, v130, v246
    v_mul_f32 v130, v130, v250
    v_mfma_f32_32x32x16_bf16 v[112:127], v[200:203], v[0:3], 0
    v_mul_f32 v255, v131, v247
    v_mul_f32 v131, v131, v251
    v_fma_f32 v252, -v144, v248, v252
    v_fma_f32 v128, v144, v244, v128
    v_fma_f32 v253, -v145, v249, v253
    v_fma_f32 v129, v145, v245, v129
    v_fma_f32 v254, -v146, v250, v254
    v_fma_f32 v130, v146, v246, v130
    v_fma_f32 v255, -v147, v251, v255
    v_fma_f32 v131, v147, v247, v131
    v_cvt_pk_bf16_f32 v168, v252, v253
    v_cvt_pk_bf16_f32 v169, v254, v255
    v_cvt_pk_bf16_f32 v184, v128, v129
    v_cvt_pk_bf16_f32 v185, v130, v131
    v_mfma_f32_32x32x16_bf16 v[96:111], v[196:199], v[4:7], v[96:111]
    v_lshlrev_b32 v244, 16, v232
    v_lshlrev_b32 v248, 16, v234
    v_and_b32 v245, 0xffff0000, v232
    v_and_b32 v249, 0xffff0000, v234
    v_lshlrev_b32 v246, 16, v233
    v_lshlrev_b32 v250, 16, v235
    v_and_b32 v247, 0xffff0000, v233
    v_and_b32 v251, 0xffff0000, v235
    v_mul_f32 v252, v132, v244
    v_mul_f32 v132, v132, v248
    v_mul_f32 v253, v133, v245
    v_mul_f32 v133, v133, v249
    v_mul_f32 v254, v134, v246
    v_mul_f32 v134, v134, v250
    v_mfma_f32_32x32x16_bf16 v[112:127], v[204:207], v[4:7], v[112:127]
    v_mul_f32 v255, v135, v247
    v_mul_f32 v135, v135, v251
    v_fma_f32 v252, -v148, v248, v252
    v_fma_f32 v132, v148, v244, v132
    v_fma_f32 v253, -v149, v249, v253
    v_fma_f32 v133, v149, v245, v133
    v_fma_f32 v254, -v150, v250, v254
    v_fma_f32 v134, v150, v246, v134
    v_fma_f32 v255, -v151, v251, v255
    v_fma_f32 v135, v151, v247, v135
    v_cvt_pk_bf16_f32 v170, v252, v253
    v_cvt_pk_bf16_f32 v171, v254, v255
    v_cvt_pk_bf16_f32 v186, v132, v133
    v_cvt_pk_bf16_f32 v187, v134, v135
    v_mfma_f32_32x32x16_bf16 v[96:111], v[200:203], v[32:35], v[96:111]
    v_lshlrev_b32 v244, 16, v236
    v_lshlrev_b32 v248, 16, v238
    v_and_b32 v245, 0xffff0000, v236
    v_and_b32 v249, 0xffff0000, v238
    v_lshlrev_b32 v246, 16, v237
    v_lshlrev_b32 v250, 16, v239
    v_and_b32 v247, 0xffff0000, v237
    v_and_b32 v251, 0xffff0000, v239
    v_mul_f32 v252, v136, v244
    v_mul_f32 v136, v136, v248
    v_mul_f32 v253, v137, v245
    v_mul_f32 v137, v137, v249
    v_mul_f32 v254, v138, v246
    v_mul_f32 v138, v138, v250
    v_mfma_f32_32x32x16_bf16 v[112:127], v[192:195], v[16:19], v[112:127]
    v_mul_f32 v255, v139, v247
    v_mul_f32 v139, v139, v251
    v_fma_f32 v252, -v152, v248, v252
    v_fma_f32 v136, v152, v244, v136
    v_fma_f32 v253, -v153, v249, v253
    v_fma_f32 v137, v153, v245, v137
    v_fma_f32 v254, -v154, v250, v254
    v_fma_f32 v138, v154, v246, v138
    v_fma_f32 v255, -v155, v251, v255
    v_fma_f32 v139, v155, v247, v139
    v_cvt_pk_bf16_f32 v172, v252, v253
    v_cvt_pk_bf16_f32 v173, v254, v255
    v_cvt_pk_bf16_f32 v188, v136, v137
    v_cvt_pk_bf16_f32 v189, v138, v139
    v_mfma_f32_32x32x16_bf16 v[96:111], v[204:207], v[36:39], v[96:111]
    v_lshlrev_b32 v244, 16, v240
    v_lshlrev_b32 v248, 16, v242
    v_and_b32 v245, 0xffff0000, v240
    v_and_b32 v249, 0xffff0000, v242
    v_lshlrev_b32 v246, 16, v241
    v_lshlrev_b32 v250, 16, v243
    v_and_b32 v247, 0xffff0000, v241
    v_and_b32 v251, 0xffff0000, v243
    v_mul_f32 v252, v140, v244
    v_mul_f32 v140, v140, v248
    v_mul_f32 v253, v141, v245
    v_mul_f32 v141, v141, v249
    v_mul_f32 v254, v142, v246
    v_mul_f32 v142, v142, v250
    v_mfma_f32_32x32x16_bf16 v[112:127], v[196:199], v[20:23], v[112:127]
    v_mul_f32 v255, v143, v247
    v_mul_f32 v143, v143, v251
    v_fma_f32 v252, -v156, v248, v252
    v_fma_f32 v140, v156, v244, v140
    v_fma_f32 v253, -v157, v249, v253
    v_fma_f32 v141, v157, v245, v141
    v_fma_f32 v254, -v158, v250, v254
    v_fma_f32 v142, v158, v246, v142
    v_fma_f32 v255, -v159, v251, v255
    v_fma_f32 v143, v159, v247, v143
    v_cvt_pk_bf16_f32 v174, v252, v253
    v_cvt_pk_bf16_f32 v175, v254, v255
    v_cvt_pk_bf16_f32 v190, v140, v141
    v_cvt_pk_bf16_f32 v191, v142, v143
    v_mfma_f32_32x32x16_bf16 v[96:111], v[168:171], v[8:11], v[96:111]
    v_mfma_f32_32x32x16_bf16 v[112:127], v[184:187], v[8:11], v[112:127]
    v_mfma_f32_32x32x16_bf16 v[96:111], v[172:175], v[12:15], v[96:111]
    v_mfma_f32_32x32x16_bf16 v[112:127], v[188:191], v[12:15], v[112:127]
    v_mfma_f32_32x32x16_bf16 v[96:111], v[184:187], v[40:43], v[96:111]
    v_mfma_f32_32x32x16_bf16 v[112:127], v[168:171], v[24:27], v[112:127]
    v_mfma_f32_32x32x16_bf16 v[96:111], v[188:191], v[44:47], v[96:111]
    v_mfma_f32_32x32x16_bf16 v[112:127], v[172:175], v[28:31], v[112:127]
    v_add_u32 v211, 57344, v209
    ds_read_b128 v[0:3], v211 offset:14336
    ds_read_b128 v[4:7], v211 offset:15360
    ds_read_b128 v[8:11], v211 offset:16384
    ds_read_b128 v[12:15], v211 offset:17408
    ds_read_b128 v[16:19], v211 offset:18432
    ds_read_b128 v[20:23], v211 offset:19456
    ds_read_b128 v[24:27], v211 offset:20480
    ds_read_b128 v[28:31], v211 offset:21504
    ds_read_b128 v[212:215], v211 offset:8192
    ds_read_b128 v[216:219], v211 offset:9216
    ds_read_b128 v[220:223], v211 offset:10240
    ds_read_b128 v[224:227], v211 offset:11264
    ds_read_b128 v[228:231], v211 offset:12288
    ds_read_b128 v[232:235], v211 offset:13312
    s_lshr_b32 s25, s27, 1
    s_and_b32 s26, s27, 1
    s_mul_i32 s26, s26, 224
    s_add_u32 s25, s25, s26
    s_mul_i32 s25, s25, 4224
    s_add_u32 s29, s25, 13107200
    s_add_u32 s30, s29, 473088
    s_cmp_eq_u32 s27, 0
    s_cselect_b32 s30, 15024128, s30
    s_cmp_eq_u32 s27, 224
    s_cselect_b32 s30, 15032320, s30
    v_and_b32 v210, 31, v208
    v_lshlrev_b32 v210, 6, v210
    v_lshrrev_b32 v244, 5, v208
    v_lshl_add_u32 v210, v244, 4, v210
    v_add_u32 v210, 57344, v210
    s_waitcnt lgkmcnt(6)
    v_mfma_f32_32x32x16_bf16 v[128:143], v[192:195], v[48:51], 0
    v_mul_f32 v252, v96, v0
    v_mul_f32 v96, v96, v16
    v_mul_f32 v253, v97, v1
    v_mul_f32 v97, v97, v17
    v_mul_f32 v254, v98, v2
    v_mfma_f32_32x32x16_bf16 v[144:159], v[200:203], v[48:51], 0
    v_mul_f32 v98, v98, v18
    v_mul_f32 v255, v99, v3
    v_mul_f32 v99, v99, v19
    v_fma_f32 v252, -v112, v16, v252
    v_fma_f32 v96, v112, v0, v96
    v_mfma_f32_32x32x16_bf16 v[128:143], v[196:199], v[52:55], v[128:143]
    v_fma_f32 v253, -v113, v17, v253
    v_fma_f32 v97, v113, v1, v97
    v_fma_f32 v254, -v114, v18, v254
    v_fma_f32 v98, v114, v2, v98
    v_fma_f32 v255, -v115, v19, v255
    v_mfma_f32_32x32x16_bf16 v[144:159], v[204:207], v[52:55], v[144:159]
    v_fma_f32 v99, v115, v3, v99
    v_cvt_pk_bf16_f32 v160, v252, v253
    v_cvt_pk_bf16_f32 v161, v254, v255
    v_cvt_pk_bf16_f32 v176, v96, v97
    v_cvt_pk_bf16_f32 v177, v98, v99
    v_mfma_f32_32x32x16_bf16 v[128:143], v[168:171], v[56:59], v[128:143]
    v_mul_f32 v252, v100, v4
    v_mul_f32 v100, v100, v20
    v_mul_f32 v253, v101, v5
    v_mul_f32 v101, v101, v21
    v_mul_f32 v254, v102, v6
    v_mfma_f32_32x32x16_bf16 v[144:159], v[184:187], v[56:59], v[144:159]
    v_mul_f32 v102, v102, v22
    v_mul_f32 v255, v103, v7
    v_mul_f32 v103, v103, v23
    v_fma_f32 v252, -v116, v20, v252
    v_fma_f32 v100, v116, v4, v100
    v_mfma_f32_32x32x16_bf16 v[128:143], v[172:175], v[60:63], v[128:143]
    v_fma_f32 v253, -v117, v21, v253
    v_fma_f32 v101, v117, v5, v101
    v_fma_f32 v254, -v118, v22, v254
    v_fma_f32 v102, v118, v6, v102
    v_fma_f32 v255, -v119, v23, v255
    v_mfma_f32_32x32x16_bf16 v[144:159], v[188:191], v[60:63], v[144:159]
    v_fma_f32 v103, v119, v7, v103
    v_cvt_pk_bf16_f32 v162, v252, v253
    v_cvt_pk_bf16_f32 v163, v254, v255
    v_cvt_pk_bf16_f32 v178, v100, v101
    v_cvt_pk_bf16_f32 v179, v102, v103
    v_mfma_f32_32x32x16_bf16 v[128:143], v[200:203], v[80:83], v[128:143]
    v_mul_f32 v252, v104, v8
    v_mul_f32 v104, v104, v24
    v_mul_f32 v253, v105, v9
    v_mul_f32 v105, v105, v25
    v_mul_f32 v254, v106, v10
    v_mfma_f32_32x32x16_bf16 v[144:159], v[192:195], v[64:67], v[144:159]
    v_mul_f32 v106, v106, v26
    v_mul_f32 v255, v107, v11
    v_mul_f32 v107, v107, v27
    v_fma_f32 v252, -v120, v24, v252
    v_fma_f32 v104, v120, v8, v104
    v_mfma_f32_32x32x16_bf16 v[128:143], v[204:207], v[84:87], v[128:143]
    v_fma_f32 v253, -v121, v25, v253
    v_fma_f32 v105, v121, v9, v105
    v_fma_f32 v254, -v122, v26, v254
    v_fma_f32 v106, v122, v10, v106
    v_fma_f32 v255, -v123, v27, v255
    v_mfma_f32_32x32x16_bf16 v[144:159], v[196:199], v[68:71], v[144:159]
    v_fma_f32 v107, v123, v11, v107
    v_cvt_pk_bf16_f32 v164, v252, v253
    v_cvt_pk_bf16_f32 v165, v254, v255
    v_cvt_pk_bf16_f32 v180, v104, v105
    v_cvt_pk_bf16_f32 v181, v106, v107
    v_mfma_f32_32x32x16_bf16 v[128:143], v[184:187], v[88:91], v[128:143]
    v_mul_f32 v252, v108, v12
    v_mul_f32 v108, v108, v28
    v_mul_f32 v253, v109, v13
    v_mul_f32 v109, v109, v29
    v_mul_f32 v254, v110, v14
    v_mfma_f32_32x32x16_bf16 v[144:159], v[168:171], v[72:75], v[144:159]
    v_mul_f32 v110, v110, v30
    v_mul_f32 v255, v111, v15
    v_mul_f32 v111, v111, v31
    v_fma_f32 v252, -v124, v28, v252
    v_fma_f32 v108, v124, v12, v108
    v_mfma_f32_32x32x16_bf16 v[128:143], v[188:191], v[92:95], v[128:143]
    v_fma_f32 v253, -v125, v29, v253
    v_fma_f32 v109, v125, v13, v109
    v_fma_f32 v254, -v126, v30, v254
    v_fma_f32 v110, v126, v14, v110
    v_fma_f32 v255, -v127, v31, v255
    v_mfma_f32_32x32x16_bf16 v[144:159], v[172:175], v[76:79], v[144:159]
    v_fma_f32 v111, v127, v15, v111
    v_cvt_pk_bf16_f32 v166, v252, v253
    v_cvt_pk_bf16_f32 v167, v254, v255
    v_cvt_pk_bf16_f32 v182, v108, v109
    v_cvt_pk_bf16_f32 v183, v110, v111
    ds_read_b128 v[48:51], v211 offset:22528
    ds_read_b128 v[52:55], v211 offset:23552
    ds_read_b128 v[56:59], v211 offset:24576
    ds_read_b128 v[60:63], v211 offset:25600
    ds_read_b128 v[64:67], v211 offset:26624
    ds_read_b128 v[68:71], v211 offset:27648
    ds_read_b128 v[72:75], v211 offset:28672
    ds_read_b128 v[76:79], v211 offset:29696
    s_waitcnt lgkmcnt(0)
    v_mfma_f32_32x32x16_bf16 v[96:111], v[212:215], v[160:163], 0
    v_mul_f32 v252, v128, v48
    v_mul_f32 v128, v128, v64
    v_mul_f32 v253, v129, v49
    v_mul_f32 v129, v129, v65
    v_mul_f32 v254, v130, v50
    v_mul_f32 v130, v130, v66
    v_mul_f32 v255, v131, v51
    v_mul_f32 v131, v131, v67
    v_fma_f32 v252, -v144, v64, v252
    v_fma_f32 v128, v144, v48, v128
    v_mfma_f32_32x32x16_bf16 v[112:127], v[212:215], v[176:179], 0
    v_fma_f32 v253, -v145, v65, v253
    v_fma_f32 v129, v145, v49, v129
    v_fma_f32 v254, -v146, v66, v254
    v_fma_f32 v130, v146, v50, v130
    v_fma_f32 v255, -v147, v67, v255
    v_fma_f32 v131, v147, v51, v131
    v_cvt_pk_bf16_f32 v192, v252, v253
    v_cvt_pk_bf16_f32 v193, v254, v255
    v_cvt_pk_bf16_f32 v200, v128, v129
    v_cvt_pk_bf16_f32 v201, v130, v131
    v_mfma_f32_32x32x16_bf16 v[96:111], v[216:219], v[164:167], v[96:111]
    v_mul_f32 v252, v132, v52
    v_mul_f32 v132, v132, v68
    v_mul_f32 v253, v133, v53
    v_mul_f32 v133, v133, v69
    v_mul_f32 v254, v134, v54
    v_mul_f32 v134, v134, v70
    v_mul_f32 v255, v135, v55
    v_mul_f32 v135, v135, v71
    v_fma_f32 v252, -v148, v68, v252
    v_fma_f32 v132, v148, v52, v132
    v_mfma_f32_32x32x16_bf16 v[112:127], v[216:219], v[180:183], v[112:127]
    v_fma_f32 v253, -v149, v69, v253
    v_fma_f32 v133, v149, v53, v133
    v_fma_f32 v254, -v150, v70, v254
    v_fma_f32 v134, v150, v54, v134
    v_fma_f32 v255, -v151, v71, v255
    v_fma_f32 v135, v151, v55, v135
    v_cvt_pk_bf16_f32 v194, v252, v253
    v_cvt_pk_bf16_f32 v195, v254, v255
    v_cvt_pk_bf16_f32 v202, v132, v133
    v_cvt_pk_bf16_f32 v203, v134, v135
    v_mfma_f32_32x32x16_bf16 v[96:111], v[228:231], v[176:179], v[96:111]
    v_mul_f32 v252, v136, v56
    v_mul_f32 v136, v136, v72
    v_mul_f32 v253, v137, v57
    v_mul_f32 v137, v137, v73
    v_mul_f32 v254, v138, v58
    v_mul_f32 v138, v138, v74
    v_mul_f32 v255, v139, v59
    v_mul_f32 v139, v139, v75
    v_fma_f32 v252, -v152, v72, v252
    v_fma_f32 v136, v152, v56, v136
    v_mfma_f32_32x32x16_bf16 v[112:127], v[220:223], v[160:163], v[112:127]
    v_fma_f32 v253, -v153, v73, v253
    v_fma_f32 v137, v153, v57, v137
    v_fma_f32 v254, -v154, v74, v254
    v_fma_f32 v138, v154, v58, v138
    v_fma_f32 v255, -v155, v75, v255
    v_fma_f32 v139, v155, v59, v139
    v_cvt_pk_bf16_f32 v196, v252, v253
    v_cvt_pk_bf16_f32 v197, v254, v255
    v_cvt_pk_bf16_f32 v204, v136, v137
    v_cvt_pk_bf16_f32 v205, v138, v139
    v_mfma_f32_32x32x16_bf16 v[96:111], v[232:235], v[180:183], v[96:111]
    v_mul_f32 v252, v140, v60
    v_mul_f32 v140, v140, v76
    v_mul_f32 v253, v141, v61
    v_mul_f32 v141, v141, v77
    v_mul_f32 v254, v142, v62
    v_mul_f32 v142, v142, v78
    v_mul_f32 v255, v143, v63
    v_mul_f32 v143, v143, v79
    v_fma_f32 v252, -v156, v76, v252
    v_fma_f32 v140, v156, v60, v140
    v_mfma_f32_32x32x16_bf16 v[112:127], v[224:227], v[164:167], v[112:127]
    v_fma_f32 v253, -v157, v77, v253
    v_fma_f32 v141, v157, v61, v141
    v_fma_f32 v254, -v158, v78, v254
    v_fma_f32 v142, v158, v62, v142
    v_fma_f32 v255, -v159, v79, v255
    v_fma_f32 v143, v159, v63, v143
    v_cvt_pk_bf16_f32 v198, v252, v253
    v_cvt_pk_bf16_f32 v199, v254, v255
    v_cvt_pk_bf16_f32 v206, v140, v141
    v_cvt_pk_bf16_f32 v207, v142, v143
    s_nop 1
    v_mfma_f32_32x32x16_bf16 v[128:143], v[212:215], v[192:195], 0
    v_cvt_pk_bf16_f32 v0, v96, v97
    v_cvt_pk_bf16_f32 v1, v98, v99
    v_cvt_pk_bf16_f32 v2, v100, v101
    v_mfma_f32_32x32x16_bf16 v[144:159], v[212:215], v[200:203], 0
    v_cvt_pk_bf16_f32 v3, v102, v103
    v_cvt_pk_bf16_f32 v4, v104, v105
    v_cvt_pk_bf16_f32 v5, v106, v107
    v_cvt_pk_bf16_f32 v6, v108, v109
    v_mfma_f32_32x32x16_bf16 v[128:143], v[216:219], v[196:199], v[128:143]
    v_cvt_pk_bf16_f32 v7, v110, v111
    s_nop 1
    v_permlane32_swap_b32 v0, v2
    v_permlane32_swap_b32 v1, v3
    v_mfma_f32_32x32x16_bf16 v[144:159], v[216:219], v[204:207], v[144:159]
    v_permlane32_swap_b32 v4, v6
    v_permlane32_swap_b32 v5, v7
    ds_write_b128 v210, v[0:3] offset:0
    ds_write_b128 v210, v[4:7] offset:32
    v_mfma_f32_32x32x16_bf16 v[128:143], v[228:231], v[200:203], v[128:143]
    v_cvt_pk_bf16_f32 v8, v112, v113
    v_cvt_pk_bf16_f32 v9, v114, v115
    v_cvt_pk_bf16_f32 v10, v116, v117
    v_mfma_f32_32x32x16_bf16 v[144:159], v[220:223], v[192:195], v[144:159]
    v_cvt_pk_bf16_f32 v11, v118, v119
    v_cvt_pk_bf16_f32 v12, v120, v121
    v_cvt_pk_bf16_f32 v13, v122, v123
    v_cvt_pk_bf16_f32 v14, v124, v125
    v_mfma_f32_32x32x16_bf16 v[128:143], v[232:235], v[204:207], v[128:143]
    v_cvt_pk_bf16_f32 v15, v126, v127
    s_nop 1
    v_permlane32_swap_b32 v8, v10
    v_permlane32_swap_b32 v9, v11
    v_mfma_f32_32x32x16_bf16 v[144:159], v[224:227], v[196:199], v[144:159]
    v_permlane32_swap_b32 v12, v14
    v_permlane32_swap_b32 v13, v15
    ds_write_b128 v210, v[8:11] offset:4096
    ds_write_b128 v210, v[12:15] offset:4128
    s_nop 7
    v_cvt_pk_bf16_f32 v48, v128, v129
    v_cvt_pk_bf16_f32 v49, v130, v131
    v_cvt_pk_bf16_f32 v50, v132, v133
    v_cvt_pk_bf16_f32 v51, v134, v135
    v_cvt_pk_bf16_f32 v52, v136, v137
    v_cvt_pk_bf16_f32 v53, v138, v139
    v_cvt_pk_bf16_f32 v54, v140, v141
    v_cvt_pk_bf16_f32 v55, v142, v143
    s_nop 1
    v_permlane32_swap_b32 v48, v50
    v_permlane32_swap_b32 v49, v51
    v_permlane32_swap_b32 v52, v54
    v_permlane32_swap_b32 v53, v55
    ds_write_b128 v210, v[48:51] offset:2048
    ds_write_b128 v210, v[52:55] offset:2080
    v_cvt_pk_bf16_f32 v56, v144, v145
    v_cvt_pk_bf16_f32 v57, v146, v147
    v_cvt_pk_bf16_f32 v58, v148, v149
    v_cvt_pk_bf16_f32 v59, v150, v151
    v_cvt_pk_bf16_f32 v60, v152, v153
    v_cvt_pk_bf16_f32 v61, v154, v155
    v_cvt_pk_bf16_f32 v62, v156, v157
    v_cvt_pk_bf16_f32 v63, v158, v159
    s_nop 1
    v_permlane32_swap_b32 v56, v58
    v_permlane32_swap_b32 v57, v59
    v_permlane32_swap_b32 v60, v62
    v_permlane32_swap_b32 v61, v63
    ds_write_b128 v210, v[56:59] offset:6144
    ds_write_b128 v210, v[60:63] offset:6176
    s_waitcnt lgkmcnt(0)
    ds_read_b128 v[96:99], v211 offset:0
    ds_read_b128 v[100:103], v211 offset:1024
    ds_read_b128 v[104:107], v211 offset:2048
    ds_read_b128 v[108:111], v211 offset:3072
    ds_read_b128 v[112:115], v211 offset:4096
    ds_read_b128 v[116:119], v211 offset:5120
    ds_read_b128 v[120:123], v211 offset:6144
    ds_read_b128 v[124:127], v211 offset:7168
    s_waitcnt lgkmcnt(7)
    buffer_store_dwordx4 v[96:99], v209, s[8:11], s29 offen offset:0 sc1
    s_waitcnt lgkmcnt(6)
    buffer_store_dwordx4 v[100:103], v209, s[8:11], s29 offen offset:1024 sc1
    s_waitcnt lgkmcnt(5)
    buffer_store_dwordx4 v[104:107], v209, s[8:11], s29 offen offset:2048 sc1
    s_waitcnt lgkmcnt(4)
    buffer_store_dwordx4 v[108:111], v209, s[8:11], s29 offen offset:3072 sc1
    s_waitcnt lgkmcnt(3)
    buffer_store_dwordx4 v[112:115], v209, s[8:11], s30 offen offset:0 sc1
    s_waitcnt lgkmcnt(2)
    buffer_store_dwordx4 v[116:119], v209, s[8:11], s30 offen offset:1024 sc1
    s_waitcnt lgkmcnt(1)
    buffer_store_dwordx4 v[120:123], v209, s[8:11], s30 offen offset:2048 sc1
    s_waitcnt lgkmcnt(0)
    buffer_store_dwordx4 v[124:127], v209, s[8:11], s30 offen offset:3072 sc1
    s_setprio 0
    s_lshl_b32 s25, s27, 7
    s_add_u32 s25, s25, 15269888
    v_mov_b32 v248, 0
    v_mov_b32 v250, s6
    v_mov_b32 v251, s7
    s_mov_b64 exec, 1
    s_waitcnt vmcnt(0)
    buffer_store_dwordx2 v[250:251], v248, s[8:11], s25 offen sc1
    s_mov_b64 exec, -1
    s_cmp_ge_u32 s2, 224
    s_cbranch_scc1 k2_auxw
    v_lshrrev_b32 v244, 3, v208
    v_and_b32 v245, 7, v208
    v_bfe_u32 v246, v208, 4, 1
    v_lshlrev_b32 v246, 2, v246
    v_xor_b32 v245, v245, v246
    v_lshlrev_b32 v245, 4, v245
    v_mul_u32_u24 v246, 4224, v244
    v_add_u32 v246, v246, v245
    s_sleep 6
    v_lshlrev_b32 v4, 7, v208
    v_add_u32 v5, 0x6000, v4
    v_min_u32 v5, 28672, v5
    s_lshr_b32 s25, s52, 1
    s_and_b32 s26, s25, 3
    s_add_u32 s26, s26, 28
    s_lshl_b32 s26, s26, 2
    s_lshr_b32 s25, s25, 2
    s_add_u32 s26, s26, s25
    s_lshl_b32 s26, s26, 11
    s_and_b32 s25, s52, 1
    s_lshl_b32 s25, s25, 8
    s_add_u32 s26, s26, s25
    s_add_u32 s26, s26, 66816
    v_writelane_b32 v5, s26, 62
    s_add_u32 s26, s26, 128
    v_writelane_b32 v5, s26, 63
    s_mov_b32 s28, 200000
    s_mov_b32 s25, 15269888
    s_mov_b32 s26, 15278080
    s_mov_b32 s29, 15286272
k2_pz:
    buffer_load_dwordx2 v[12:13], v4, s[8:11], s25 offen sc1
    buffer_load_dwordx2 v[14:15], v4, s[8:11], s26 offen sc1
    buffer_load_dwordx2 v[16:17], v4, s[8:11], s29 offen sc1
    buffer_load_dwordx2 v[18:19], v5, s[8:11], s25 offen sc1
    s_waitcnt vmcnt(0)
    v_cmp_ne_u64 vcc, s[6:7], v[12:13]
    v_cmp_ne_u64 s[36:37], s[6:7], v[14:15]
    v_cmp_ne_u64 s[38:39], s[6:7], v[16:17]
    v_cmp_ne_u64 s[62:63], s[6:7], v[18:19]
    s_nop 1
    s_or_b64 vcc, vcc, s[36:37]
    s_or_b64 vcc, vcc, s[38:39]
    s_or_b64 vcc, vcc, s[62:63]
    s_and_b64 exec, exec, vcc
    s_cbranch_scc0 k2_pz_done
    s_sub_u32 s28, s28, 1
    s_sleep 6
    s_cmp_gt_i32 s28, 0
    s_cbranch_scc1 k2_pz
k2_pz_done:
    s_mov_b64 exec, -1
    s_lshl_b32 s25, s52, 7
    s_add_u32 s25, s25, 13107200
    v_add_u32 v21, 32768, v246
    v_add_u32 v22, 65536, v246
    v_add_u32 v23, 98304, v246
    s_mov_b32 m0, 57344
    s_add_u32 s25, s25, 0
    buffer_load_dwordx4 v246, s[8:11], s25 offen offset:0 sc1 lds
    buffer_load_dwordx4 v21, s[8:11], s25 offen offset:1024 sc1 lds
    buffer_load_dwordx4 v22, s[8:11], s25 offen offset:2048 sc1 lds
    buffer_load_dwordx4 v23, s[8:11], s25 offen offset:3072 sc1 lds
    s_mov_b32 m0, 61440
    s_add_u32 s25, s25, 135168
    buffer_load_dwordx4 v246, s[8:11], s25 offen offset:0 sc1 lds
    buffer_load_dwordx4 v21, s[8:11], s25 offen offset:1024 sc1 lds
    buffer_load_dwordx4 v22, s[8:11], s25 offen offset:2048 sc1 lds
    buffer_load_dwordx4 v23, s[8:11], s25 offen offset:3072 sc1 lds
    s_mov_b32 m0, 65536
    s_add_u32 s25, s25, 135168
    buffer_load_dwordx4 v246, s[8:11], s25 offen offset:0 sc1 lds
    buffer_load_dwordx4 v21, s[8:11], s25 offen offset:1024 sc1 lds
    buffer_load_dwordx4 v22, s[8:11], s25 offen offset:2048 sc1 lds
    buffer_load_dwordx4 v23, s[8:11], s25 offen offset:3072 sc1 lds
    s_mov_b32 m0, 69632
    s_add_u32 s25, s25, 135168
    buffer_load_dwordx4 v246, s[8:11], s25 offen offset:0 sc1 lds
    buffer_load_dwordx4 v21, s[8:11], s25 offen offset:1024 sc1 lds
    buffer_load_dwordx4 v22, s[8:11], s25 offen offset:2048 sc1 lds
    buffer_load_dwordx4 v23, s[8:11], s25 offen offset:3072 sc1 lds
    s_mov_b32 m0, 73728
    s_add_u32 s25, s25, 135168
    buffer_load_dwordx4 v246, s[8:11], s25 offen offset:0 sc1 lds
    buffer_load_dwordx4 v21, s[8:11], s25 offen offset:1024 sc1 lds
    buffer_load_dwordx4 v22, s[8:11], s25 offen offset:2048 sc1 lds
    buffer_load_dwordx4 v23, s[8:11], s25 offen offset:3072 sc1 lds
    s_mov_b32 m0, 77824
    s_add_u32 s25, s25, 135168
    buffer_load_dwordx4 v246, s[8:11], s25 offen offset:0 sc1 lds
    buffer_load_dwordx4 v21, s[8:11], s25 offen offset:1024 sc1 lds
    buffer_load_dwordx4 v22, s[8:11], s25 offen offset:2048 sc1 lds
    buffer_load_dwordx4 v23, s[8:11], s25 offen offset:3072 sc1 lds
    s_mov_b32 m0, 81920
    s_add_u32 s25, s25, 135168
    buffer_load_dwordx4 v246, s[8:11], s25 offen offset:0 sc1 lds
    buffer_load_dwordx4 v21, s[8:11], s25 offen offset:1024 sc1 lds
    buffer_load_dwordx4 v22, s[8:11], s25 offen offset:2048 sc1 lds
    buffer_load_dwordx4 v23, s[8:11], s25 offen offset:3072 sc1 lds
    s_mov_b32 m0, 86016
    s_add_u32 s25, s25, 135168
    buffer_load_dwordx4 v246, s[8:11], s25 offen offset:0 sc1 lds
    buffer_load_dwordx4 v21, s[8:11], s25 offen offset:1024 sc1 lds
    buffer_load_dwordx4 v22, s[8:11], s25 offen offset:2048 sc1 lds
    buffer_load_dwordx4 v23, s[8:11], s25 offen offset:3072 sc1 lds
    s_mov_b32 m0, 90112
    s_add_u32 s25, s25, 135168
    buffer_load_dwordx4 v246, s[8:11], s25 offen offset:0 sc1 lds
    buffer_load_dwordx4 v21, s[8:11], s25 offen offset:1024 sc1 lds
    buffer_load_dwordx4 v22, s[8:11], s25 offen offset:2048 sc1 lds
    buffer_load_dwordx4 v23, s[8:11], s25 offen offset:3072 sc1 lds
    s_mov_b32 m0, 94208
    s_add_u32 s25, s25, 135168
    buffer_load_dwordx4 v246, s[8:11], s25 offen offset:0 sc1 lds
    buffer_load_dwordx4 v21, s[8:11], s25 offen offset:1024 sc1 lds
    buffer_load_dwordx4 v22, s[8:11], s25 offen offset:2048 sc1 lds
    buffer_load_dwordx4 v23, s[8:11], s25 offen offset:3072 sc1 lds
    s_mov_b32 m0, 98304
    s_add_u32 s25, s25, 135168
    buffer_load_dwordx4 v246, s[8:11], s25 offen offset:0 sc1 lds
    buffer_load_dwordx4 v21, s[8:11], s25 offen offset:1024 sc1 lds
    buffer_load_dwordx4 v22, s[8:11], s25 offen offset:2048 sc1 lds
    buffer_load_dwordx4 v23, s[8:11], s25 offen offset:3072 sc1 lds
    s_mov_b32 m0, 102400
    s_add_u32 s25, s25, 135168
    buffer_load_dwordx4 v246, s[8:11], s25 offen offset:0 sc1 lds
    buffer_load_dwordx4 v21, s[8:11], s25 offen offset:1024 sc1 lds
    buffer_load_dwordx4 v22, s[8:11], s25 offen offset:2048 sc1 lds
    buffer_load_dwordx4 v23, s[8:11], s25 offen offset:3072 sc1 lds
    s_mov_b32 m0, 106496
    s_add_u32 s25, s25, 135168
    buffer_load_dwordx4 v246, s[8:11], s25 offen offset:0 sc1 lds
    buffer_load_dwordx4 v21, s[8:11], s25 offen offset:1024 sc1 lds
    buffer_load_dwordx4 v22, s[8:11], s25 offen offset:2048 sc1 lds
    buffer_load_dwordx4 v23, s[8:11], s25 offen offset:3072 sc1 lds
    s_mov_b32 m0, 110592
    s_add_u32 s25, s25, 135168
    buffer_load_dwordx4 v246, s[8:11], s25 offen offset:0 sc1 lds
    buffer_load_dwordx4 v21, s[8:11], s25 offen offset:1024 sc1 lds
    buffer_load_dwordx4 v22, s[8:11], s25 offen offset:2048 sc1 lds
    buffer_load_dwordx4 v23, s[8:11], s25 offen offset:3072 sc1 lds
k2_auxw:
k2_auxb1:
    v_lshrrev_b32 v237, 3, v208
    v_and_b32 v218, 7, v208
    v_bfe_u32 v219, v208, 4, 1
    v_lshlrev_b32 v219, 2, v219
    v_xor_b32 v218, v218, v219
    v_mul_u32_u24 v237, 896, v237
    v_lshl_add_u32 v237, v218, 4, v237
    s_barrier
    s_barrier
    s_cmp_ge_u32 s2, 224
    s_cbranch_scc1 k2_chk
    s_lshl_b32 s25, s53, 7
    s_add_u32 s25, s25, 57344
    s_mov_b32 m0, 114688
    s_nop 0
    buffer_load_dwordx4 v237, s[12:15], s25 offen offset:0 lds
    s_add_u32 s25, s25, 6144
    buffer_load_dwordx4 v237, s[12:15], s25 offen offset:1024 lds
    s_add_u32 s25, s25, 6144
    buffer_load_dwordx4 v237, s[12:15], s25 offen offset:2048 lds
    s_add_u32 s25, s25, 6144
    buffer_load_dwordx4 v237, s[12:15], s25 offen offset:3072 lds
    s_mov_b32 m0, 118784
    s_add_u32 s25, s25, 10240
    buffer_load_dwordx4 v237, s[12:15], s25 offen offset:0 lds
    s_add_u32 s25, s25, 6144
    buffer_load_dwordx4 v237, s[12:15], s25 offen offset:1024 lds
    s_add_u32 s25, s25, 6144
    buffer_load_dwordx4 v237, s[12:15], s25 offen offset:2048 lds
    s_add_u32 s25, s25, 6144
    buffer_load_dwordx4 v237, s[12:15], s25 offen offset:3072 lds
    s_mov_b32 m0, 122880
    s_add_u32 s25, s25, 10240
    buffer_load_dwordx4 v237, s[12:15], s25 offen offset:0 lds
    s_add_u32 s25, s25, 6144
    buffer_load_dwordx4 v237, s[12:15], s25 offen offset:1024 lds
    s_add_u32 s25, s25, 6144
    buffer_load_dwordx4 v237, s[12:15], s25 offen offset:2048 lds
    s_add_u32 s25, s25, 6144
    buffer_load_dwordx4 v237, s[12:15], s25 offen offset:3072 lds
    s_mov_b32 m0, 126976
    s_add_u32 s25, s25, 10240
    buffer_load_dwordx4 v237, s[12:15], s25 offen offset:0 lds
    s_add_u32 s25, s25, 6144
    buffer_load_dwordx4 v237, s[12:15], s25 offen offset:1024 lds
    s_add_u32 s25, s25, 6144
    buffer_load_dwordx4 v237, s[12:15], s25 offen offset:2048 lds
    s_add_u32 s25, s25, 6144
    buffer_load_dwordx4 v237, s[12:15], s25 offen offset:3072 lds
    s_mov_b32 m0, 131072
    s_add_u32 s25, s25, 10240
    buffer_load_dwordx4 v237, s[12:15], s25 offen offset:0 lds
    s_add_u32 s25, s25, 6144
    buffer_load_dwordx4 v237, s[12:15], s25 offen offset:1024 lds
    s_add_u32 s25, s25, 6144
    buffer_load_dwordx4 v237, s[12:15], s25 offen offset:2048 lds
    s_add_u32 s25, s25, 6144
    buffer_load_dwordx4 v237, s[12:15], s25 offen offset:3072 lds
    s_mov_b32 m0, 135168
    s_add_u32 s25, s25, 10240
    buffer_load_dwordx4 v237, s[12:15], s25 offen offset:0 lds
    s_add_u32 s25, s25, 6144
    buffer_load_dwordx4 v237, s[12:15], s25 offen offset:1024 lds
    s_add_u32 s25, s25, 6144
    buffer_load_dwordx4 v237, s[12:15], s25 offen offset:2048 lds
    s_add_u32 s25, s25, 6144
    buffer_load_dwordx4 v237, s[12:15], s25 offen offset:3072 lds
    s_mov_b32 m0, 139264
    s_add_u32 s25, s25, 10240
    buffer_load_dwordx4 v237, s[12:15], s25 offen offset:0 lds
    s_add_u32 s25, s25, 6144
    buffer_load_dwordx4 v237, s[12:15], s25 offen offset:1024 lds
    s_add_u32 s25, s25, 6144
    buffer_load_dwordx4 v237, s[12:15], s25 offen offset:2048 lds
    s_add_u32 s25, s25, 6144
    buffer_load_dwordx4 v237, s[12:15], s25 offen offset:3072 lds
    s_mov_b32 m0, 143360
    s_add_u32 s25, s25, 10240
    buffer_load_dwordx4 v237, s[12:15], s25 offen offset:0 lds
    s_add_u32 s25, s25, 6144
    buffer_load_dwordx4 v237, s[12:15], s25 offen offset:1024 lds
    s_add_u32 s25, s25, 6144
    buffer_load_dwordx4 v237, s[12:15], s25 offen offset:2048 lds
    s_add_u32 s25, s25, 6144
    buffer_load_dwordx4 v237, s[12:15], s25 offen offset:3072 lds
    s_mov_b32 m0, 147456
    s_add_u32 s25, s25, 10240
    buffer_load_dwordx4 v237, s[12:15], s25 offen offset:0 lds
    s_add_u32 s25, s25, 6144
    buffer_load_dwordx4 v237, s[12:15], s25 offen offset:1024 lds
    s_add_u32 s25, s25, 6144
    buffer_load_dwordx4 v237, s[12:15], s25 offen offset:2048 lds
    s_add_u32 s25, s25, 6144
    buffer_load_dwordx4 v237, s[12:15], s25 offen offset:3072 lds
    s_mov_b32 m0, 151552
    s_add_u32 s25, s25, 10240
    buffer_load_dwordx4 v237, s[12:15], s25 offen offset:0 lds
    s_add_u32 s25, s25, 6144
    buffer_load_dwordx4 v237, s[12:15], s25 offen offset:1024 lds
    s_add_u32 s25, s25, 6144
    buffer_load_dwordx4 v237, s[12:15], s25 offen offset:2048 lds
    s_add_u32 s25, s25, 6144
    buffer_load_dwordx4 v237, s[12:15], s25 offen offset:3072 lds
    s_mov_b32 m0, 155648
    s_add_u32 s25, s25, 10240
    buffer_load_dwordx4 v237, s[12:15], s25 offen offset:0 lds
    s_add_u32 s25, s25, 6144
    buffer_load_dwordx4 v237, s[12:15], s25 offen offset:1024 lds
    s_add_u32 s25, s25, 6144
    buffer_load_dwordx4 v237, s[12:15], s25 offen offset:2048 lds
    s_add_u32 s25, s25, 6144
    buffer_load_dwordx4 v237, s[12:15], s25 offen offset:3072 lds
    s_mov_b32 m0, 159744
    s_add_u32 s25, s25, 10240
    buffer_load_dwordx4 v237, s[12:15], s25 offen offset:0 lds
    s_add_u32 s25, s25, 6144
    buffer_load_dwordx4 v237, s[12:15], s25 offen offset:1024 lds
    s_add_u32 s25, s25, 6144
    buffer_load_dwordx4 v237, s[12:15], s25 offen offset:2048 lds
    s_add_u32 s25, s25, 6144
    s_mov_b32 exec_hi, 0x00ffffff
    buffer_load_dwordx4 v237, s[12:15], s25 offen offset:3072 lds
    s_mov_b32 exec_hi, -1
    s_mov_b32 s60, s25
    s_waitcnt vmcnt(48)
    s_branch k2_chk
k2_auxfb:
    s_waitcnt vmcnt(0)
    s_barrier
    s_barrier
    s_barrier
    s_branch k2_auxb1
k2_auxp3:
    v_and_b32 v4, 31, v208
    v_lshlrev_b32 v4, 7, v4
    s_lshl_b32 s25, s52, 12
    s_add_u32 s25, s25, 15073280
    s_mov_b32 s29, s25
    buffer_load_dwordx2 v[0:1], v4, s[8:11], s29 offen sc1
    s_mov_b32 m0, 159744
    s_mov_b32 exec_lo, 0
    s_mov_b32 exec_hi, 0xff000000
    buffer_load_dwordx4 v237, s[12:15], s60 offen offset:3072 lds
    s_mov_b64 exec, -1
    s_mov_b32 s25, s29
    s_waitcnt vmcnt(0)
    v_cmp_eq_u64 vcc, s[6:7], v[0:1]
    s_nop 1
    s_cmp_eq_u64 vcc, -1
    s_cbranch_scc1 k2_po_done
    s_mov_b32 s28, 200000
k2_po:
    buffer_load_dwordx2 v[0:1], v4, s[8:11], s25 offen sc1
    s_waitcnt vmcnt(0)
    v_cmp_eq_u64 vcc, s[6:7], v[0:1]
    s_nop 1
    s_cmp_eq_u64 vcc, -1
    s_cbranch_scc1 k2_po_done
    s_sub_u32 s28, s28, 1
    s_sleep 2
    s_cmp_lg_u32 s28, 0
    s_cbranch_scc1 k2_po
k2_po_done:
    s_barrier
    s_lshl_b32 s25, s53, 7
    s_mov_b32 m0, 106496
    s_nop 0
    buffer_load_dwordx4 v237, s[12:15], s25 offen offset:0 lds
    s_add_u32 s25, s25, 6144
    buffer_load_dwordx4 v237, s[12:15], s25 offen offset:1024 lds
    s_add_u32 s25, s25, 6144
    buffer_load_dwordx4 v237, s[12:15], s25 offen offset:2048 lds
    s_add_u32 s25, s25, 6144
    buffer_load_dwordx4 v237, s[12:15], s25 offen offset:3072 lds
    s_mov_b32 m0, 110592
    s_add_u32 s25, s25, 10240
    buffer_load_dwordx4 v237, s[12:15], s25 offen offset:0 lds
    s_add_u32 s25, s25, 6144
    buffer_load_dwordx4 v237, s[12:15], s25 offen offset:1024 lds
    s_add_u32 s25, s25, 6144
    buffer_load_dwordx4 v237, s[12:15], s25 offen offset:2048 lds
    s_add_u32 s25, s25, 6144
    buffer_load_dwordx4 v237, s[12:15], s25 offen offset:3072 lds
    s_waitcnt vmcnt(0)
    s_barrier
    s_endpgm
k2_help:
    s_waitcnt lgkmcnt(0)
    s_barrier
    s_cmp_ge_u32 s2, 224
    s_cbranch_scc1 k2_end
    s_sleep 40
    s_mul_i32 s44, s53, 57344
    s_mov_b32 s45, 0
k2_fi:
    s_lshl_b32 m0, s45, 1
    s_add_u32 s26, s44, s45
    buffer_load_dwordx4 v209, s[16:19], s26 offen lds
    s_add_u32 s26, s26, 27648
    buffer_load_dwordx4 v209, s[16:19], s26 offen offset:1024 lds
    s_add_u32 s45, s45, 1024
    s_waitcnt vmcnt(12)
    s_cmp_lt_u32 s45, 28672
    s_cbranch_scc1 k2_fi
    s_and_b32 s25, s21, 3
    s_mul_i32 s25, s25, 100352
    s_lshl_b32 s26, s53, 7
    s_add_u32 s25, s25, s26
    v_mul_u32_u24 v8, 896, v208
    buffer_load_dword v9, v8, s[12:15], s25 offen
    s_add_u32 s25, s25, 43008
    buffer_load_dword v10, v8, s[12:15], s25 offen
    s_waitcnt vmcnt(0)
    s_endpgm
k2_end:
    s_endpgm
.fill 2048,4,0xbf810000
.section .rodata,"a"
.p2align 6
.amdhsa_kernel gated_mix__spectral_gfnet__softmax_full_mha__prompt_kernel
  .amdhsa_next_free_vgpr 256
  .amdhsa_next_free_sgpr 64
  .amdhsa_accum_offset 256
  .amdhsa_group_segment_fixed_size 0
  .amdhsa_kernarg_size 80
  .amdhsa_user_sgpr_count 2
  .amdhsa_user_sgpr_kernarg_segment_ptr 1
  .amdhsa_system_sgpr_workgroup_id_x 1
.end_amdhsa_kernel
.p2align 8
tab_small:
.quad 0x3f803f803f803f80,0x3f803f803f803f80,0x3f753f7b3f7f3f80,0x3ef13f0e3f223f35,0x3f553f6d3f7b3f80,0xbf0ebec4be480000,0x3f223f553f753f80,0xbf7fbf7bbf62bf35
.quad 0x3ec43f353f6d3f80,0xbec4bf35bf6dbf80,0x3dc93f0e3f623f80,0x3f223e48be95bf35,0xbe483ec43f553f80,0x3f7b3f6d3f0e0000,0xbef13e483f463f80,0x3e953f553f7f3f35
.quad 0xbf3500003f353f80,0xbf3500003f353f80,0xbf62be483f223f80,0xbf75bf55bdc93f35,0xbf7bbec43f0e3f80,0xbe48bf6dbf550000,0xbf7fbf0e3ef13f80,0x3f46be48bf75bf35
.quad 0xbf6dbf353ec43f80,0x3f6d3f35bec4bf80,0xbf46bf553e953f80,0x3dc93f7b3ef1bf35,0xbf0ebf6d3e483f80,0xbf553ec43f7b0000,0xbe95bf7b3dc93f80,0xbf62bf0e3f463f35
.quad 0xbf8000003f80,0xbf8000003f80,0x3e95bf7bbdc93f80,0x3f62bf0ebf463f35,0x3f0ebf6dbe483f80,0x3f553ec4bf7b0000,0x3f46bf55be953f80,0xbdc93f7bbef1bf35
.quad 0x3f6dbf35bec43f80,0xbf6d3f353ec4bf80,0x3f7fbf0ebef13f80,0xbf46be483f75bf35,0x3f7bbec4bf0e3f80,0x3e48bf6d3f550000,0x3f62be48bf223f80,0x3f75bf553dc93f35
.quad 0x3f350000bf353f80,0x3f350000bf353f80,0x3ef13e48bf463f80,0xbe953f55bf7f3f35,0x3e483ec4bf553f80,0xbf7b3f6dbf0e0000,0xbdc93f0ebf623f80,0xbf223e483e95bf35
.quad 0xbec43f35bf6d3f80,0x3ec4bf353f6dbf80,0xbf223f55bf753f80,0x3f7fbf7b3f62bf35,0xbf553f6dbf7b3f80,0x3f0ebec43e480000,0xbf753f7bbf7f3f80,0xbef13f0ebf223f35
.quad 0x3f803f803f803f80,0x3f803f803f803f80,0x3f463f553f623f6d,0x3dc93e483e953ec4,0x3e483ec43f0e3f35,0xbf7bbf6dbf55bf35,0xbef1be483dc93ec4,0xbe95bf0ebf46bf6d
.quad 0xbf6dbf35bec40000,0x3f6d3f353ec40000,0xbf75bf7bbf46bec4,0x3ef13f553f7f3f6d,0xbf0ebf6dbf7bbf35,0xbf55bec43e483f35,0x3dc9bf0ebf75bf6d,0xbf22bf7bbf62bec4
.quad 0x3f350000bf35bf80,0x3f350000bf35bf80,0x3f7f3f0ebe95bf6d,0x3f463f7b3ef1bec4,0x3f553f6d3e48bf35,0xbf0e3ec43f7b3f35,0x3e953f7b3f22bec4,0xbf62bf553dc93f6d
.quad 0xbec43f353f6d0000,0x3ec4bf35bf6d0000,0xbf623e483f7f3ec4,0x3f753f0ebf22bf6d,0xbf7bbec43f553f35,0xbe483f6d3f0ebf35,0xbf22bf553ef13f6d,0xbf7fbe483f753ec4
.quad 0xbf8000003f80,0xbf8000003f80,0x3f22bf55bef13f6d,0x3f7fbe48bf753ec4,0x3f7bbec4bf553f35,0x3e483f6dbf0ebf35,0x3f623e48bf7f3ec4,0xbf753f0e3f22bf6d
.quad 0x3ec43f35bf6d0000,0xbec4bf353f6d0000,0xbe953f7bbf22bec4,0x3f62bf55bdc93f6d,0xbf553f6dbe48bf35,0x3f0e3ec4bf7b3f35,0xbf7f3f0e3e95bf6d,0xbf463f7bbef1bec4
.quad 0xbf3500003f35bf80,0xbf3500003f35bf80,0xbdc9bf0e3f75bf6d,0x3f22bf7b3f62bec4,0x3f0ebf6d3f7bbf35,0x3f55bec4be483f35,0x3f75bf7b3f46bec4,0xbef13f55bf7f3f6d
.quad 0x3f6dbf353ec40000,0xbf6d3f35bec40000,0x3ef1be48bdc93ec4,0x3e95bf0e3f46bf6d,0xbe483ec4bf0e3f35,0x3f7bbf6d3f55bf35,0xbf463f55bf623f6d,0xbdc93e48be953ec4
.quad 0x3f803f803f803f80,0x3f803f803f803f80,0xbe95be48bdc90000,0xbf62bf55bf46bf35,0xbf55bf6dbf7bbf80,0x3f0e3ec43e480000,0x3f463f0e3e950000,0xbdc93e483ef13f35
.quad 0x3ec43f353f6d3f80,0xbec4bf35bf6dbf80,0xbf7fbf55bef10000,0x3f463f7b3f753f35,0x3e48bec4bf55bf80,0xbf7bbf6dbf0e0000,0x3f623f7b3f220000,0x3f753f0ebdc9bf35
.quad 0xbf3500003f353f80,0xbf3500003f353f80,0xbef1bf7bbf460000,0x3e95bf0ebf7fbf35,0x3f7b3ec4bf0ebf80,0x3e483f6d3f550000,0xbdc93f553f620000,0xbf22bf7bbe953f35
.quad 0xbf6dbf353ec43f80,0x3f6d3f35bec4bf80,0x3f22bf0ebf750000,0xbf7fbe483f623f35,0x3f0e3f6dbe48bf80,0x3f55bec4bf7b0000,0xbf753e483f7f0000,0xbef13f553f22bf35
.quad 0xbf8000003f80,0xbf8000003f80,0x3f753e48bf7f0000,0x3ef13f55bf22bf35,0xbf0e3f6d3e48bf80,0xbf55bec43f7b0000,0xbf22bf0e3f750000,0x3f7fbe48bf623f35
.quad 0x3f6dbf35bec43f80,0xbf6d3f353ec4bf80,0x3dc93f55bf620000,0x3f22bf7b3e953f35,0xbf7b3ec43f0ebf80,0xbe483f6dbf550000,0x3ef1bf7b3f460000,0xbe95bf0e3f7fbf35
.quad 0x3f350000bf353f80,0x3f350000bf353f80,0xbf623f7bbf220000,0xbf753f0e3dc9bf35,0xbe48bec43f55bf80,0x3f7bbf6d3f0e0000,0x3f7fbf553ef10000,0xbf463f7bbf753f35
.quad 0xbec43f35bf6d3f80,0x3ec4bf353f6dbf80,0xbf463f0ebe950000,0x3dc93e48bef13f35,0x3f55bf6d3f7bbf80,0xbf0e3ec4be480000,0x3e95be483dc90000,0x3f62bf553f46bf35
.quad 0x3f803f803f803f80,0x3f803f803f803f80,0xbf22bf0ebef1bec4,0xbf7fbf7bbf75bf6d,0xbe48bec4bf0ebf35,0x3f7b3f6d3f553f35,0x3f623f7b3f7f3f6d,0xbf75bf55bf22bec4
.quad 0xbf6dbf35bec40000,0x3f6d3f353ec40000,0x3e95be48bf22bf6d,0xbf62bf0ebdc93ec4,0x3f0e3f6d3f7b3f35,0x3f553ec4be48bf35,0xbf7fbf55be953ec4,0xbf46be483ef13f6d
.quad 0x3f350000bf35bf80,0x3f350000bf35bf80,0x3dc93f553f753ec4,0xbf223e483f623f6d,0xbf55bf6dbe483f35,0x3f0ebec4bf7bbf35,0x3f753e48bf46bf6d,0xbef13f0e3f7f3ec4
.quad 0xbec43f353f6d0000,0x3ec4bf35bf6d0000,0xbef1bf7bbdc93f6d,0xbe953f553f46bec4,0x3f7b3ec4bf55bf35,0x3e48bf6dbf0e3f35,0xbf463f0e3f62bec4,0xbdc93f7b3e95bf6d
.quad 0xbf8000003f80,0xbf8000003f80,0x3f463f0ebf62bec4,0x3dc93f7bbe95bf6d,0xbf7b3ec43f55bf35,0xbe48bf6d3f0e3f35,0x3ef1bf7b3dc93f6d,0x3e953f55bf46bec4
.quad 0x3ec43f35bf6d0000,0xbec4bf353f6d0000,0xbf753e483f46bf6d,0x3ef13f0ebf7f3ec4,0x3f55bf6d3e483f35,0xbf0ebec43f7bbf35,0xbdc93f55bf753ec4,0x3f223e48bf623f6d
.quad 0xbf3500003f35bf80,0xbf3500003f35bf80,0x3f7fbf553e953ec4,0x3f46be48bef13f6d,0xbf0e3f6dbf7b3f35,0xbf553ec43e48bf35,0xbe95be483f22bf6d,0x3f62bf0e3dc93ec4
.quad 0x3f6dbf353ec40000,0xbf6d3f35bec40000,0xbf623f7bbf7f3f6d,0x3f75bf553f22bec4,0x3e48bec43f0ebf35,0xbf7b3f6dbf553f35,0x3f22bf0e3ef1bec4,0x3f7fbf7b3f75bf6d
.quad 0x3f803f803f803f80,0x3f803f803f803f80,0xbf75bf7bbf7fbf80,0xbef1bf0ebf22bf35,0x3f553f6d3f7b3f80,0xbf0ebec4be480000,0xbf22bf55bf75bf80,0x3f7f3f7b3f623f35
.quad 0x3ec43f353f6d3f80,0xbec4bf35bf6dbf80,0xbdc9bf0ebf62bf80,0xbf22be483e953f35,0xbe483ec43f553f80,0x3f7b3f6d3f0e0000,0x3ef1be48bf46bf80,0xbe95bf55bf7fbf35
.quad 0xbf3500003f353f80,0xbf3500003f353f80,0x3f623e48bf22bf80,0x3f753f553dc9bf35,0xbf7bbec43f0e3f80,0xbe48bf6dbf550000,0x3f7f3f0ebef1bf80,0xbf463e483f753f35
.quad 0xbf6dbf353ec43f80,0x3f6d3f35bec4bf80,0x3f463f55be95bf80,0xbdc9bf7bbef13f35,0xbf0ebf6d3e483f80,0xbf553ec43f7b0000,0x3e953f7bbdc9bf80,0x3f623f0ebf46bf35
.quad 0xbf8000003f80,0xbf8000003f80,0xbe953f7b3dc9bf80,0xbf623f0e3f46bf35,0x3f0ebf6dbe483f80,0x3f553ec4bf7b0000,0xbf463f553e95bf80,0x3dc9bf7b3ef13f35
.quad 0x3f6dbf35bec43f80,0xbf6d3f353ec4bf80,0xbf7f3f0e3ef1bf80,0x3f463e48bf753f35,0x3f7bbec4bf0e3f80,0x3e48bf6d3f550000,0xbf623e483f22bf80,0xbf753f55bdc9bf35
.quad 0x3f350000bf353f80,0x3f350000bf353f80,0xbef1be483f46bf80,0x3e95bf553f7fbf35,0x3e483ec4bf553f80,0xbf7b3f6dbf0e0000,0x3dc9bf0e3f62bf80,0x3f22be48be953f35
.quad 0xbec43f35bf6d3f80,0x3ec4bf353f6dbf80,0x3f22bf553f75bf80,0xbf7f3f7bbf623f35,0xbf553f6dbf7b3f80,0x3f0ebec43e480000,0x3f75bf7b3f7fbf80,0x3ef1bf0e3f22bf35
.quad 0x3f803f803f803f80,0x3f803f803f803f80,0xbf46bf55bf62bf6d,0xbdc9be48be95bec4,0x3e483ec43f0e3f35,0xbf7bbf6dbf55bf35,0x3ef13e48bdc9bec4,0x3e953f0e3f463f6d
.quad 0xbf6dbf35bec40000,0x3f6d3f353ec40000,0x3f753f7b3f463ec4,0xbef1bf55bf7fbf6d,0xbf0ebf6dbf7bbf35,0xbf55bec43e483f35,0xbdc93f0e3f753f6d,0x3f223f7b3f623ec4
.quad 0x3f350000bf35bf80,0x3f350000bf35bf80,0xbf7fbf0e3e953f6d,0xbf46bf7bbef13ec4,0x3f553f6d3e48bf35,0xbf0e3ec43f7b3f35,0xbe95bf7bbf223ec4,0x3f623f55bdc9bf6d
.quad 0xbec43f353f6d0000,0x3ec4bf35bf6d0000,0x3f62be48bf7fbec4,0xbf75bf0e3f223f6d,0xbf7bbec43f553f35,0xbe483f6d3f0ebf35,0x3f223f55bef1bf6d,0x3f7f3e48bf75bec4
.quad 0xbf8000003f80,0xbf8000003f80,0xbf223f553ef1bf6d,0xbf7f3e483f75bec4,0x3f7bbec4bf553f35,0x3e483f6dbf0ebf35,0xbf62be483f7fbec4,0x3f75bf0ebf223f6d
.quad 0x3ec43f35bf6d0000,0xbec4bf353f6d0000,0x3e95bf7b3f223ec4,0xbf623f553dc9bf6d,0xbf553f6dbe48bf35,0x3f0e3ec4bf7b3f35,0x3f7fbf0ebe953f6d,0x3f46bf7b3ef13ec4
.quad 0xbf3500003f35bf80,0xbf3500003f35bf80,0x3dc93f0ebf753f6d,0xbf223f7bbf623ec4,0x3f0ebf6d3f7bbf35,0x3f55bec4be483f35,0xbf753f7bbf463ec4,0x3ef1bf553f7fbf6d
.quad 0x3f6dbf353ec40000,0xbf6d3f35bec40000,0xbef13e483dc9bec4,0xbe953f0ebf463f6d,0xbe483ec4bf0e3f35,0x3f7bbf6d3f55bf35,0x3f46bf553f62bf6d,0x3dc9be483e95bec4
.quad 0x3f803f803f803f80,0x3f803f803f803f80,0x3e953e483dc90000,0x3f623f553f463f35,0xbf55bf6dbf7bbf80,0x3f0e3ec43e480000,0xbf46bf0ebe950000,0x3dc9be48bef1bf35
.quad 0x3ec43f353f6d3f80,0xbec4bf35bf6dbf80,0x3f7f3f553ef10000,0xbf46bf7bbf75bf35,0x3e48bec4bf55bf80,0xbf7bbf6dbf0e0000,0xbf62bf7bbf220000,0xbf75bf0e3dc93f35
.quad 0xbf3500003f353f80,0xbf3500003f353f80,0x3ef13f7b3f460000,0xbe953f0e3f7f3f35,0x3f7b3ec4bf0ebf80,0x3e483f6d3f550000,0x3dc9bf55bf620000,0x3f223f7b3e95bf35
.quad 0xbf6dbf353ec43f80,0x3f6d3f35bec4bf80,0xbf223f0e3f750000,0x3f7f3e48bf62bf35,0x3f0e3f6dbe48bf80,0x3f55bec4bf7b0000,0x3f75be48bf7f0000,0x3ef1bf55bf223f35
.quad 0xbf8000003f80,0xbf8000003f80,0xbf75be483f7f0000,0xbef1bf553f223f35,0xbf0e3f6d3e48bf80,0xbf55bec43f7b0000,0x3f223f0ebf750000,0xbf7f3e483f62bf35
.quad 0x3f6dbf35bec43f80,0xbf6d3f353ec4bf80,0xbdc9bf553f620000,0xbf223f7bbe95bf35,0xbf7b3ec43f0ebf80,0xbe483f6dbf550000,0xbef13f7bbf460000,0x3e953f0ebf7f3f35
.quad 0x3f350000bf353f80,0x3f350000bf353f80,0x3f62bf7b3f220000,0x3f75bf0ebdc93f35,0xbe48bec43f55bf80,0x3f7bbf6d3f0e0000,0xbf7f3f55bef10000,0x3f46bf7b3f75bf35
.quad 0xbec43f35bf6d3f80,0x3ec4bf353f6dbf80,0x3f46bf0e3e950000,0xbdc9be483ef1bf35,0x3f55bf6d3f7bbf80,0xbf0e3ec4be480000,0xbe953e48bdc90000,0xbf623f55bf463f35
.quad 0x3f803f803f803f80,0x3f803f803f803f80,0x3f223f0e3ef13ec4,0x3f7f3f7b3f753f6d,0xbe48bec4bf0ebf35,0x3f7b3f6d3f553f35,0xbf62bf7bbf7fbf6d,0x3f753f553f223ec4
.quad 0xbf6dbf35bec40000,0x3f6d3f353ec40000,0xbe953e483f223f6d,0x3f623f0e3dc9bec4,0x3f0e3f6d3f7b3f35,0x3f553ec4be48bf35,0x3f7f3f553e95bec4,0x3f463e48bef1bf6d
.quad 0x3f350000bf35bf80,0x3f350000bf35bf80,0xbdc9bf55bf75bec4,0x3f22be48bf62bf6d,0xbf55bf6dbe483f35,0x3f0ebec4bf7bbf35,0xbf75be483f463f6d,0x3ef1bf0ebf7fbec4
.quad 0xbec43f353f6d0000,0x3ec4bf35bf6d0000,0x3ef13f7b3dc9bf6d,0x3e95bf55bf463ec4,0x3f7b3ec4bf55bf35,0x3e48bf6dbf0e3f35,0x3f46bf0ebf623ec4,0x3dc9bf7bbe953f6d
.quad 0xbf8000003f80,0xbf8000003f80,0xbf46bf0e3f623ec4,0xbdc9bf7b3e953f6d,0xbf7b3ec43f55bf35,0xbe48bf6d3f0e3f35,0xbef13f7bbdc9bf6d,0xbe95bf553f463ec4
.quad 0x3ec43f35bf6d0000,0xbec4bf353f6d0000,0x3f75be48bf463f6d,0xbef1bf0e3f7fbec4,0x3f55bf6d3e483f35,0xbf0ebec43f7bbf35,0x3dc9bf553f75bec4,0xbf22be483f62bf6d
.quad 0xbf3500003f35bf80,0xbf3500003f35bf80,0xbf7f3f55be95bec4,0xbf463e483ef1bf6d,0xbf0e3f6dbf7b3f35,0xbf553ec43e48bf35,0x3e953e48bf223f6d,0xbf623f0ebdc9bec4
.quad 0x3f6dbf353ec40000,0xbf6d3f35bec40000,0x3f62bf7b3f7fbf6d,0xbf753f55bf223ec4,0x3e48bec43f0ebf35,0xbf7b3f6dbf553f35,0xbf223f0ebef13ec4,0xbf7f3f7bbf753f6d
.quad 0xbf803f80bf803f80,0xbf803f80bf803f80,0xbf753f7bbf7f3f80,0xbef13f0ebf223f35,0xbf553f6dbf7b3f80,0x3f0ebec43e480000,0xbf223f55bf753f80,0x3f7fbf7b3f62bf35
.quad 0xbec43f35bf6d3f80,0x3ec4bf353f6dbf80,0xbdc93f0ebf623f80,0xbf223e483e95bf35,0x3e483ec4bf553f80,0xbf7b3f6dbf0e0000,0x3ef13e48bf463f80,0xbe953f55bf7f3f35
.quad 0x3f350000bf353f80,0x3f350000bf353f80,0x3f62be48bf223f80,0x3f75bf553dc93f35,0x3f7bbec4bf0e3f80,0x3e48bf6d3f550000,0x3f7fbf0ebef13f80,0xbf46be483f75bf35
.quad 0x3f6dbf35bec43f80,0xbf6d3f353ec4bf80,0x3f46bf55be953f80,0xbdc93f7bbef1bf35,0x3f0ebf6dbe483f80,0x3f553ec4bf7b0000,0x3e95bf7bbdc93f80,0x3f62bf0ebf463f35
.quad 0xbf8000003f80,0xbf8000003f80,0xbe95bf7b3dc93f80,0xbf62bf0e3f463f35,0xbf0ebf6d3e483f80,0xbf553ec43f7b0000,0xbf46bf553e953f80,0x3dc93f7b3ef1bf35
.quad 0xbf6dbf353ec43f80,0x3f6d3f35bec4bf80,0xbf7fbf0e3ef13f80,0x3f46be48bf75bf35,0xbf7bbec43f0e3f80,0xbe48bf6dbf550000,0xbf62be483f223f80,0xbf75bf55bdc93f35
.quad 0xbf3500003f353f80,0xbf3500003f353f80,0xbef13e483f463f80,0x3e953f553f7f3f35,0xbe483ec43f553f80,0x3f7b3f6d3f0e0000,0x3dc93f0e3f623f80,0x3f223e48be95bf35
.quad 0x3ec43f353f6d3f80,0xbec4bf35bf6dbf80,0x3f223f553f753f80,0xbf7fbf7bbf62bf35,0x3f553f6d3f7b3f80,0xbf0ebec4be480000,0x3f753f7b3f7f3f80,0x3ef13f0e3f223f35
.quad 0xbf803f80bf803f80,0xbf803f80bf803f80,0xbf463f55bf623f6d,0xbdc93e48be953ec4,0xbe483ec4bf0e3f35,0x3f7bbf6d3f55bf35,0x3ef1be48bdc93ec4,0x3e95bf0e3f46bf6d
.quad 0x3f6dbf353ec40000,0xbf6d3f35bec40000,0x3f75bf7b3f46bec4,0xbef13f55bf7f3f6d,0x3f0ebf6d3f7bbf35,0x3f55bec4be483f35,0xbdc9bf0e3f75bf6d,0x3f22bf7b3f62bec4
.quad 0xbf3500003f35bf80,0xbf3500003f35bf80,0xbf7f3f0e3e95bf6d,0xbf463f7bbef1bec4,0xbf553f6dbe48bf35,0x3f0e3ec4bf7b3f35,0xbe953f7bbf22bec4,0x3f62bf55bdc93f6d
.quad 0x3ec43f35bf6d0000,0xbec4bf353f6d0000,0x3f623e48bf7f3ec4,0xbf753f0e3f22bf6d,0x3f7bbec4bf553f35,0x3e483f6dbf0ebf35,0x3f22bf55bef13f6d,0x3f7fbe48bf753ec4
.quad 0xbf8000003f80,0xbf8000003f80,0xbf22bf553ef13f6d,0xbf7fbe483f753ec4,0xbf7bbec43f553f35,0xbe483f6d3f0ebf35,0xbf623e483f7f3ec4,0x3f753f0ebf22bf6d
.quad 0xbec43f353f6d0000,0x3ec4bf35bf6d0000,0x3e953f7b3f22bec4,0xbf62bf553dc93f6d,0x3f553f6d3e48bf35,0xbf0e3ec43f7b3f35,0x3f7f3f0ebe95bf6d,0x3f463f7b3ef1bec4
.quad 0x3f350000bf35bf80,0x3f350000bf35bf80,0x3dc9bf0ebf75bf6d,0xbf22bf7bbf62bec4,0xbf0ebf6dbf7bbf35,0xbf55bec43e483f35,0xbf75bf7bbf46bec4,0x3ef13f553f7f3f6d
.quad 0xbf6dbf35bec40000,0x3f6d3f353ec40000,0xbef1be483dc93ec4,0xbe95bf0ebf46bf6d,0x3e483ec43f0e3f35,0xbf7bbf6dbf55bf35,0x3f463f553f623f6d,0x3dc93e483e953ec4
.quad 0xbf803f80bf803f80,0xbf803f80bf803f80,0x3e95be483dc90000,0x3f62bf553f46bf35,0x3f55bf6d3f7bbf80,0xbf0e3ec4be480000,0xbf463f0ebe950000,0x3dc93e48bef13f35
.quad 0xbec43f35bf6d3f80,0x3ec4bf353f6dbf80,0x3f7fbf553ef10000,0xbf463f7bbf753f35,0xbe48bec43f55bf80,0x3f7bbf6d3f0e0000,0xbf623f7bbf220000,0xbf753f0e3dc9bf35
.quad 0x3f350000bf353f80,0x3f350000bf353f80,0x3ef1bf7b3f460000,0xbe95bf0e3f7fbf35,0xbf7b3ec43f0ebf80,0xbe483f6dbf550000,0x3dc93f55bf620000,0x3f22bf7b3e953f35
.quad 0x3f6dbf35bec43f80,0xbf6d3f353ec4bf80,0xbf22bf0e3f750000,0x3f7fbe48bf623f35,0xbf0e3f6d3e48bf80,0xbf55bec43f7b0000,0x3f753e48bf7f0000,0x3ef13f55bf22bf35
.quad 0xbf8000003f80,0xbf8000003f80,0xbf753e483f7f0000,0xbef13f553f22bf35,0x3f0e3f6dbe48bf80,0x3f55bec4bf7b0000,0x3f22bf0ebf750000,0xbf7fbe483f623f35
.quad 0xbf6dbf353ec43f80,0x3f6d3f35bec4bf80,0xbdc93f553f620000,0xbf22bf7bbe953f35,0x3f7b3ec4bf0ebf80,0x3e483f6d3f550000,0xbef1bf7bbf460000,0x3e95bf0ebf7fbf35
.quad 0xbf3500003f353f80,0xbf3500003f353f80,0x3f623f7b3f220000,0x3f753f0ebdc9bf35,0x3e48bec4bf55bf80,0xbf7bbf6dbf0e0000,0xbf7fbf55bef10000,0x3f463f7b3f753f35
.quad 0x3ec43f353f6d3f80,0xbec4bf35bf6dbf80,0x3f463f0e3e950000,0xbdc93e483ef13f35,0xbf55bf6dbf7bbf80,0x3f0e3ec43e480000,0xbe95be48bdc90000,0xbf62bf55bf46bf35
.quad 0xbf803f80bf803f80,0xbf803f80bf803f80,0x3f22bf0e3ef1bec4,0x3f7fbf7b3f75bf6d,0x3e48bec43f0ebf35,0xbf7b3f6dbf553f35,0xbf623f7bbf7f3f6d,0x3f75bf553f22bec4
.quad 0x3f6dbf353ec40000,0xbf6d3f35bec40000,0xbe95be483f22bf6d,0x3f62bf0e3dc93ec4,0xbf0e3f6dbf7b3f35,0xbf553ec43e48bf35,0x3f7fbf553e953ec4,0x3f46be48bef13f6d
.quad 0xbf3500003f35bf80,0xbf3500003f35bf80,0xbdc93f55bf753ec4,0x3f223e48bf623f6d,0x3f55bf6d3e483f35,0xbf0ebec43f7bbf35,0xbf753e483f46bf6d,0x3ef13f0ebf7f3ec4
.quad 0x3ec43f35bf6d0000,0xbec4bf353f6d0000,0x3ef1bf7b3dc93f6d,0x3e953f55bf46bec4,0xbf7b3ec43f55bf35,0xbe48bf6d3f0e3f35,0x3f463f0ebf62bec4,0x3dc93f7bbe95bf6d
.quad 0xbf8000003f80,0xbf8000003f80,0xbf463f0e3f62bec4,0xbdc93f7b3e95bf6d,0x3f7b3ec4bf55bf35,0x3e48bf6dbf0e3f35,0xbef1bf7bbdc93f6d,0xbe953f553f46bec4
.quad 0xbec43f353f6d0000,0x3ec4bf35bf6d0000,0x3f753e48bf46bf6d,0xbef13f0e3f7f3ec4,0xbf55bf6dbe483f35,0x3f0ebec4bf7bbf35,0x3dc93f553f753ec4,0xbf223e483f623f6d
.quad 0x3f350000bf35bf80,0x3f350000bf35bf80,0xbf7fbf55be953ec4,0xbf46be483ef13f6d,0x3f0e3f6d3f7b3f35,0x3f553ec4be48bf35,0x3e95be48bf22bf6d,0xbf62bf0ebdc93ec4
.quad 0xbf6dbf35bec40000,0x3f6d3f353ec40000,0x3f623f7b3f7f3f6d,0xbf75bf55bf22bec4,0xbe48bec4bf0ebf35,0x3f7b3f6d3f553f35,0xbf22bf0ebef1bec4,0xbf7fbf7bbf75bf6d
.quad 0xbf803f80bf803f80,0xbf803f80bf803f80,0x3f75bf7b3f7fbf80,0x3ef1bf0e3f22bf35,0xbf553f6dbf7b3f80,0x3f0ebec43e480000,0x3f22bf553f75bf80,0xbf7f3f7bbf623f35
.quad 0xbec43f35bf6d3f80,0x3ec4bf353f6dbf80,0x3dc9bf0e3f62bf80,0x3f22be48be953f35,0x3e483ec4bf553f80,0xbf7b3f6dbf0e0000,0xbef1be483f46bf80,0x3e95bf553f7fbf35
.quad 0x3f350000bf353f80,0x3f350000bf353f80,0xbf623e483f22bf80,0xbf753f55bdc9bf35,0x3f7bbec4bf0e3f80,0x3e48bf6d3f550000,0xbf7f3f0e3ef1bf80,0x3f463e48bf753f35
.quad 0x3f6dbf35bec43f80,0xbf6d3f353ec4bf80,0xbf463f553e95bf80,0x3dc9bf7b3ef13f35,0x3f0ebf6dbe483f80,0x3f553ec4bf7b0000,0xbe953f7b3dc9bf80,0xbf623f0e3f46bf35
.quad 0xbf8000003f80,0xbf8000003f80,0x3e953f7bbdc9bf80,0x3f623f0ebf46bf35,0xbf0ebf6d3e483f80,0xbf553ec43f7b0000,0x3f463f55be95bf80,0xbdc9bf7bbef13f35
.quad 0xbf6dbf353ec43f80,0x3f6d3f35bec4bf80,0x3f7f3f0ebef1bf80,0xbf463e483f753f35,0xbf7bbec43f0e3f80,0xbe48bf6dbf550000,0x3f623e48bf22bf80,0x3f753f553dc9bf35
.quad 0xbf3500003f353f80,0xbf3500003f353f80,0x3ef1be48bf46bf80,0xbe95bf55bf7fbf35,0xbe483ec43f553f80,0x3f7b3f6d3f0e0000,0xbdc9bf0ebf62bf80,0xbf22be483e953f35
.quad 0x3ec43f353f6d3f80,0xbec4bf35bf6dbf80,0xbf22bf55bf75bf80,0x3f7f3f7b3f623f35,0x3f553f6d3f7b3f80,0xbf0ebec4be480000,0xbf75bf7bbf7fbf80,0xbef1bf0ebf22bf35
.quad 0xbf803f80bf803f80,0xbf803f80bf803f80,0x3f46bf553f62bf6d,0x3dc9be483e95bec4,0xbe483ec4bf0e3f35,0x3f7bbf6d3f55bf35,0xbef13e483dc9bec4,0xbe953f0ebf463f6d
.quad 0x3f6dbf353ec40000,0xbf6d3f35bec40000,0xbf753f7bbf463ec4,0x3ef1bf553f7fbf6d,0x3f0ebf6d3f7bbf35,0x3f55bec4be483f35,0x3dc93f0ebf753f6d,0xbf223f7bbf623ec4
.quad 0xbf3500003f35bf80,0xbf3500003f35bf80,0x3f7fbf0ebe953f6d,0x3f46bf7b3ef13ec4,0xbf553f6dbe48bf35,0x3f0e3ec4bf7b3f35,0x3e95bf7b3f223ec4,0xbf623f553dc9bf6d
.quad 0x3ec43f35bf6d0000,0xbec4bf353f6d0000,0xbf62be483f7fbec4,0x3f75bf0ebf223f6d,0x3f7bbec4bf553f35,0x3e483f6dbf0ebf35,0xbf223f553ef1bf6d,0xbf7f3e483f75bec4
.quad 0xbf8000003f80,0xbf8000003f80,0x3f223f55bef1bf6d,0x3f7f3e48bf75bec4,0xbf7bbec43f553f35,0xbe483f6d3f0ebf35,0x3f62be48bf7fbec4,0xbf75bf0e3f223f6d
.quad 0xbec43f353f6d0000,0x3ec4bf35bf6d0000,0xbe95bf7bbf223ec4,0x3f623f55bdc9bf6d,0x3f553f6d3e48bf35,0xbf0e3ec43f7b3f35,0xbf7fbf0e3e953f6d,0xbf46bf7bbef13ec4
.quad 0x3f350000bf35bf80,0x3f350000bf35bf80,0xbdc93f0e3f753f6d,0x3f223f7b3f623ec4,0xbf0ebf6dbf7bbf35,0xbf55bec43e483f35,0x3f753f7b3f463ec4,0xbef1bf55bf7fbf6d
.quad 0xbf6dbf35bec40000,0x3f6d3f353ec40000,0x3ef13e48bdc9bec4,0x3e953f0e3f463f6d,0x3e483ec43f0e3f35,0xbf7bbf6dbf55bf35,0xbf46bf55bf62bf6d,0xbdc9be48be95bec4
.quad 0xbf803f80bf803f80,0xbf803f80bf803f80,0xbe953e48bdc90000,0xbf623f55bf463f35,0x3f55bf6d3f7bbf80,0xbf0e3ec4be480000,0x3f46bf0e3e950000,0xbdc9be483ef1bf35
.quad 0xbec43f35bf6d3f80,0x3ec4bf353f6dbf80,0xbf7f3f55bef10000,0x3f46bf7b3f75bf35,0xbe48bec43f55bf80,0x3f7bbf6d3f0e0000,0x3f62bf7b3f220000,0x3f75bf0ebdc93f35
.quad 0x3f350000bf353f80,0x3f350000bf353f80,0xbef13f7bbf460000,0x3e953f0ebf7f3f35,0xbf7b3ec43f0ebf80,0xbe483f6dbf550000,0xbdc9bf553f620000,0xbf223f7bbe95bf35
.quad 0x3f6dbf35bec43f80,0xbf6d3f353ec4bf80,0x3f223f0ebf750000,0xbf7f3e483f62bf35,0xbf0e3f6d3e48bf80,0xbf55bec43f7b0000,0xbf75be483f7f0000,0xbef1bf553f223f35
.quad 0xbf8000003f80,0xbf8000003f80,0x3f75be48bf7f0000,0x3ef1bf55bf223f35,0x3f0e3f6dbe48bf80,0x3f55bec4bf7b0000,0xbf223f0e3f750000,0x3f7f3e48bf62bf35
.quad 0xbf6dbf353ec43f80,0x3f6d3f35bec4bf80,0x3dc9bf55bf620000,0x3f223f7b3e95bf35,0x3f7b3ec4bf0ebf80,0x3e483f6d3f550000,0x3ef13f7b3f460000,0xbe953f0e3f7f3f35
.quad 0xbf3500003f353f80,0xbf3500003f353f80,0xbf62bf7bbf220000,0xbf75bf0e3dc93f35,0x3e48bec4bf55bf80,0xbf7bbf6dbf0e0000,0x3f7f3f553ef10000,0xbf46bf7bbf75bf35
.quad 0x3ec43f353f6d3f80,0xbec4bf35bf6dbf80,0xbf46bf0ebe950000,0x3dc9be48bef1bf35,0xbf55bf6dbf7bbf80,0x3f0e3ec43e480000,0x3e953e483dc90000,0x3f623f553f463f35
.quad 0xbf803f80bf803f80,0xbf803f80bf803f80,0xbf223f0ebef13ec4,0xbf7f3f7bbf753f6d,0x3e48bec43f0ebf35,0xbf7b3f6dbf553f35,0x3f62bf7b3f7fbf6d,0xbf753f55bf223ec4
.quad 0x3f6dbf353ec40000,0xbf6d3f35bec40000,0x3e953e48bf223f6d,0xbf623f0ebdc9bec4,0xbf0e3f6dbf7b3f35,0xbf553ec43e48bf35,0xbf7f3f55be95bec4,0xbf463e483ef1bf6d
.quad 0xbf3500003f35bf80,0xbf3500003f35bf80,0x3dc9bf553f75bec4,0xbf22be483f62bf6d,0x3f55bf6d3e483f35,0xbf0ebec43f7bbf35,0x3f75be48bf463f6d,0xbef1bf0e3f7fbec4
.quad 0x3ec43f35bf6d0000,0xbec4bf353f6d0000,0xbef13f7bbdc9bf6d,0xbe95bf553f463ec4,0xbf7b3ec43f55bf35,0xbe48bf6d3f0e3f35,0xbf46bf0e3f623ec4,0xbdc9bf7b3e953f6d
.quad 0xbf8000003f80,0xbf8000003f80,0x3f46bf0ebf623ec4,0x3dc9bf7bbe953f6d,0x3f7b3ec4bf55bf35,0x3e48bf6dbf0e3f35,0x3ef13f7b3dc9bf6d,0x3e95bf55bf463ec4
.quad 0xbec43f353f6d0000,0x3ec4bf35bf6d0000,0xbf75be483f463f6d,0x3ef1bf0ebf7fbec4,0xbf55bf6dbe483f35,0x3f0ebec4bf7bbf35,0xbdc9bf55bf75bec4,0x3f22be48bf62bf6d
.quad 0x3f350000bf35bf80,0x3f350000bf35bf80,0x3f7f3f553e95bec4,0x3f463e48bef1bf6d,0x3f0e3f6d3f7b3f35,0x3f553ec4be48bf35,0xbe953e483f223f6d,0x3f623f0e3dc9bec4
.quad 0xbf6dbf35bec40000,0x3f6d3f353ec40000,0xbf62bf7bbf7fbf6d,0x3f753f553f223ec4,0xbe48bec4bf0ebf35,0x3f7b3f6d3f553f35,0x3f223f0e3ef13ec4,0x3f7f3f7b3f753f6d
.quad 0x0,0x0,0x3e953e483dc90000,0x3f623f553f463f35,0x3f0e3ec43e480000,0x3f553f6d3f7b3f80,0x3f463f0e3e950000,0xbdc93e483ef13f35
.quad 0x3f6d3f353ec40000,0xbf6dbf35bec40000,0x3f7f3f553ef10000,0xbf46bf7bbf75bf35,0x3f7b3f6d3f0e0000,0x3e48bec4bf55bf80,0x3f623f7b3f220000,0x3f753f0ebdc9bf35
.quad 0x3f353f803f350000,0x3f353f803f350000,0x3ef13f7b3f460000,0xbe953f0e3f7f3f35,0x3e483f6d3f550000,0xbf7bbec43f0e3f80,0xbdc93f553f620000,0xbf22bf7bbe953f35
.quad 0xbec43f353f6d0000,0x3ec4bf35bf6d0000,0xbf223f0e3f750000,0x3f7f3e48bf62bf35,0xbf553ec43f7b0000,0x3f0e3f6dbe48bf80,0xbf753e483f7f0000,0xbef13f553f22bf35
.quad 0xbf8000003f800000,0xbf8000003f800000,0xbf75be483f7f0000,0xbef1bf553f223f35,0xbf55bec43f7b0000,0x3f0ebf6dbe483f80,0xbf22bf0e3f750000,0x3f7fbe48bf623f35
.quad 0xbec4bf353f6d0000,0x3ec43f35bf6d0000,0xbdc9bf553f620000,0xbf223f7bbe95bf35,0x3e48bf6d3f550000,0xbf7b3ec43f0ebf80,0x3ef1bf7b3f460000,0xbe95bf0e3f7fbf35
.quad 0x3f35bf803f350000,0x3f35bf803f350000,0x3f62bf7b3f220000,0x3f75bf0ebdc93f35,0x3f7bbf6d3f0e0000,0x3e483ec4bf553f80,0x3f7fbf553ef10000,0xbf463f7bbf753f35
.quad 0x3f6dbf353ec40000,0xbf6d3f35bec40000,0x3f46bf0e3e950000,0xbdc9be483ef1bf35,0x3f0ebec43e480000,0x3f55bf6d3f7bbf80,0x3e95be483dc90000,0x3f62bf553f46bf35
.quad 0x0,0x0,0x3f223f0e3ef13ec4,0x3f7f3f7b3f753f6d,0x3f7b3f6d3f553f35,0x3e483ec43f0e3f35,0x3f623f7b3f7f3f6d,0xbf75bf55bf22bec4
.quad 0x3ec43f353f6d3f80,0xbec4bf35bf6dbf80,0xbe953e483f223f6d,0x3f623f0e3dc9bec4,0xbf55bec43e483f35,0x3f0e3f6d3f7b3f35,0xbf7fbf55be953ec4,0xbf46be483ef13f6d
.quad 0xbf35bf80bf350000,0xbf35bf80bf350000,0xbdc9bf55bf75bec4,0x3f22be48bf62bf6d,0x3f0ebec4bf7bbf35,0x3f553f6d3e48bf35,0x3f753e48bf46bf6d,0xbef13f0e3f7f3ec4
.quad 0x3f6d3f35bec4bf80,0xbf6dbf353ec43f80,0x3ef13f7b3dc9bf6d,0x3e95bf55bf463ec4,0xbe483f6d3f0ebf35,0x3f7b3ec4bf55bf35,0xbf463f0e3f62bec4,0xbdc93f7b3e95bf6d
.quad 0xbf8000003f800000,0xbf8000003f800000,0xbf46bf0e3f623ec4,0xbdc9bf7b3e953f6d,0xbe48bf6d3f0e3f35,0x3f7bbec4bf553f35,0x3ef1bf7b3dc93f6d,0x3e953f55bf46bec4
.quad 0x3f6dbf35bec43f80,0xbf6d3f353ec4bf80,0x3f75be48bf463f6d,0xbef1bf0e3f7fbec4,0x3f0e3ec4bf7b3f35,0x3f55bf6d3e483f35,0xbdc93f55bf753ec4,0x3f223e48bf623f6d
.quad 0xbf353f80bf350000,0xbf353f80bf350000,0xbf7f3f55be95bec4,0xbf463e483ef1bf6d,0xbf553ec43e48bf35,0x3f0ebf6d3f7bbf35,0xbe95be483f22bf6d,0x3f62bf0e3dc93ec4
.quad 0x3ec4bf353f6dbf80,0xbec43f35bf6d3f80,0x3f62bf7b3f7fbf6d,0xbf753f55bf223ec4,0x3f7bbf6d3f55bf35,0x3e48bec43f0ebf35,0x3f22bf0e3ef1bec4,0x3f7fbf7b3f75bf6d
.quad 0x0,0x0,0x3f753f7b3f7f3f80,0x3ef13f0e3f223f35,0xbf0ebec4be480000,0xbf55bf6dbf7bbf80,0xbf22bf55bf75bf80,0x3f7f3f7b3f623f35
.quad 0x3f6d3f353ec40000,0xbf6dbf35bec40000,0x3dc93f0e3f623f80,0x3f223e48be95bf35,0xbf7bbf6dbf0e0000,0xbe483ec43f553f80,0x3ef1be48bf46bf80,0xbe95bf55bf7fbf35
.quad 0x3f353f803f350000,0x3f353f803f350000,0xbf62be483f223f80,0xbf75bf55bdc93f35,0xbe48bf6dbf550000,0x3f7b3ec4bf0ebf80,0x3f7f3f0ebef1bf80,0xbf463e483f753f35
.quad 0xbec43f353f6d0000,0x3ec4bf35bf6d0000,0xbf46bf553e953f80,0x3dc93f7b3ef1bf35,0x3f55bec4bf7b0000,0xbf0ebf6d3e483f80,0x3e953f7bbdc9bf80,0x3f623f0ebf46bf35
.quad 0xbf8000003f800000,0xbf8000003f800000,0x3e95bf7bbdc93f80,0x3f62bf0ebf463f35,0x3f553ec4bf7b0000,0xbf0e3f6d3e48bf80,0xbf463f553e95bf80,0x3dc9bf7b3ef13f35
.quad 0xbec4bf353f6d0000,0x3ec43f35bf6d0000,0x3f7fbf0ebef13f80,0xbf46be483f75bf35,0xbe483f6dbf550000,0x3f7bbec4bf0e3f80,0xbf623e483f22bf80,0xbf753f55bdc9bf35
.quad 0x3f35bf803f350000,0x3f35bf803f350000,0x3ef13e48bf463f80,0xbe953f55bf7f3f35,0xbf7b3f6dbf0e0000,0xbe48bec43f55bf80,0x3dc9bf0e3f62bf80,0x3f22be48be953f35
.quad 0x3f6dbf353ec40000,0xbf6d3f35bec40000,0xbf223f55bf753f80,0x3f7fbf7b3f62bf35,0xbf0e3ec4be480000,0xbf553f6dbf7b3f80,0x3f75bf7b3f7fbf80,0x3ef1bf0e3f22bf35
.quad 0x0,0x0,0x3f463f553f623f6d,0x3dc93e483e953ec4,0xbf7bbf6dbf55bf35,0xbe48bec4bf0ebf35,0x3ef13e48bdc9bec4,0x3e953f0e3f463f6d
.quad 0x3ec43f353f6d3f80,0xbec4bf35bf6dbf80,0xbf75bf7bbf46bec4,0x3ef13f553f7f3f6d,0x3f553ec4be48bf35,0xbf0ebf6dbf7bbf35,0xbdc93f0e3f753f6d,0x3f223f7b3f623ec4
.quad 0xbf35bf80bf350000,0xbf35bf80bf350000,0x3f7f3f0ebe95bf6d,0x3f463f7b3ef1bec4,0xbf0e3ec43f7b3f35,0xbf55bf6dbe483f35,0xbe95bf7bbf223ec4,0x3f623f55bdc9bf6d
.quad 0x3f6d3f35bec4bf80,0xbf6dbf353ec43f80,0xbf623e483f7f3ec4,0x3f753f0ebf22bf6d,0x3e48bf6dbf0e3f35,0xbf7bbec43f553f35,0x3f223f55bef1bf6d,0x3f7f3e48bf75bec4
.quad 0xbf8000003f800000,0xbf8000003f800000,0x3f22bf55bef13f6d,0x3f7fbe48bf753ec4,0x3e483f6dbf0ebf35,0xbf7b3ec43f55bf35,0xbf62be483f7fbec4,0x3f75bf0ebf223f6d
.quad 0x3f6dbf35bec43f80,0xbf6d3f353ec4bf80,0xbe953f7bbf22bec4,0x3f62bf55bdc93f6d,0xbf0ebec43f7bbf35,0xbf553f6dbe48bf35,0x3f7fbf0ebe953f6d,0x3f46bf7b3ef13ec4
.quad 0xbf353f80bf350000,0xbf353f80bf350000,0xbdc9bf0e3f75bf6d,0x3f22bf7b3f62bec4,0x3f55bec4be483f35,0xbf0e3f6dbf7b3f35,0xbf753f7bbf463ec4,0x3ef1bf553f7fbf6d
.quad 0x3ec4bf353f6dbf80,0xbec43f35bf6d3f80,0x3ef1be48bdc93ec4,0x3e95bf0e3f46bf6d,0xbf7b3f6dbf553f35,0xbe483ec4bf0e3f35,0x3f46bf553f62bf6d,0x3dc9be483e95bec4
.quad 0x0,0x0,0xbe95be48bdc90000,0xbf62bf55bf46bf35,0x3f0e3ec43e480000,0x3f553f6d3f7b3f80,0xbf46bf0ebe950000,0x3dc9be48bef1bf35
.quad 0x3f6d3f353ec40000,0xbf6dbf35bec40000,0xbf7fbf55bef10000,0x3f463f7b3f753f35,0x3f7b3f6d3f0e0000,0x3e48bec4bf55bf80,0xbf62bf7bbf220000,0xbf75bf0e3dc93f35
.quad 0x3f353f803f350000,0x3f353f803f350000,0xbef1bf7bbf460000,0x3e95bf0ebf7fbf35,0x3e483f6d3f550000,0xbf7bbec43f0e3f80,0x3dc9bf55bf620000,0x3f223f7b3e95bf35
.quad 0xbec43f353f6d0000,0x3ec4bf35bf6d0000,0x3f22bf0ebf750000,0xbf7fbe483f623f35,0xbf553ec43f7b0000,0x3f0e3f6dbe48bf80,0x3f75be48bf7f0000,0x3ef1bf55bf223f35
.quad 0xbf8000003f800000,0xbf8000003f800000,0x3f753e48bf7f0000,0x3ef13f55bf22bf35,0xbf55bec43f7b0000,0x3f0ebf6dbe483f80,0x3f223f0ebf750000,0xbf7f3e483f62bf35
.quad 0xbec4bf353f6d0000,0x3ec43f35bf6d0000,0x3dc93f55bf620000,0x3f22bf7b3e953f35,0x3e48bf6d3f550000,0xbf7b3ec43f0ebf80,0xbef13f7bbf460000,0x3e953f0ebf7f3f35
.quad 0x3f35bf803f350000,0x3f35bf803f350000,0xbf623f7bbf220000,0xbf753f0e3dc9bf35,0x3f7bbf6d3f0e0000,0x3e483ec4bf553f80,0xbf7f3f55bef10000,0x3f46bf7b3f75bf35
.quad 0x3f6dbf353ec40000,0xbf6d3f35bec40000,0xbf463f0ebe950000,0x3dc93e48bef13f35,0x3f0ebec43e480000,0x3f55bf6d3f7bbf80,0xbe953e48bdc90000,0xbf623f55bf463f35
.quad 0x0,0x0,0xbf22bf0ebef1bec4,0xbf7fbf7bbf75bf6d,0x3f7b3f6d3f553f35,0x3e483ec43f0e3f35,0xbf62bf7bbf7fbf6d,0x3f753f553f223ec4
.quad 0x3ec43f353f6d3f80,0xbec4bf35bf6dbf80,0x3e95be48bf22bf6d,0xbf62bf0ebdc93ec4,0xbf55bec43e483f35,0x3f0e3f6d3f7b3f35,0x3f7f3f553e95bec4,0x3f463e48bef1bf6d
.quad 0xbf35bf80bf350000,0xbf35bf80bf350000,0x3dc93f553f753ec4,0xbf223e483f623f6d,0x3f0ebec4bf7bbf35,0x3f553f6d3e48bf35,0xbf75be483f463f6d,0x3ef1bf0ebf7fbec4
.quad 0x3f6d3f35bec4bf80,0xbf6dbf353ec43f80,0xbef1bf7bbdc93f6d,0xbe953f553f46bec4,0xbe483f6d3f0ebf35,0x3f7b3ec4bf55bf35,0x3f46bf0ebf623ec4,0x3dc9bf7bbe953f6d
.quad 0xbf8000003f800000,0xbf8000003f800000,0x3f463f0ebf62bec4,0x3dc93f7bbe95bf6d,0xbe48bf6d3f0e3f35,0x3f7bbec4bf553f35,0xbef13f7bbdc9bf6d,0xbe95bf553f463ec4
.quad 0x3f6dbf35bec43f80,0xbf6d3f353ec4bf80,0xbf753e483f46bf6d,0x3ef13f0ebf7f3ec4,0x3f0e3ec4bf7b3f35,0x3f55bf6d3e483f35,0x3dc9bf553f75bec4,0xbf22be483f62bf6d
.quad 0xbf353f80bf350000,0xbf353f80bf350000,0x3f7fbf553e953ec4,0x3f46be48bef13f6d,0xbf553ec43e48bf35,0x3f0ebf6d3f7bbf35,0x3e953e48bf223f6d,0xbf623f0ebdc9bec4
.quad 0x3ec4bf353f6dbf80,0xbec43f35bf6d3f80,0xbf623f7bbf7f3f6d,0x3f75bf553f22bec4,0x3f7bbf6d3f55bf35,0x3e48bec43f0ebf35,0xbf223f0ebef13ec4,0xbf7f3f7bbf753f6d
.quad 0x0,0x0,0xbf75bf7bbf7fbf80,0xbef1bf0ebf22bf35,0xbf0ebec4be480000,0xbf55bf6dbf7bbf80,0x3f223f553f753f80,0xbf7fbf7bbf62bf35
.quad 0x3f6d3f353ec40000,0xbf6dbf35bec40000,0xbdc9bf0ebf62bf80,0xbf22be483e953f35,0xbf7bbf6dbf0e0000,0xbe483ec43f553f80,0xbef13e483f463f80,0x3e953f553f7f3f35
.quad 0x3f353f803f350000,0x3f353f803f350000,0x3f623e48bf22bf80,0x3f753f553dc9bf35,0xbe48bf6dbf550000,0x3f7b3ec4bf0ebf80,0xbf7fbf0e3ef13f80,0x3f46be48bf75bf35
.quad 0xbec43f353f6d0000,0x3ec4bf35bf6d0000,0x3f463f55be95bf80,0xbdc9bf7bbef13f35,0x3f55bec4bf7b0000,0xbf0ebf6d3e483f80,0xbe95bf7b3dc93f80,0xbf62bf0e3f463f35
.quad 0xbf8000003f800000,0xbf8000003f800000,0xbe953f7b3dc9bf80,0xbf623f0e3f46bf35,0x3f553ec4bf7b0000,0xbf0e3f6d3e48bf80,0x3f46bf55be953f80,0xbdc93f7bbef1bf35
.quad 0xbec4bf353f6d0000,0x3ec43f35bf6d0000,0xbf7f3f0e3ef1bf80,0x3f463e48bf753f35,0xbe483f6dbf550000,0x3f7bbec4bf0e3f80,0x3f62be48bf223f80,0x3f75bf553dc93f35
.quad 0x3f35bf803f350000,0x3f35bf803f350000,0xbef1be483f46bf80,0x3e95bf553f7fbf35,0xbf7b3f6dbf0e0000,0xbe48bec43f55bf80,0xbdc93f0ebf623f80,0xbf223e483e95bf35
.quad 0x3f6dbf353ec40000,0xbf6d3f35bec40000,0x3f22bf553f75bf80,0xbf7f3f7bbf623f35,0xbf0e3ec4be480000,0xbf553f6dbf7b3f80,0xbf753f7bbf7f3f80,0xbef13f0ebf223f35
.quad 0x0,0x0,0xbf46bf55bf62bf6d,0xbdc9be48be95bec4,0xbf7bbf6dbf55bf35,0xbe48bec4bf0ebf35,0xbef1be483dc93ec4,0xbe95bf0ebf46bf6d
.quad 0x3ec43f353f6d3f80,0xbec4bf35bf6dbf80,0x3f753f7b3f463ec4,0xbef1bf55bf7fbf6d,0x3f553ec4be48bf35,0xbf0ebf6dbf7bbf35,0x3dc9bf0ebf75bf6d,0xbf22bf7bbf62bec4
.quad 0xbf35bf80bf350000,0xbf35bf80bf350000,0xbf7fbf0e3e953f6d,0xbf46bf7bbef13ec4,0xbf0e3ec43f7b3f35,0xbf55bf6dbe483f35,0x3e953f7b3f22bec4,0xbf62bf553dc93f6d
.quad 0x3f6d3f35bec4bf80,0xbf6dbf353ec43f80,0x3f62be48bf7fbec4,0xbf75bf0e3f223f6d,0x3e48bf6dbf0e3f35,0xbf7bbec43f553f35,0xbf22bf553ef13f6d,0xbf7fbe483f753ec4
.quad 0xbf8000003f800000,0xbf8000003f800000,0xbf223f553ef1bf6d,0xbf7f3e483f75bec4,0x3e483f6dbf0ebf35,0xbf7b3ec43f55bf35,0x3f623e48bf7f3ec4,0xbf753f0e3f22bf6d
.quad 0x3f6dbf35bec43f80,0xbf6d3f353ec4bf80,0x3e95bf7b3f223ec4,0xbf623f553dc9bf6d,0xbf0ebec43f7bbf35,0xbf553f6dbe48bf35,0xbf7f3f0e3e95bf6d,0xbf463f7bbef1bec4
.quad 0xbf353f80bf350000,0xbf353f80bf350000,0x3dc93f0ebf753f6d,0xbf223f7bbf623ec4,0x3f55bec4be483f35,0xbf0e3f6dbf7b3f35,0x3f75bf7b3f46bec4,0xbef13f55bf7f3f6d
.quad 0x3ec4bf353f6dbf80,0xbec43f35bf6d3f80,0xbef13e483dc9bec4,0xbe953f0ebf463f6d,0xbf7b3f6dbf553f35,0xbe483ec4bf0e3f35,0xbf463f55bf623f6d,0xbdc93e48be953ec4
.quad 0x0,0x0,0xbe953e48bdc90000,0xbf623f55bf463f35,0xbf0e3ec4be480000,0xbf553f6dbf7b3f80,0xbf463f0ebe950000,0x3dc93e48bef13f35
.quad 0xbf6d3f35bec40000,0x3f6dbf353ec40000,0xbf7f3f55bef10000,0x3f46bf7b3f75bf35,0xbf7b3f6dbf0e0000,0xbe48bec43f55bf80,0xbf623f7bbf220000,0xbf753f0e3dc9bf35
.quad 0xbf353f80bf350000,0xbf353f80bf350000,0xbef13f7bbf460000,0x3e953f0ebf7f3f35,0xbe483f6dbf550000,0x3f7bbec4bf0e3f80,0x3dc93f55bf620000,0x3f22bf7b3e953f35
.quad 0x3ec43f35bf6d0000,0xbec4bf353f6d0000,0x3f223f0ebf750000,0xbf7f3e483f62bf35,0x3f553ec4bf7b0000,0xbf0e3f6d3e48bf80,0x3f753e48bf7f0000,0x3ef13f55bf22bf35
.quad 0x3f800000bf800000,0x3f800000bf800000,0x3f75be48bf7f0000,0x3ef1bf55bf223f35,0x3f55bec4bf7b0000,0xbf0ebf6d3e483f80,0x3f22bf0ebf750000,0xbf7fbe483f623f35
.quad 0x3ec4bf35bf6d0000,0xbec43f353f6d0000,0x3dc9bf55bf620000,0x3f223f7b3e95bf35,0xbe48bf6dbf550000,0x3f7b3ec4bf0ebf80,0xbef1bf7bbf460000,0x3e95bf0ebf7fbf35
.quad 0xbf35bf80bf350000,0xbf35bf80bf350000,0xbf62bf7bbf220000,0xbf75bf0e3dc93f35,0xbf7bbf6dbf0e0000,0xbe483ec43f553f80,0xbf7fbf55bef10000,0x3f463f7b3f753f35
.quad 0xbf6dbf35bec40000,0x3f6d3f353ec40000,0xbf46bf0ebe950000,0x3dc9be48bef1bf35,0xbf0ebec4be480000,0xbf55bf6dbf7bbf80,0xbe95be48bdc90000,0xbf62bf55bf46bf35
.quad 0x0,0x0,0xbf223f0ebef13ec4,0xbf7f3f7bbf753f6d,0xbf7b3f6dbf553f35,0xbe483ec4bf0e3f35,0xbf623f7bbf7f3f6d,0x3f75bf553f22bec4
.quad 0xbec43f35bf6d3f80,0x3ec4bf353f6dbf80,0x3e953e48bf223f6d,0xbf623f0ebdc9bec4,0x3f55bec4be483f35,0xbf0e3f6dbf7b3f35,0x3f7fbf553e953ec4,0x3f46be48bef13f6d
.quad 0x3f35bf803f350000,0x3f35bf803f350000,0x3dc9bf553f75bec4,0xbf22be483f62bf6d,0xbf0ebec43f7bbf35,0xbf553f6dbe48bf35,0xbf753e483f46bf6d,0x3ef13f0ebf7f3ec4
.quad 0xbf6d3f353ec4bf80,0x3f6dbf35bec43f80,0xbef13f7bbdc9bf6d,0xbe95bf553f463ec4,0x3e483f6dbf0ebf35,0xbf7b3ec43f55bf35,0x3f463f0ebf62bec4,0x3dc93f7bbe95bf6d
.quad 0x3f800000bf800000,0x3f800000bf800000,0x3f46bf0ebf623ec4,0x3dc9bf7bbe953f6d,0x3e48bf6dbf0e3f35,0xbf7bbec43f553f35,0xbef1bf7bbdc93f6d,0xbe953f553f46bec4
.quad 0xbf6dbf353ec43f80,0x3f6d3f35bec4bf80,0xbf75be483f463f6d,0x3ef1bf0ebf7fbec4,0xbf0e3ec43f7b3f35,0xbf55bf6dbe483f35,0x3dc93f553f753ec4,0xbf223e483f623f6d
.quad 0x3f353f803f350000,0x3f353f803f350000,0x3f7f3f553e95bec4,0x3f463e48bef1bf6d,0x3f553ec4be48bf35,0xbf0ebf6dbf7bbf35,0x3e95be48bf22bf6d,0xbf62bf0ebdc93ec4
.quad 0xbec4bf35bf6dbf80,0x3ec43f353f6d3f80,0xbf62bf7bbf7fbf6d,0x3f753f553f223ec4,0xbf7bbf6dbf55bf35,0xbe48bec4bf0ebf35,0xbf22bf0ebef1bec4,0xbf7fbf7bbf75bf6d
.quad 0x0,0x0,0xbf753f7bbf7f3f80,0xbef13f0ebf223f35,0x3f0ebec43e480000,0x3f55bf6d3f7bbf80,0x3f22bf553f75bf80,0xbf7f3f7bbf623f35
.quad 0xbf6d3f35bec40000,0x3f6dbf353ec40000,0xbdc93f0ebf623f80,0xbf223e483e95bf35,0x3f7bbf6d3f0e0000,0x3e483ec4bf553f80,0xbef1be483f46bf80,0x3e95bf553f7fbf35
.quad 0xbf353f80bf350000,0xbf353f80bf350000,0x3f62be48bf223f80,0x3f75bf553dc93f35,0x3e48bf6d3f550000,0xbf7b3ec43f0ebf80,0xbf7f3f0e3ef1bf80,0x3f463e48bf753f35
.quad 0x3ec43f35bf6d0000,0xbec4bf353f6d0000,0x3f46bf55be953f80,0xbdc93f7bbef1bf35,0xbf55bec43f7b0000,0x3f0ebf6dbe483f80,0xbe953f7b3dc9bf80,0xbf623f0e3f46bf35
.quad 0x3f800000bf800000,0x3f800000bf800000,0xbe95bf7b3dc93f80,0xbf62bf0e3f463f35,0xbf553ec43f7b0000,0x3f0e3f6dbe48bf80,0x3f463f55be95bf80,0xbdc9bf7bbef13f35
.quad 0x3ec4bf35bf6d0000,0xbec43f353f6d0000,0xbf7fbf0e3ef13f80,0x3f46be48bf75bf35,0x3e483f6d3f550000,0xbf7bbec43f0e3f80,0x3f623e48bf22bf80,0x3f753f553dc9bf35
.quad 0xbf35bf80bf350000,0xbf35bf80bf350000,0xbef13e483f463f80,0x3e953f553f7f3f35,0x3f7b3f6d3f0e0000,0x3e48bec4bf55bf80,0xbdc9bf0ebf62bf80,0xbf22be483e953f35
.quad 0xbf6dbf35bec40000,0x3f6d3f353ec40000,0x3f223f553f753f80,0xbf7fbf7bbf62bf35,0x3f0e3ec43e480000,0x3f553f6d3f7b3f80,0xbf75bf7bbf7fbf80,0xbef1bf0ebf22bf35
.quad 0x0,0x0,0xbf463f55bf623f6d,0xbdc93e48be953ec4,0x3f7bbf6d3f55bf35,0x3e48bec43f0ebf35,0xbef13e483dc9bec4,0xbe953f0ebf463f6d
.quad 0xbec43f35bf6d3f80,0x3ec4bf353f6dbf80,0x3f75bf7b3f46bec4,0xbef13f55bf7f3f6d,0xbf553ec43e48bf35,0x3f0ebf6d3f7bbf35,0x3dc93f0ebf753f6d,0xbf223f7bbf623ec4
.quad 0x3f35bf803f350000,0x3f35bf803f350000,0xbf7f3f0e3e95bf6d,0xbf463f7bbef1bec4,0x3f0e3ec4bf7b3f35,0x3f55bf6d3e483f35,0x3e95bf7b3f223ec4,0xbf623f553dc9bf6d
.quad 0xbf6d3f353ec4bf80,0x3f6dbf35bec43f80,0x3f623e48bf7f3ec4,0xbf753f0e3f22bf6d,0xbe48bf6d3f0e3f35,0x3f7bbec4bf553f35,0xbf223f553ef1bf6d,0xbf7f3e483f75bec4
.quad 0x3f800000bf800000,0x3f800000bf800000,0xbf22bf553ef13f6d,0xbf7fbe483f753ec4,0xbe483f6d3f0ebf35,0x3f7b3ec4bf55bf35,0x3f62be48bf7fbec4,0xbf75bf0e3f223f6d
.quad 0xbf6dbf353ec43f80,0x3f6d3f35bec4bf80,0x3e953f7b3f22bec4,0xbf62bf553dc93f6d,0x3f0ebec4bf7bbf35,0x3f553f6d3e48bf35,0xbf7fbf0e3e953f6d,0xbf46bf7bbef13ec4
.quad 0x3f353f803f350000,0x3f353f803f350000,0x3dc9bf0ebf75bf6d,0xbf22bf7bbf62bec4,0xbf55bec43e483f35,0x3f0e3f6d3f7b3f35,0x3f753f7b3f463ec4,0xbef1bf55bf7fbf6d
.quad 0xbec4bf35bf6dbf80,0x3ec43f353f6d3f80,0xbef1be483dc93ec4,0xbe95bf0ebf46bf6d,0x3f7b3f6d3f553f35,0x3e483ec43f0e3f35,0xbf46bf55bf62bf6d,0xbdc9be48be95bec4
.quad 0x0,0x0,0x3e95be483dc90000,0x3f62bf553f46bf35,0xbf0e3ec4be480000,0xbf553f6dbf7b3f80,0x3f46bf0e3e950000,0xbdc9be483ef1bf35
.quad 0xbf6d3f35bec40000,0x3f6dbf353ec40000,0x3f7fbf553ef10000,0xbf463f7bbf753f35,0xbf7b3f6dbf0e0000,0xbe48bec43f55bf80,0x3f62bf7b3f220000,0x3f75bf0ebdc93f35
.quad 0xbf353f80bf350000,0xbf353f80bf350000,0x3ef1bf7b3f460000,0xbe95bf0e3f7fbf35,0xbe483f6dbf550000,0x3f7bbec4bf0e3f80,0xbdc9bf553f620000,0xbf223f7bbe95bf35
.quad 0x3ec43f35bf6d0000,0xbec4bf353f6d0000,0xbf22bf0e3f750000,0x3f7fbe48bf623f35,0x3f553ec4bf7b0000,0xbf0e3f6d3e48bf80,0xbf75be483f7f0000,0xbef1bf553f223f35
.quad 0x3f800000bf800000,0x3f800000bf800000,0xbf753e483f7f0000,0xbef13f553f22bf35,0x3f55bec4bf7b0000,0xbf0ebf6d3e483f80,0xbf223f0e3f750000,0x3f7f3e48bf62bf35
.quad 0x3ec4bf35bf6d0000,0xbec43f353f6d0000,0xbdc93f553f620000,0xbf22bf7bbe953f35,0xbe48bf6dbf550000,0x3f7b3ec4bf0ebf80,0x3ef13f7b3f460000,0xbe953f0e3f7f3f35
.quad 0xbf35bf80bf350000,0xbf35bf80bf350000,0x3f623f7b3f220000,0x3f753f0ebdc9bf35,0xbf7bbf6dbf0e0000,0xbe483ec43f553f80,0x3f7f3f553ef10000,0xbf46bf7bbf75bf35
.quad 0xbf6dbf35bec40000,0x3f6d3f353ec40000,0x3f463f0e3e950000,0xbdc93e483ef13f35,0xbf0ebec4be480000,0xbf55bf6dbf7bbf80,0x3e953e483dc90000,0x3f623f553f463f35
.quad 0x0,0x0,0x3f22bf0e3ef1bec4,0x3f7fbf7b3f75bf6d,0xbf7b3f6dbf553f35,0xbe483ec4bf0e3f35,0x3f62bf7b3f7fbf6d,0xbf753f55bf223ec4
.quad 0xbec43f35bf6d3f80,0x3ec4bf353f6dbf80,0xbe95be483f22bf6d,0x3f62bf0e3dc93ec4,0x3f55bec4be483f35,0xbf0e3f6dbf7b3f35,0xbf7f3f55be95bec4,0xbf463e483ef1bf6d
.quad 0x3f35bf803f350000,0x3f35bf803f350000,0xbdc93f55bf753ec4,0x3f223e48bf623f6d,0xbf0ebec43f7bbf35,0xbf553f6dbe48bf35,0x3f75be48bf463f6d,0xbef1bf0e3f7fbec4
.quad 0xbf6d3f353ec4bf80,0x3f6dbf35bec43f80,0x3ef1bf7b3dc93f6d,0x3e953f55bf46bec4,0x3e483f6dbf0ebf35,0xbf7b3ec43f55bf35,0xbf46bf0e3f623ec4,0xbdc9bf7b3e953f6d
.quad 0x3f800000bf800000,0x3f800000bf800000,0xbf463f0e3f62bec4,0xbdc93f7b3e95bf6d,0x3e48bf6dbf0e3f35,0xbf7bbec43f553f35,0x3ef13f7b3dc9bf6d,0x3e95bf55bf463ec4
.quad 0xbf6dbf353ec43f80,0x3f6d3f35bec4bf80,0x3f753e48bf46bf6d,0xbef13f0e3f7f3ec4,0xbf0e3ec43f7b3f35,0xbf55bf6dbe483f35,0xbdc9bf55bf75bec4,0x3f22be48bf62bf6d
.quad 0x3f353f803f350000,0x3f353f803f350000,0xbf7fbf55be953ec4,0xbf46be483ef13f6d,0x3f553ec4be48bf35,0xbf0ebf6dbf7bbf35,0xbe953e483f223f6d,0x3f623f0e3dc9bec4
.quad 0xbec4bf35bf6dbf80,0x3ec43f353f6d3f80,0x3f623f7b3f7f3f6d,0xbf75bf55bf22bec4,0xbf7bbf6dbf55bf35,0xbe48bec4bf0ebf35,0x3f223f0e3ef13ec4,0x3f7f3f7b3f753f6d
.quad 0x0,0x0,0x3f75bf7b3f7fbf80,0x3ef1bf0e3f22bf35,0x3f0ebec43e480000,0x3f55bf6d3f7bbf80,0xbf223f55bf753f80,0x3f7fbf7b3f62bf35
.quad 0xbf6d3f35bec40000,0x3f6dbf353ec40000,0x3dc9bf0e3f62bf80,0x3f22be48be953f35,0x3f7bbf6d3f0e0000,0x3e483ec4bf553f80,0x3ef13e48bf463f80,0xbe953f55bf7f3f35
.quad 0xbf353f80bf350000,0xbf353f80bf350000,0xbf623e483f22bf80,0xbf753f55bdc9bf35,0x3e48bf6d3f550000,0xbf7b3ec43f0ebf80,0x3f7fbf0ebef13f80,0xbf46be483f75bf35
.quad 0x3ec43f35bf6d0000,0xbec4bf353f6d0000,0xbf463f553e95bf80,0x3dc9bf7b3ef13f35,0xbf55bec43f7b0000,0x3f0ebf6dbe483f80,0x3e95bf7bbdc93f80,0x3f62bf0ebf463f35
.quad 0x3f800000bf800000,0x3f800000bf800000,0x3e953f7bbdc9bf80,0x3f623f0ebf46bf35,0xbf553ec43f7b0000,0x3f0e3f6dbe48bf80,0xbf46bf553e953f80,0x3dc93f7b3ef1bf35
.quad 0x3ec4bf35bf6d0000,0xbec43f353f6d0000,0x3f7f3f0ebef1bf80,0xbf463e483f753f35,0x3e483f6d3f550000,0xbf7bbec43f0e3f80,0xbf62be483f223f80,0xbf75bf55bdc93f35
.quad 0xbf35bf80bf350000,0xbf35bf80bf350000,0x3ef1be48bf46bf80,0xbe95bf55bf7fbf35,0x3f7b3f6d3f0e0000,0x3e48bec4bf55bf80,0x3dc93f0e3f623f80,0x3f223e48be95bf35
.quad 0xbf6dbf35bec40000,0x3f6d3f353ec40000,0xbf22bf55bf75bf80,0x3f7f3f7b3f623f35,0x3f0e3ec43e480000,0x3f553f6d3f7b3f80,0x3f753f7b3f7f3f80,0x3ef13f0e3f223f35
.quad 0x0,0x0,0x3f46bf553f62bf6d,0x3dc9be483e95bec4,0x3f7bbf6d3f55bf35,0x3e48bec43f0ebf35,0x3ef1be48bdc93ec4,0x3e95bf0e3f46bf6d
.quad 0xbec43f35bf6d3f80,0x3ec4bf353f6dbf80,0xbf753f7bbf463ec4,0x3ef1bf553f7fbf6d,0xbf553ec43e48bf35,0x3f0ebf6d3f7bbf35,0xbdc9bf0e3f75bf6d,0x3f22bf7b3f62bec4
.quad 0x3f35bf803f350000,0x3f35bf803f350000,0x3f7fbf0ebe953f6d,0x3f46bf7b3ef13ec4,0x3f0e3ec4bf7b3f35,0x3f55bf6d3e483f35,0xbe953f7bbf22bec4,0x3f62bf55bdc93f6d
.quad 0xbf6d3f353ec4bf80,0x3f6dbf35bec43f80,0xbf62be483f7fbec4,0x3f75bf0ebf223f6d,0xbe48bf6d3f0e3f35,0x3f7bbec4bf553f35,0x3f22bf55bef13f6d,0x3f7fbe48bf753ec4
.quad 0x3f800000bf800000,0x3f800000bf800000,0x3f223f55bef1bf6d,0x3f7f3e48bf75bec4,0xbe483f6d3f0ebf35,0x3f7b3ec4bf55bf35,0xbf623e483f7f3ec4,0x3f753f0ebf22bf6d
.quad 0xbf6dbf353ec43f80,0x3f6d3f35bec4bf80,0xbe95bf7bbf223ec4,0x3f623f55bdc9bf6d,0x3f0ebec4bf7bbf35,0x3f553f6d3e48bf35,0x3f7f3f0ebe95bf6d,0x3f463f7b3ef1bec4
.quad 0x3f353f803f350000,0x3f353f803f350000,0xbdc93f0e3f753f6d,0x3f223f7b3f623ec4,0xbf55bec43e483f35,0x3f0e3f6d3f7b3f35,0xbf75bf7bbf46bec4,0x3ef13f553f7f3f6d
.quad 0xbec4bf35bf6dbf80,0x3ec43f353f6d3f80,0x3ef13e48bdc9bec4,0x3e953f0e3f463f6d,0x3f7b3f6d3f553f35,0x3e483ec43f0e3f35,0x3f463f553f623f6d,0x3dc93e483e953ec4
.quad 0x8000800080008000,0x8000800080008000,0xbe95be48bdc98000,0xbf62bf55bf46bf35,0xbf0ebec4be488000,0xbf55bf6dbf7bbf80,0xbf46bf0ebe958000,0x3dc9be48bef1bf35
.quad 0xbf6dbf35bec48000,0x3f6d3f353ec48000,0xbf7fbf55bef18000,0x3f463f7b3f753f35,0xbf7bbf6dbf0e8000,0xbe483ec43f553f80,0xbf62bf7bbf228000,0xbf75bf0e3dc93f35
.quad 0xbf35bf80bf358000,0xbf35bf80bf358000,0xbef1bf7bbf468000,0x3e95bf0ebf7fbf35,0xbe48bf6dbf558000,0x3f7b3ec4bf0ebf80,0x3dc9bf55bf628000,0x3f223f7b3e95bf35
.quad 0x3ec4bf35bf6d8000,0xbec43f353f6d8000,0x3f22bf0ebf758000,0xbf7fbe483f623f35,0x3f55bec4bf7b8000,0xbf0ebf6d3e483f80,0x3f75be48bf7f8000,0x3ef1bf55bf223f35
.quad 0x3f808000bf808000,0x3f808000bf808000,0x3f753e48bf7f8000,0x3ef13f55bf22bf35,0x3f553ec4bf7b8000,0xbf0e3f6d3e48bf80,0x3f223f0ebf758000,0xbf7f3e483f62bf35
.quad 0x3ec43f35bf6d8000,0xbec4bf353f6d8000,0x3dc93f55bf628000,0x3f22bf7b3e953f35,0xbe483f6dbf558000,0x3f7bbec4bf0e3f80,0xbef13f7bbf468000,0x3e953f0ebf7f3f35
.quad 0xbf353f80bf358000,0xbf353f80bf358000,0xbf623f7bbf228000,0xbf753f0e3dc9bf35,0xbf7b3f6dbf0e8000,0xbe48bec43f55bf80,0xbf7f3f55bef18000,0x3f46bf7b3f75bf35
.quad 0xbf6d3f35bec48000,0x3f6dbf353ec48000,0xbf463f0ebe958000,0x3dc93e48bef13f35,0xbf0e3ec4be488000,0xbf553f6dbf7b3f80,0xbe953e48bdc98000,0xbf623f55bf463f35
.quad 0x8000800080008000,0x8000800080008000,0xbf22bf0ebef1bec4,0xbf7fbf7bbf75bf6d,0xbf7bbf6dbf55bf35,0xbe48bec4bf0ebf35,0xbf62bf7bbf7fbf6d,0x3f753f553f223ec4
.quad 0xbec4bf35bf6dbf80,0x3ec43f353f6d3f80,0x3e95be48bf22bf6d,0xbf62bf0ebdc93ec4,0x3f553ec4be48bf35,0xbf0ebf6dbf7bbf35,0x3f7f3f553e95bec4,0x3f463e48bef1bf6d
.quad 0x3f353f803f358000,0x3f353f803f358000,0x3dc93f553f753ec4,0xbf223e483f623f6d,0xbf0e3ec43f7b3f35,0xbf55bf6dbe483f35,0xbf75be483f463f6d,0x3ef1bf0ebf7fbec4
.quad 0xbf6dbf353ec43f80,0x3f6d3f35bec4bf80,0xbef1bf7bbdc93f6d,0xbe953f553f46bec4,0x3e48bf6dbf0e3f35,0xbf7bbec43f553f35,0x3f46bf0ebf623ec4,0x3dc9bf7bbe953f6d
.quad 0x3f808000bf808000,0x3f808000bf808000,0x3f463f0ebf62bec4,0x3dc93f7bbe95bf6d,0x3e483f6dbf0ebf35,0xbf7b3ec43f55bf35,0xbef13f7bbdc9bf6d,0xbe95bf553f463ec4
.quad 0xbf6d3f353ec4bf80,0x3f6dbf35bec43f80,0xbf753e483f46bf6d,0x3ef13f0ebf7f3ec4,0xbf0ebec43f7bbf35,0xbf553f6dbe48bf35,0x3dc9bf553f75bec4,0xbf22be483f62bf6d
.quad 0x3f35bf803f358000,0x3f35bf803f358000,0x3f7fbf553e953ec4,0x3f46be48bef13f6d,0x3f55bec4be483f35,0xbf0e3f6dbf7b3f35,0x3e953e48bf223f6d,0xbf623f0ebdc9bec4
.quad 0xbec43f35bf6d3f80,0x3ec4bf353f6dbf80,0xbf623f7bbf7f3f6d,0x3f75bf553f22bec4,0xbf7b3f6dbf553f35,0xbe483ec4bf0e3f35,0xbf223f0ebef13ec4,0xbf7f3f7bbf753f6d
.quad 0x8000800080008000,0x8000800080008000,0xbf75bf7bbf7fbf80,0xbef1bf0ebf22bf35,0x3f0e3ec43e488000,0x3f553f6d3f7b3f80,0x3f223f553f753f80,0xbf7fbf7bbf62bf35
.quad 0xbf6dbf35bec48000,0x3f6d3f353ec48000,0xbdc9bf0ebf62bf80,0xbf22be483e953f35,0x3f7b3f6d3f0e8000,0x3e48bec4bf55bf80,0xbef13e483f463f80,0x3e953f553f7f3f35
.quad 0xbf35bf80bf358000,0xbf35bf80bf358000,0x3f623e48bf22bf80,0x3f753f553dc9bf35,0x3e483f6d3f558000,0xbf7bbec43f0e3f80,0xbf7fbf0e3ef13f80,0x3f46be48bf75bf35
.quad 0x3ec4bf35bf6d8000,0xbec43f353f6d8000,0x3f463f55be95bf80,0xbdc9bf7bbef13f35,0xbf553ec43f7b8000,0x3f0e3f6dbe48bf80,0xbe95bf7b3dc93f80,0xbf62bf0e3f463f35
.quad 0x3f808000bf808000,0x3f808000bf808000,0xbe953f7b3dc9bf80,0xbf623f0e3f46bf35,0xbf55bec43f7b8000,0x3f0ebf6dbe483f80,0x3f46bf55be953f80,0xbdc93f7bbef1bf35
.quad 0x3ec43f35bf6d8000,0xbec4bf353f6d8000,0xbf7f3f0e3ef1bf80,0x3f463e48bf753f35,0x3e48bf6d3f558000,0xbf7b3ec43f0ebf80,0x3f62be48bf223f80,0x3f75bf553dc93f35
.quad 0xbf353f80bf358000,0xbf353f80bf358000,0xbef1be483f46bf80,0x3e95bf553f7fbf35,0x3f7bbf6d3f0e8000,0x3e483ec4bf553f80,0xbdc93f0ebf623f80,0xbf223e483e95bf35
.quad 0xbf6d3f35bec48000,0x3f6dbf353ec48000,0x3f22bf553f75bf80,0xbf7f3f7bbf623f35,0x3f0ebec43e488000,0x3f55bf6d3f7bbf80,0xbf753f7bbf7f3f80,0xbef13f0ebf223f35
.quad 0x8000800080008000,0x8000800080008000,0xbf46bf55bf62bf6d,0xbdc9be48be95bec4,0x3f7b3f6d3f553f35,0x3e483ec43f0e3f35,0xbef1be483dc93ec4,0xbe95bf0ebf46bf6d
.quad 0xbec4bf35bf6dbf80,0x3ec43f353f6d3f80,0x3f753f7b3f463ec4,0xbef1bf55bf7fbf6d,0xbf55bec43e483f35,0x3f0e3f6d3f7b3f35,0x3dc9bf0ebf75bf6d,0xbf22bf7bbf62bec4
.quad 0x3f353f803f358000,0x3f353f803f358000,0xbf7fbf0e3e953f6d,0xbf46bf7bbef13ec4,0x3f0ebec4bf7bbf35,0x3f553f6d3e48bf35,0x3e953f7b3f22bec4,0xbf62bf553dc93f6d
.quad 0xbf6dbf353ec43f80,0x3f6d3f35bec4bf80,0x3f62be48bf7fbec4,0xbf75bf0e3f223f6d,0xbe483f6d3f0ebf35,0x3f7b3ec4bf55bf35,0xbf22bf553ef13f6d,0xbf7fbe483f753ec4
.quad 0x3f808000bf808000,0x3f808000bf808000,0xbf223f553ef1bf6d,0xbf7f3e483f75bec4,0xbe48bf6d3f0e3f35,0x3f7bbec4bf553f35,0x3f623e48bf7f3ec4,0xbf753f0e3f22bf6d
.quad 0xbf6d3f353ec4bf80,0x3f6dbf35bec43f80,0x3e95bf7b3f223ec4,0xbf623f553dc9bf6d,0x3f0e3ec4bf7b3f35,0x3f55bf6d3e483f35,0xbf7f3f0e3e95bf6d,0xbf463f7bbef1bec4
.quad 0x3f35bf803f358000,0x3f35bf803f358000,0x3dc93f0ebf753f6d,0xbf223f7bbf623ec4,0xbf553ec43e48bf35,0x3f0ebf6d3f7bbf35,0x3f75bf7b3f46bec4,0xbef13f55bf7f3f6d
.quad 0xbec43f35bf6d3f80,0x3ec4bf353f6dbf80,0xbef13e483dc9bec4,0xbe953f0ebf463f6d,0x3f7bbf6d3f55bf35,0x3e48bec43f0ebf35,0xbf463f55bf623f6d,0xbdc93e48be953ec4
.quad 0x8000800080008000,0x8000800080008000,0x3e953e483dc98000,0x3f623f553f463f35,0xbf0ebec4be488000,0xbf55bf6dbf7bbf80,0x3f463f0e3e958000,0xbdc93e483ef13f35
.quad 0xbf6dbf35bec48000,0x3f6d3f353ec48000,0x3f7f3f553ef18000,0xbf46bf7bbf75bf35,0xbf7bbf6dbf0e8000,0xbe483ec43f553f80,0x3f623f7b3f228000,0x3f753f0ebdc9bf35
.quad 0xbf35bf80bf358000,0xbf35bf80bf358000,0x3ef13f7b3f468000,0xbe953f0e3f7f3f35,0xbe48bf6dbf558000,0x3f7b3ec4bf0ebf80,0xbdc93f553f628000,0xbf22bf7bbe953f35
.quad 0x3ec4bf35bf6d8000,0xbec43f353f6d8000,0xbf223f0e3f758000,0x3f7f3e48bf62bf35,0x3f55bec4bf7b8000,0xbf0ebf6d3e483f80,0xbf753e483f7f8000,0xbef13f553f22bf35
.quad 0x3f808000bf808000,0x3f808000bf808000,0xbf75be483f7f8000,0xbef1bf553f223f35,0x3f553ec4bf7b8000,0xbf0e3f6d3e48bf80,0xbf22bf0e3f758000,0x3f7fbe48bf623f35
.quad 0x3ec43f35bf6d8000,0xbec4bf353f6d8000,0xbdc9bf553f628000,0xbf223f7bbe95bf35,0xbe483f6dbf558000,0x3f7bbec4bf0e3f80,0x3ef1bf7b3f468000,0xbe95bf0e3f7fbf35
.quad 0xbf353f80bf358000,0xbf353f80bf358000,0x3f62bf7b3f228000,0x3f75bf0ebdc93f35,0xbf7b3f6dbf0e8000,0xbe48bec43f55bf80,0x3f7fbf553ef18000,0xbf463f7bbf753f35
.quad 0xbf6d3f35bec48000,0x3f6dbf353ec48000,0x3f46bf0e3e958000,0xbdc9be483ef1bf35,0xbf0e3ec4be488000,0xbf553f6dbf7b3f80,0x3e95be483dc98000,0x3f62bf553f46bf35
.quad 0x8000800080008000,0x8000800080008000,0x3f223f0e3ef13ec4,0x3f7f3f7b3f753f6d,0xbf7bbf6dbf55bf35,0xbe48bec4bf0ebf35,0x3f623f7b3f7f3f6d,0xbf75bf55bf22bec4
.quad 0xbec4bf35bf6dbf80,0x3ec43f353f6d3f80,0xbe953e483f223f6d,0x3f623f0e3dc9bec4,0x3f553ec4be48bf35,0xbf0ebf6dbf7bbf35,0xbf7fbf55be953ec4,0xbf46be483ef13f6d
.quad 0x3f353f803f358000,0x3f353f803f358000,0xbdc9bf55bf75bec4,0x3f22be48bf62bf6d,0xbf0e3ec43f7b3f35,0xbf55bf6dbe483f35,0x3f753e48bf46bf6d,0xbef13f0e3f7f3ec4
.quad 0xbf6dbf353ec43f80,0x3f6d3f35bec4bf80,0x3ef13f7b3dc9bf6d,0x3e95bf55bf463ec4,0x3e48bf6dbf0e3f35,0xbf7bbec43f553f35,0xbf463f0e3f62bec4,0xbdc93f7b3e95bf6d
.quad 0x3f808000bf808000,0x3f808000bf808000,0xbf46bf0e3f623ec4,0xbdc9bf7b3e953f6d,0x3e483f6dbf0ebf35,0xbf7b3ec43f55bf35,0x3ef1bf7b3dc93f6d,0x3e953f55bf46bec4
.quad 0xbf6d3f353ec4bf80,0x3f6dbf35bec43f80,0x3f75be48bf463f6d,0xbef1bf0e3f7fbec4,0xbf0ebec43f7bbf35,0xbf553f6dbe48bf35,0xbdc93f55bf753ec4,0x3f223e48bf623f6d
.quad 0x3f35bf803f358000,0x3f35bf803f358000,0xbf7f3f55be95bec4,0xbf463e483ef1bf6d,0x3f55bec4be483f35,0xbf0e3f6dbf7b3f35,0xbe95be483f22bf6d,0x3f62bf0e3dc93ec4
.quad 0xbec43f35bf6d3f80,0x3ec4bf353f6dbf80,0x3f62bf7b3f7fbf6d,0xbf753f55bf223ec4,0xbf7b3f6dbf553f35,0xbe483ec4bf0e3f35,0x3f22bf0e3ef1bec4,0x3f7fbf7b3f75bf6d
.quad 0x8000800080008000,0x8000800080008000,0x3f753f7b3f7f3f80,0x3ef13f0e3f223f35,0x3f0e3ec43e488000,0x3f553f6d3f7b3f80,0xbf22bf55bf75bf80,0x3f7f3f7b3f623f35
.quad 0xbf6dbf35bec48000,0x3f6d3f353ec48000,0x3dc93f0e3f623f80,0x3f223e48be95bf35,0x3f7b3f6d3f0e8000,0x3e48bec4bf55bf80,0x3ef1be48bf46bf80,0xbe95bf55bf7fbf35
.quad 0xbf35bf80bf358000,0xbf35bf80bf358000,0xbf62be483f223f80,0xbf75bf55bdc93f35,0x3e483f6d3f558000,0xbf7bbec43f0e3f80,0x3f7f3f0ebef1bf80,0xbf463e483f753f35
.quad 0x3ec4bf35bf6d8000,0xbec43f353f6d8000,0xbf46bf553e953f80,0x3dc93f7b3ef1bf35,0xbf553ec43f7b8000,0x3f0e3f6dbe48bf80,0x3e953f7bbdc9bf80,0x3f623f0ebf46bf35
.quad 0x3f808000bf808000,0x3f808000bf808000,0x3e95bf7bbdc93f80,0x3f62bf0ebf463f35,0xbf55bec43f7b8000,0x3f0ebf6dbe483f80,0xbf463f553e95bf80,0x3dc9bf7b3ef13f35
.quad 0x3ec43f35bf6d8000,0xbec4bf353f6d8000,0x3f7fbf0ebef13f80,0xbf46be483f75bf35,0x3e48bf6d3f558000,0xbf7b3ec43f0ebf80,0xbf623e483f22bf80,0xbf753f55bdc9bf35
.quad 0xbf353f80bf358000,0xbf353f80bf358000,0x3ef13e48bf463f80,0xbe953f55bf7f3f35,0x3f7bbf6d3f0e8000,0x3e483ec4bf553f80,0x3dc9bf0e3f62bf80,0x3f22be48be953f35
.quad 0xbf6d3f35bec48000,0x3f6dbf353ec48000,0xbf223f55bf753f80,0x3f7fbf7b3f62bf35,0x3f0ebec43e488000,0x3f55bf6d3f7bbf80,0x3f75bf7b3f7fbf80,0x3ef1bf0e3f22bf35
.quad 0x8000800080008000,0x8000800080008000,0x3f463f553f623f6d,0x3dc93e483e953ec4,0x3f7b3f6d3f553f35,0x3e483ec43f0e3f35,0x3ef13e48bdc9bec4,0x3e953f0e3f463f6d
.quad 0xbec4bf35bf6dbf80,0x3ec43f353f6d3f80,0xbf75bf7bbf46bec4,0x3ef13f553f7f3f6d,0xbf55bec43e483f35,0x3f0e3f6d3f7b3f35,0xbdc93f0e3f753f6d,0x3f223f7b3f623ec4
.quad 0x3f353f803f358000,0x3f353f803f358000,0x3f7f3f0ebe95bf6d,0x3f463f7b3ef1bec4,0x3f0ebec4bf7bbf35,0x3f553f6d3e48bf35,0xbe95bf7bbf223ec4,0x3f623f55bdc9bf6d
.quad 0xbf6dbf353ec43f80,0x3f6d3f35bec4bf80,0xbf623e483f7f3ec4,0x3f753f0ebf22bf6d,0xbe483f6d3f0ebf35,0x3f7b3ec4bf55bf35,0x3f223f55bef1bf6d,0x3f7f3e48bf75bec4
.quad 0x3f808000bf808000,0x3f808000bf808000,0x3f22bf55bef13f6d,0x3f7fbe48bf753ec4,0xbe48bf6d3f0e3f35,0x3f7bbec4bf553f35,0xbf62be483f7fbec4,0x3f75bf0ebf223f6d
.quad 0xbf6d3f353ec4bf80,0x3f6dbf35bec43f80,0xbe953f7bbf22bec4,0x3f62bf55bdc93f6d,0x3f0e3ec4bf7b3f35,0x3f55bf6d3e483f35,0x3f7fbf0ebe953f6d,0x3f46bf7b3ef13ec4
.quad 0x3f35bf803f358000,0x3f35bf803f358000,0xbdc9bf0e3f75bf6d,0x3f22bf7b3f62bec4,0xbf553ec43e48bf35,0x3f0ebf6d3f7bbf35,0xbf753f7bbf463ec4,0x3ef1bf553f7fbf6d
.quad 0xbec43f35bf6d3f80,0x3ec4bf353f6dbf80,0x3ef1be48bdc93ec4,0x3e95bf0e3f46bf6d,0x3f7bbf6d3f55bf35,0x3e48bec43f0ebf35,0x3f46bf553f62bf6d,0x3dc9be483e95bec4
.quad 0x8000800080008000,0x8000800080008000,0x3e95be483dc98000,0x3f62bf553f46bf35,0x3f0ebec43e488000,0x3f55bf6d3f7bbf80,0x3f46bf0e3e958000,0xbdc9be483ef1bf35
.quad 0x3f6dbf353ec48000,0xbf6d3f35bec48000,0x3f7fbf553ef18000,0xbf463f7bbf753f35,0x3f7bbf6d3f0e8000,0x3e483ec4bf553f80,0x3f62bf7b3f228000,0x3f75bf0ebdc93f35
.quad 0x3f35bf803f358000,0x3f35bf803f358000,0x3ef1bf7b3f468000,0xbe95bf0e3f7fbf35,0x3e48bf6d3f558000,0xbf7b3ec43f0ebf80,0xbdc9bf553f628000,0xbf223f7bbe95bf35
.quad 0xbec4bf353f6d8000,0x3ec43f35bf6d8000,0xbf22bf0e3f758000,0x3f7fbe48bf623f35,0xbf55bec43f7b8000,0x3f0ebf6dbe483f80,0xbf75be483f7f8000,0xbef1bf553f223f35
.quad 0xbf8080003f808000,0xbf8080003f808000,0xbf753e483f7f8000,0xbef13f553f22bf35,0xbf553ec43f7b8000,0x3f0e3f6dbe48bf80,0xbf223f0e3f758000,0x3f7f3e48bf62bf35
.quad 0xbec43f353f6d8000,0x3ec4bf35bf6d8000,0xbdc93f553f628000,0xbf22bf7bbe953f35,0x3e483f6d3f558000,0xbf7bbec43f0e3f80,0x3ef13f7b3f468000,0xbe953f0e3f7f3f35
.quad 0x3f353f803f358000,0x3f353f803f358000,0x3f623f7b3f228000,0x3f753f0ebdc9bf35,0x3f7b3f6d3f0e8000,0x3e48bec4bf55bf80,0x3f7f3f553ef18000,0xbf46bf7bbf75bf35
.quad 0x3f6d3f353ec48000,0xbf6dbf35bec48000,0x3f463f0e3e958000,0xbdc93e483ef13f35,0x3f0e3ec43e488000,0x3f553f6d3f7b3f80,0x3e953e483dc98000,0x3f623f553f463f35
.quad 0x8000800080008000,0x8000800080008000,0x3f22bf0e3ef1bec4,0x3f7fbf7b3f75bf6d,0x3f7bbf6d3f55bf35,0x3e48bec43f0ebf35,0x3f62bf7b3f7fbf6d,0xbf753f55bf223ec4
.quad 0x3ec4bf353f6dbf80,0xbec43f35bf6d3f80,0xbe95be483f22bf6d,0x3f62bf0e3dc93ec4,0xbf553ec43e48bf35,0x3f0ebf6d3f7bbf35,0xbf7f3f55be95bec4,0xbf463e483ef1bf6d
.quad 0xbf353f80bf358000,0xbf353f80bf358000,0xbdc93f55bf753ec4,0x3f223e48bf623f6d,0x3f0e3ec4bf7b3f35,0x3f55bf6d3e483f35,0x3f75be48bf463f6d,0xbef1bf0e3f7fbec4
.quad 0x3f6dbf35bec43f80,0xbf6d3f353ec4bf80,0x3ef1bf7b3dc93f6d,0x3e953f55bf46bec4,0xbe48bf6d3f0e3f35,0x3f7bbec4bf553f35,0xbf46bf0e3f623ec4,0xbdc9bf7b3e953f6d
.quad 0xbf8080003f808000,0xbf8080003f808000,0xbf463f0e3f62bec4,0xbdc93f7b3e95bf6d,0xbe483f6d3f0ebf35,0x3f7b3ec4bf55bf35,0x3ef13f7b3dc9bf6d,0x3e95bf55bf463ec4
.quad 0x3f6d3f35bec4bf80,0xbf6dbf353ec43f80,0x3f753e48bf46bf6d,0xbef13f0e3f7f3ec4,0x3f0ebec4bf7bbf35,0x3f553f6d3e48bf35,0xbdc9bf55bf75bec4,0x3f22be48bf62bf6d
.quad 0xbf35bf80bf358000,0xbf35bf80bf358000,0xbf7fbf55be953ec4,0xbf46be483ef13f6d,0xbf55bec43e483f35,0x3f0e3f6d3f7b3f35,0xbe953e483f223f6d,0x3f623f0e3dc9bec4
.quad 0x3ec43f353f6d3f80,0xbec4bf35bf6dbf80,0x3f623f7b3f7f3f6d,0xbf75bf55bf22bec4,0x3f7b3f6d3f553f35,0x3e483ec43f0e3f35,0x3f223f0e3ef13ec4,0x3f7f3f7b3f753f6d
.quad 0x8000800080008000,0x8000800080008000,0x3f75bf7b3f7fbf80,0x3ef1bf0e3f22bf35,0xbf0e3ec4be488000,0xbf553f6dbf7b3f80,0xbf223f55bf753f80,0x3f7fbf7b3f62bf35
.quad 0x3f6dbf353ec48000,0xbf6d3f35bec48000,0x3dc9bf0e3f62bf80,0x3f22be48be953f35,0xbf7b3f6dbf0e8000,0xbe48bec43f55bf80,0x3ef13e48bf463f80,0xbe953f55bf7f3f35
.quad 0x3f35bf803f358000,0x3f35bf803f358000,0xbf623e483f22bf80,0xbf753f55bdc9bf35,0xbe483f6dbf558000,0x3f7bbec4bf0e3f80,0x3f7fbf0ebef13f80,0xbf46be483f75bf35
.quad 0xbec4bf353f6d8000,0x3ec43f35bf6d8000,0xbf463f553e95bf80,0x3dc9bf7b3ef13f35,0x3f553ec4bf7b8000,0xbf0e3f6d3e48bf80,0x3e95bf7bbdc93f80,0x3f62bf0ebf463f35
.quad 0xbf8080003f808000,0xbf8080003f808000,0x3e953f7bbdc9bf80,0x3f623f0ebf46bf35,0x3f55bec4bf7b8000,0xbf0ebf6d3e483f80,0xbf46bf553e953f80,0x3dc93f7b3ef1bf35
.quad 0xbec43f353f6d8000,0x3ec4bf35bf6d8000,0x3f7f3f0ebef1bf80,0xbf463e483f753f35,0xbe48bf6dbf558000,0x3f7b3ec4bf0ebf80,0xbf62be483f223f80,0xbf75bf55bdc93f35
.quad 0x3f353f803f358000,0x3f353f803f358000,0x3ef1be48bf46bf80,0xbe95bf55bf7fbf35,0xbf7bbf6dbf0e8000,0xbe483ec43f553f80,0x3dc93f0e3f623f80,0x3f223e48be95bf35
.quad 0x3f6d3f353ec48000,0xbf6dbf35bec48000,0xbf22bf55bf75bf80,0x3f7f3f7b3f623f35,0xbf0ebec4be488000,0xbf55bf6dbf7bbf80,0x3f753f7b3f7f3f80,0x3ef13f0e3f223f35
.quad 0x8000800080008000,0x8000800080008000,0x3f46bf553f62bf6d,0x3dc9be483e95bec4,0xbf7b3f6dbf553f35,0xbe483ec4bf0e3f35,0x3ef1be48bdc93ec4,0x3e95bf0e3f46bf6d
.quad 0x3ec4bf353f6dbf80,0xbec43f35bf6d3f80,0xbf753f7bbf463ec4,0x3ef1bf553f7fbf6d,0x3f55bec4be483f35,0xbf0e3f6dbf7b3f35,0xbdc9bf0e3f75bf6d,0x3f22bf7b3f62bec4
.quad 0xbf353f80bf358000,0xbf353f80bf358000,0x3f7fbf0ebe953f6d,0x3f46bf7b3ef13ec4,0xbf0ebec43f7bbf35,0xbf553f6dbe48bf35,0xbe953f7bbf22bec4,0x3f62bf55bdc93f6d
.quad 0x3f6dbf35bec43f80,0xbf6d3f353ec4bf80,0xbf62be483f7fbec4,0x3f75bf0ebf223f6d,0x3e483f6dbf0ebf35,0xbf7b3ec43f55bf35,0x3f22bf55bef13f6d,0x3f7fbe48bf753ec4
.quad 0xbf8080003f808000,0xbf8080003f808000,0x3f223f55bef1bf6d,0x3f7f3e48bf75bec4,0x3e48bf6dbf0e3f35,0xbf7bbec43f553f35,0xbf623e483f7f3ec4,0x3f753f0ebf22bf6d
.quad 0x3f6d3f35bec4bf80,0xbf6dbf353ec43f80,0xbe95bf7bbf223ec4,0x3f623f55bdc9bf6d,0xbf0e3ec43f7b3f35,0xbf55bf6dbe483f35,0x3f7f3f0ebe95bf6d,0x3f463f7b3ef1bec4
.quad 0xbf35bf80bf358000,0xbf35bf80bf358000,0xbdc93f0e3f753f6d,0x3f223f7b3f623ec4,0x3f553ec4be48bf35,0xbf0ebf6dbf7bbf35,0xbf75bf7bbf46bec4,0x3ef13f553f7f3f6d
.quad 0x3ec43f353f6d3f80,0xbec4bf35bf6dbf80,0x3ef13e48bdc9bec4,0x3e953f0e3f463f6d,0xbf7bbf6dbf55bf35,0xbe48bec4bf0ebf35,0x3f463f553f623f6d,0x3dc93e483e953ec4
.quad 0x8000800080008000,0x8000800080008000,0xbe953e48bdc98000,0xbf623f55bf463f35,0x3f0ebec43e488000,0x3f55bf6d3f7bbf80,0xbf463f0ebe958000,0x3dc93e48bef13f35
.quad 0x3f6dbf353ec48000,0xbf6d3f35bec48000,0xbf7f3f55bef18000,0x3f46bf7b3f75bf35,0x3f7bbf6d3f0e8000,0x3e483ec4bf553f80,0xbf623f7bbf228000,0xbf753f0e3dc9bf35
.quad 0x3f35bf803f358000,0x3f35bf803f358000,0xbef13f7bbf468000,0x3e953f0ebf7f3f35,0x3e48bf6d3f558000,0xbf7b3ec43f0ebf80,0x3dc93f55bf628000,0x3f22bf7b3e953f35
.quad 0xbec4bf353f6d8000,0x3ec43f35bf6d8000,0x3f223f0ebf758000,0xbf7f3e483f62bf35,0xbf55bec43f7b8000,0x3f0ebf6dbe483f80,0x3f753e48bf7f8000,0x3ef13f55bf22bf35
.quad 0xbf8080003f808000,0xbf8080003f808000,0x3f75be48bf7f8000,0x3ef1bf55bf223f35,0xbf553ec43f7b8000,0x3f0e3f6dbe48bf80,0x3f22bf0ebf758000,0xbf7fbe483f623f35
.quad 0xbec43f353f6d8000,0x3ec4bf35bf6d8000,0x3dc9bf55bf628000,0x3f223f7b3e95bf35,0x3e483f6d3f558000,0xbf7bbec43f0e3f80,0xbef1bf7bbf468000,0x3e95bf0ebf7fbf35
.quad 0x3f353f803f358000,0x3f353f803f358000,0xbf62bf7bbf228000,0xbf75bf0e3dc93f35,0x3f7b3f6d3f0e8000,0x3e48bec4bf55bf80,0xbf7fbf55bef18000,0x3f463f7b3f753f35
.quad 0x3f6d3f353ec48000,0xbf6dbf35bec48000,0xbf46bf0ebe958000,0x3dc9be48bef1bf35,0x3f0e3ec43e488000,0x3f553f6d3f7b3f80,0xbe95be48bdc98000,0xbf62bf55bf46bf35
.quad 0x8000800080008000,0x8000800080008000,0xbf223f0ebef13ec4,0xbf7f3f7bbf753f6d,0x3f7bbf6d3f55bf35,0x3e48bec43f0ebf35,0xbf623f7bbf7f3f6d,0x3f75bf553f22bec4
.quad 0x3ec4bf353f6dbf80,0xbec43f35bf6d3f80,0x3e953e48bf223f6d,0xbf623f0ebdc9bec4,0xbf553ec43e48bf35,0x3f0ebf6d3f7bbf35,0x3f7fbf553e953ec4,0x3f46be48bef13f6d
.quad 0xbf353f80bf358000,0xbf353f80bf358000,0x3dc9bf553f75bec4,0xbf22be483f62bf6d,0x3f0e3ec4bf7b3f35,0x3f55bf6d3e483f35,0xbf753e483f46bf6d,0x3ef13f0ebf7f3ec4
.quad 0x3f6dbf35bec43f80,0xbf6d3f353ec4bf80,0xbef13f7bbdc9bf6d,0xbe95bf553f463ec4,0xbe48bf6d3f0e3f35,0x3f7bbec4bf553f35,0x3f463f0ebf62bec4,0x3dc93f7bbe95bf6d
.quad 0xbf8080003f808000,0xbf8080003f808000,0x3f46bf0ebf623ec4,0x3dc9bf7bbe953f6d,0xbe483f6d3f0ebf35,0x3f7b3ec4bf55bf35,0xbef1bf7bbdc93f6d,0xbe953f553f46bec4
.quad 0x3f6d3f35bec4bf80,0xbf6dbf353ec43f80,0xbf75be483f463f6d,0x3ef1bf0ebf7fbec4,0x3f0ebec4bf7bbf35,0x3f553f6d3e48bf35,0x3dc93f553f753ec4,0xbf223e483f623f6d
.quad 0xbf35bf80bf358000,0xbf35bf80bf358000,0x3f7f3f553e95bec4,0x3f463e48bef1bf6d,0xbf55bec43e483f35,0x3f0e3f6d3f7b3f35,0x3e95be48bf22bf6d,0xbf62bf0ebdc93ec4
.quad 0x3ec43f353f6d3f80,0xbec4bf35bf6dbf80,0xbf62bf7bbf7fbf6d,0x3f753f553f223ec4,0x3f7b3f6d3f553f35,0x3e483ec43f0e3f35,0xbf22bf0ebef1bec4,0xbf7fbf7bbf75bf6d
.quad 0x8000800080008000,0x8000800080008000,0xbf753f7bbf7f3f80,0xbef13f0ebf223f35,0xbf0e3ec4be488000,0xbf553f6dbf7b3f80,0x3f22bf553f75bf80,0xbf7f3f7bbf623f35
.quad 0x3f6dbf353ec48000,0xbf6d3f35bec48000,0xbdc93f0ebf623f80,0xbf223e483e95bf35,0xbf7b3f6dbf0e8000,0xbe48bec43f55bf80,0xbef1be483f46bf80,0x3e95bf553f7fbf35
.quad 0x3f35bf803f358000,0x3f35bf803f358000,0x3f62be48bf223f80,0x3f75bf553dc93f35,0xbe483f6dbf558000,0x3f7bbec4bf0e3f80,0xbf7f3f0e3ef1bf80,0x3f463e48bf753f35
.quad 0xbec4bf353f6d8000,0x3ec43f35bf6d8000,0x3f46bf55be953f80,0xbdc93f7bbef1bf35,0x3f553ec4bf7b8000,0xbf0e3f6d3e48bf80,0xbe953f7b3dc9bf80,0xbf623f0e3f46bf35
.quad 0xbf8080003f808000,0xbf8080003f808000,0xbe95bf7b3dc93f80,0xbf62bf0e3f463f35,0x3f55bec4bf7b8000,0xbf0ebf6d3e483f80,0x3f463f55be95bf80,0xbdc9bf7bbef13f35
.quad 0xbec43f353f6d8000,0x3ec4bf35bf6d8000,0xbf7fbf0e3ef13f80,0x3f46be48bf75bf35,0xbe48bf6dbf558000,0x3f7b3ec4bf0ebf80,0x3f623e48bf22bf80,0x3f753f553dc9bf35
.quad 0x3f353f803f358000,0x3f353f803f358000,0xbef13e483f463f80,0x3e953f553f7f3f35,0xbf7bbf6dbf0e8000,0xbe483ec43f553f80,0xbdc9bf0ebf62bf80,0xbf22be483e953f35
.quad 0x3f6d3f353ec48000,0xbf6dbf35bec48000,0x3f223f553f753f80,0xbf7fbf7bbf62bf35,0xbf0ebec4be488000,0xbf55bf6dbf7bbf80,0xbf75bf7bbf7fbf80,0xbef1bf0ebf22bf35
.quad 0x8000800080008000,0x8000800080008000,0xbf463f55bf623f6d,0xbdc93e48be953ec4,0xbf7b3f6dbf553f35,0xbe483ec4bf0e3f35,0xbef13e483dc9bec4,0xbe953f0ebf463f6d
.quad 0x3ec4bf353f6dbf80,0xbec43f35bf6d3f80,0x3f75bf7b3f46bec4,0xbef13f55bf7f3f6d,0x3f55bec4be483f35,0xbf0e3f6dbf7b3f35,0x3dc93f0ebf753f6d,0xbf223f7bbf623ec4
.quad 0xbf353f80bf358000,0xbf353f80bf358000,0xbf7f3f0e3e95bf6d,0xbf463f7bbef1bec4,0xbf0ebec43f7bbf35,0xbf553f6dbe48bf35,0x3e95bf7b3f223ec4,0xbf623f553dc9bf6d
.quad 0x3f6dbf35bec43f80,0xbf6d3f353ec4bf80,0x3f623e48bf7f3ec4,0xbf753f0e3f22bf6d,0x3e483f6dbf0ebf35,0xbf7b3ec43f55bf35,0xbf223f553ef1bf6d,0xbf7f3e483f75bec4
.quad 0xbf8080003f808000,0xbf8080003f808000,0xbf22bf553ef13f6d,0xbf7fbe483f753ec4,0x3e48bf6dbf0e3f35,0xbf7bbec43f553f35,0x3f62be48bf7fbec4,0xbf75bf0e3f223f6d
.quad 0x3f6d3f35bec4bf80,0xbf6dbf353ec43f80,0x3e953f7b3f22bec4,0xbf62bf553dc93f6d,0xbf0e3ec43f7b3f35,0xbf55bf6dbe483f35,0xbf7fbf0e3e953f6d,0xbf46bf7bbef13ec4
.quad 0xbf35bf80bf358000,0xbf35bf80bf358000,0x3dc9bf0ebf75bf6d,0xbf22bf7bbf62bec4,0x3f553ec4be48bf35,0xbf0ebf6dbf7bbf35,0x3f753f7b3f463ec4,0xbef1bf55bf7fbf6d
.quad 0x3ec43f353f6d3f80,0xbec4bf35bf6dbf80,0xbef1be483dc93ec4,0xbe95bf0ebf46bf6d,0xbf7bbf6dbf55bf35,0xbe48bec4bf0ebf35,0xbf46bf55bf62bf6d,0xbdc9be48be95bec4
.quad 0x3f803f803f803f80,0x3f803f803f803f80,0x3f553f6d3f7b3f80,0xbf0ebec4be480000,0x3ec43f353f6d3f80,0xbec4bf35bf6dbf80,0xbe483ec43f553f80,0x3f7b3f6d3f0e0000
.quad 0xbf3500003f353f80,0xbf3500003f353f80,0xbf7bbec43f0e3f80,0xbe48bf6dbf550000,0xbf6dbf353ec43f80,0x3f6d3f35bec4bf80,0xbf0ebf6d3e483f80,0xbf553ec43f7b0000
.quad 0xbf8000003f80,0xbf8000003f80,0x3f0ebf6dbe483f80,0x3f553ec4bf7b0000,0x3f6dbf35bec43f80,0xbf6d3f353ec4bf80,0x3f7bbec4bf0e3f80,0x3e48bf6d3f550000
.quad 0x3f350000bf353f80,0x3f350000bf353f80,0x3e483ec4bf553f80,0xbf7b3f6dbf0e0000,0xbec43f35bf6d3f80,0x3ec4bf353f6dbf80,0xbf553f6dbf7b3f80,0x3f0ebec43e480000
.quad 0xbf803f80bf803f80,0xbf803f80bf803f80,0xbf553f6dbf7b3f80,0x3f0ebec43e480000,0xbec43f35bf6d3f80,0x3ec4bf353f6dbf80,0x3e483ec4bf553f80,0xbf7b3f6dbf0e0000
.quad 0x3f350000bf353f80,0x3f350000bf353f80,0x3f7bbec4bf0e3f80,0x3e48bf6d3f550000,0x3f6dbf35bec43f80,0xbf6d3f353ec4bf80,0x3f0ebf6dbe483f80,0x3f553ec4bf7b0000
.quad 0xbf8000003f80,0xbf8000003f80,0xbf0ebf6d3e483f80,0xbf553ec43f7b0000,0xbf6dbf353ec43f80,0x3f6d3f35bec4bf80,0xbf7bbec43f0e3f80,0xbe48bf6dbf550000
.quad 0xbf3500003f353f80,0xbf3500003f353f80,0xbe483ec43f553f80,0x3f7b3f6d3f0e0000,0x3ec43f353f6d3f80,0xbec4bf35bf6dbf80,0x3f553f6d3f7b3f80,0xbf0ebec4be480000
.quad 0x3f803f803f803f80,0x3f803f803f803f80,0x3e483ec43f0e3f35,0xbf7bbf6dbf55bf35,0xbf6dbf35bec40000,0x3f6d3f353ec40000,0xbf0ebf6dbf7bbf35,0xbf55bec43e483f35
.quad 0x3f350000bf35bf80,0x3f350000bf35bf80,0x3f553f6d3e48bf35,0xbf0e3ec43f7b3f35,0xbec43f353f6d0000,0x3ec4bf35bf6d0000,0xbf7bbec43f553f35,0xbe483f6d3f0ebf35
.quad 0xbf8000003f80,0xbf8000003f80,0x3f7bbec4bf553f35,0x3e483f6dbf0ebf35,0x3ec43f35bf6d0000,0xbec4bf353f6d0000,0xbf553f6dbe48bf35,0x3f0e3ec4bf7b3f35
.quad 0xbf3500003f35bf80,0xbf3500003f35bf80,0x3f0ebf6d3f7bbf35,0x3f55bec4be483f35,0x3f6dbf353ec40000,0xbf6d3f35bec40000,0xbe483ec4bf0e3f35,0x3f7bbf6d3f55bf35
.quad 0xbf803f80bf803f80,0xbf803f80bf803f80,0xbe483ec4bf0e3f35,0x3f7bbf6d3f55bf35,0x3f6dbf353ec40000,0xbf6d3f35bec40000,0x3f0ebf6d3f7bbf35,0x3f55bec4be483f35
.quad 0xbf3500003f35bf80,0xbf3500003f35bf80,0xbf553f6dbe48bf35,0x3f0e3ec4bf7b3f35,0x3ec43f35bf6d0000,0xbec4bf353f6d0000,0x3f7bbec4bf553f35,0x3e483f6dbf0ebf35
.quad 0xbf8000003f80,0xbf8000003f80,0xbf7bbec43f553f35,0xbe483f6d3f0ebf35,0xbec43f353f6d0000,0x3ec4bf35bf6d0000,0x3f553f6d3e48bf35,0xbf0e3ec43f7b3f35
.quad 0x3f350000bf35bf80,0x3f350000bf35bf80,0xbf0ebf6dbf7bbf35,0xbf55bec43e483f35,0xbf6dbf35bec40000,0x3f6d3f353ec40000,0x3e483ec43f0e3f35,0xbf7bbf6dbf55bf35
.quad 0x3f803f803f803f80,0x3f803f803f803f80,0xbf55bf6dbf7bbf80,0x3f0e3ec43e480000,0x3ec43f353f6d3f80,0xbec4bf35bf6dbf80,0x3e48bec4bf55bf80,0xbf7bbf6dbf0e0000
.quad 0xbf3500003f353f80,0xbf3500003f353f80,0x3f7b3ec4bf0ebf80,0x3e483f6d3f550000,0xbf6dbf353ec43f80,0x3f6d3f35bec4bf80,0x3f0e3f6dbe48bf80,0x3f55bec4bf7b0000
.quad 0xbf8000003f80,0xbf8000003f80,0xbf0e3f6d3e48bf80,0xbf55bec43f7b0000,0x3f6dbf35bec43f80,0xbf6d3f353ec4bf80,0xbf7b3ec43f0ebf80,0xbe483f6dbf550000
.quad 0x3f350000bf353f80,0x3f350000bf353f80,0xbe48bec43f55bf80,0x3f7bbf6d3f0e0000,0xbec43f35bf6d3f80,0x3ec4bf353f6dbf80,0x3f55bf6d3f7bbf80,0xbf0e3ec4be480000
.quad 0xbf803f80bf803f80,0xbf803f80bf803f80,0x3f55bf6d3f7bbf80,0xbf0e3ec4be480000,0xbec43f35bf6d3f80,0x3ec4bf353f6dbf80,0xbe48bec43f55bf80,0x3f7bbf6d3f0e0000
.quad 0x3f350000bf353f80,0x3f350000bf353f80,0xbf7b3ec43f0ebf80,0xbe483f6dbf550000,0x3f6dbf35bec43f80,0xbf6d3f353ec4bf80,0xbf0e3f6d3e48bf80,0xbf55bec43f7b0000
.quad 0xbf8000003f80,0xbf8000003f80,0x3f0e3f6dbe48bf80,0x3f55bec4bf7b0000,0xbf6dbf353ec43f80,0x3f6d3f35bec4bf80,0x3f7b3ec4bf0ebf80,0x3e483f6d3f550000
.quad 0xbf3500003f353f80,0xbf3500003f353f80,0x3e48bec4bf55bf80,0xbf7bbf6dbf0e0000,0x3ec43f353f6d3f80,0xbec4bf35bf6dbf80,0xbf55bf6dbf7bbf80,0x3f0e3ec43e480000
.quad 0x3f803f803f803f80,0x3f803f803f803f80,0xbe48bec4bf0ebf35,0x3f7b3f6d3f553f35,0xbf6dbf35bec40000,0x3f6d3f353ec40000,0x3f0e3f6d3f7b3f35,0x3f553ec4be48bf35
.quad 0x3f350000bf35bf80,0x3f350000bf35bf80,0xbf55bf6dbe483f35,0x3f0ebec4bf7bbf35,0xbec43f353f6d0000,0x3ec4bf35bf6d0000,0x3f7b3ec4bf55bf35,0x3e48bf6dbf0e3f35
.quad 0xbf8000003f80,0xbf8000003f80,0xbf7b3ec43f55bf35,0xbe48bf6d3f0e3f35,0x3ec43f35bf6d0000,0xbec4bf353f6d0000,0x3f55bf6d3e483f35,0xbf0ebec43f7bbf35
.quad 0xbf3500003f35bf80,0xbf3500003f35bf80,0xbf0e3f6dbf7b3f35,0xbf553ec43e48bf35,0x3f6dbf353ec40000,0xbf6d3f35bec40000,0x3e48bec43f0ebf35,0xbf7b3f6dbf553f35
.quad 0xbf803f80bf803f80,0xbf803f80bf803f80,0x3e48bec43f0ebf35,0xbf7b3f6dbf553f35,0x3f6dbf353ec40000,0xbf6d3f35bec40000,0xbf0e3f6dbf7b3f35,0xbf553ec43e48bf35
.quad 0xbf3500003f35bf80,0xbf3500003f35bf80,0x3f55bf6d3e483f35,0xbf0ebec43f7bbf35,0x3ec43f35bf6d0000,0xbec4bf353f6d0000,0xbf7b3ec43f55bf35,0xbe48bf6d3f0e3f35
.quad 0xbf8000003f80,0xbf8000003f80,0x3f7b3ec4bf55bf35,0x3e48bf6dbf0e3f35,0xbec43f353f6d0000,0x3ec4bf35bf6d0000,0xbf55bf6dbe483f35,0x3f0ebec4bf7bbf35
.quad 0x3f350000bf35bf80,0x3f350000bf35bf80,0x3f0e3f6d3f7b3f35,0x3f553ec4be48bf35,0xbf6dbf35bec40000,0x3f6d3f353ec40000,0xbe48bec4bf0ebf35,0x3f7b3f6d3f553f35
.quad 0x0,0x0,0x3f0e3ec43e480000,0x3f553f6d3f7b3f80,0x3f6d3f353ec40000,0xbf6dbf35bec40000,0x3f7b3f6d3f0e0000,0x3e48bec4bf55bf80
.quad 0x3f353f803f350000,0x3f353f803f350000,0x3e483f6d3f550000,0xbf7bbec43f0e3f80,0xbec43f353f6d0000,0x3ec4bf35bf6d0000,0xbf553ec43f7b0000,0x3f0e3f6dbe48bf80
.quad 0xbf8000003f800000,0xbf8000003f800000,0xbf55bec43f7b0000,0x3f0ebf6dbe483f80,0xbec4bf353f6d0000,0x3ec43f35bf6d0000,0x3e48bf6d3f550000,0xbf7b3ec43f0ebf80
.quad 0x3f35bf803f350000,0x3f35bf803f350000,0x3f7bbf6d3f0e0000,0x3e483ec4bf553f80,0x3f6dbf353ec40000,0xbf6d3f35bec40000,0x3f0ebec43e480000,0x3f55bf6d3f7bbf80
.quad 0x0,0x0,0xbf0e3ec4be480000,0xbf553f6dbf7b3f80,0xbf6d3f35bec40000,0x3f6dbf353ec40000,0xbf7b3f6dbf0e0000,0xbe48bec43f55bf80
.quad 0xbf353f80bf350000,0xbf353f80bf350000,0xbe483f6dbf550000,0x3f7bbec4bf0e3f80,0x3ec43f35bf6d0000,0xbec4bf353f6d0000,0x3f553ec4bf7b0000,0xbf0e3f6d3e48bf80
.quad 0x3f800000bf800000,0x3f800000bf800000,0x3f55bec4bf7b0000,0xbf0ebf6d3e483f80,0x3ec4bf35bf6d0000,0xbec43f353f6d0000,0xbe48bf6dbf550000,0x3f7b3ec4bf0ebf80
.quad 0xbf35bf80bf350000,0xbf35bf80bf350000,0xbf7bbf6dbf0e0000,0xbe483ec43f553f80,0xbf6dbf35bec40000,0x3f6d3f353ec40000,0xbf0ebec4be480000,0xbf55bf6dbf7bbf80
.quad 0x0,0x0,0x3f7b3f6d3f553f35,0x3e483ec43f0e3f35,0x3ec43f353f6d3f80,0xbec4bf35bf6dbf80,0xbf55bec43e483f35,0x3f0e3f6d3f7b3f35
.quad 0xbf35bf80bf350000,0xbf35bf80bf350000,0x3f0ebec4bf7bbf35,0x3f553f6d3e48bf35,0x3f6d3f35bec4bf80,0xbf6dbf353ec43f80,0xbe483f6d3f0ebf35,0x3f7b3ec4bf55bf35
.quad 0xbf8000003f800000,0xbf8000003f800000,0xbe48bf6d3f0e3f35,0x3f7bbec4bf553f35,0x3f6dbf35bec43f80,0xbf6d3f353ec4bf80,0x3f0e3ec4bf7b3f35,0x3f55bf6d3e483f35
.quad 0xbf353f80bf350000,0xbf353f80bf350000,0xbf553ec43e48bf35,0x3f0ebf6d3f7bbf35,0x3ec4bf353f6dbf80,0xbec43f35bf6d3f80,0x3f7bbf6d3f55bf35,0x3e48bec43f0ebf35
.quad 0x0,0x0,0xbf7b3f6dbf553f35,0xbe483ec4bf0e3f35,0xbec43f35bf6d3f80,0x3ec4bf353f6dbf80,0x3f55bec4be483f35,0xbf0e3f6dbf7b3f35
.quad 0x3f35bf803f350000,0x3f35bf803f350000,0xbf0ebec43f7bbf35,0xbf553f6dbe48bf35,0xbf6d3f353ec4bf80,0x3f6dbf35bec43f80,0x3e483f6dbf0ebf35,0xbf7b3ec43f55bf35
.quad 0x3f800000bf800000,0x3f800000bf800000,0x3e48bf6dbf0e3f35,0xbf7bbec43f553f35,0xbf6dbf353ec43f80,0x3f6d3f35bec4bf80,0xbf0e3ec43f7b3f35,0xbf55bf6dbe483f35
.quad 0x3f353f803f350000,0x3f353f803f350000,0x3f553ec4be48bf35,0xbf0ebf6dbf7bbf35,0xbec4bf35bf6dbf80,0x3ec43f353f6d3f80,0xbf7bbf6dbf55bf35,0xbe48bec4bf0ebf35
.quad 0x0,0x0,0xbf0ebec4be480000,0xbf55bf6dbf7bbf80,0x3f6d3f353ec40000,0xbf6dbf35bec40000,0xbf7bbf6dbf0e0000,0xbe483ec43f553f80
.quad 0x3f353f803f350000,0x3f353f803f350000,0xbe48bf6dbf550000,0x3f7b3ec4bf0ebf80,0xbec43f353f6d0000,0x3ec4bf35bf6d0000,0x3f55bec4bf7b0000,0xbf0ebf6d3e483f80
.quad 0xbf8000003f800000,0xbf8000003f800000,0x3f553ec4bf7b0000,0xbf0e3f6d3e48bf80,0xbec4bf353f6d0000,0x3ec43f35bf6d0000,0xbe483f6dbf550000,0x3f7bbec4bf0e3f80
.quad 0x3f35bf803f350000,0x3f35bf803f350000,0xbf7b3f6dbf0e0000,0xbe48bec43f55bf80,0x3f6dbf353ec40000,0xbf6d3f35bec40000,0xbf0e3ec4be480000,0xbf553f6dbf7b3f80
.quad 0x0,0x0,0x3f0ebec43e480000,0x3f55bf6d3f7bbf80,0xbf6d3f35bec40000,0x3f6dbf353ec40000,0x3f7bbf6d3f0e0000,0x3e483ec4bf553f80
.quad 0xbf353f80bf350000,0xbf353f80bf350000,0x3e48bf6d3f550000,0xbf7b3ec43f0ebf80,0x3ec43f35bf6d0000,0xbec4bf353f6d0000,0xbf55bec43f7b0000,0x3f0ebf6dbe483f80
.quad 0x3f800000bf800000,0x3f800000bf800000,0xbf553ec43f7b0000,0x3f0e3f6dbe48bf80,0x3ec4bf35bf6d0000,0xbec43f353f6d0000,0x3e483f6d3f550000,0xbf7bbec43f0e3f80
.quad 0xbf35bf80bf350000,0xbf35bf80bf350000,0x3f7b3f6d3f0e0000,0x3e48bec4bf55bf80,0xbf6dbf35bec40000,0x3f6d3f353ec40000,0x3f0e3ec43e480000,0x3f553f6d3f7b3f80
.quad 0x0,0x0,0xbf7bbf6dbf55bf35,0xbe48bec4bf0ebf35,0x3ec43f353f6d3f80,0xbec4bf35bf6dbf80,0x3f553ec4be48bf35,0xbf0ebf6dbf7bbf35
.quad 0xbf35bf80bf350000,0xbf35bf80bf350000,0xbf0e3ec43f7b3f35,0xbf55bf6dbe483f35,0x3f6d3f35bec4bf80,0xbf6dbf353ec43f80,0x3e48bf6dbf0e3f35,0xbf7bbec43f553f35
.quad 0xbf8000003f800000,0xbf8000003f800000,0x3e483f6dbf0ebf35,0xbf7b3ec43f55bf35,0x3f6dbf35bec43f80,0xbf6d3f353ec4bf80,0xbf0ebec43f7bbf35,0xbf553f6dbe48bf35
.quad 0xbf353f80bf350000,0xbf353f80bf350000,0x3f55bec4be483f35,0xbf0e3f6dbf7b3f35,0x3ec4bf353f6dbf80,0xbec43f35bf6d3f80,0xbf7b3f6dbf553f35,0xbe483ec4bf0e3f35
.quad 0x0,0x0,0x3f7bbf6d3f55bf35,0x3e48bec43f0ebf35,0xbec43f35bf6d3f80,0x3ec4bf353f6dbf80,0xbf553ec43e48bf35,0x3f0ebf6d3f7bbf35
.quad 0x3f35bf803f350000,0x3f35bf803f350000,0x3f0e3ec4bf7b3f35,0x3f55bf6d3e483f35,0xbf6d3f353ec4bf80,0x3f6dbf35bec43f80,0xbe48bf6d3f0e3f35,0x3f7bbec4bf553f35
.quad 0x3f800000bf800000,0x3f800000bf800000,0xbe483f6d3f0ebf35,0x3f7b3ec4bf55bf35,0xbf6dbf353ec43f80,0x3f6d3f35bec4bf80,0x3f0ebec4bf7bbf35,0x3f553f6d3e48bf35
.quad 0x3f353f803f350000,0x3f353f803f350000,0xbf55bec43e483f35,0x3f0e3f6d3f7b3f35,0xbec4bf35bf6dbf80,0x3ec43f353f6d3f80,0x3f7b3f6d3f553f35,0x3e483ec43f0e3f35
.quad 0x8000800080008000,0x8000800080008000,0xbf0ebec4be488000,0xbf55bf6dbf7bbf80,0xbf6dbf35bec48000,0x3f6d3f353ec48000,0xbf7bbf6dbf0e8000,0xbe483ec43f553f80
.quad 0xbf35bf80bf358000,0xbf35bf80bf358000,0xbe48bf6dbf558000,0x3f7b3ec4bf0ebf80,0x3ec4bf35bf6d8000,0xbec43f353f6d8000,0x3f55bec4bf7b8000,0xbf0ebf6d3e483f80
.quad 0x3f808000bf808000,0x3f808000bf808000,0x3f553ec4bf7b8000,0xbf0e3f6d3e48bf80,0x3ec43f35bf6d8000,0xbec4bf353f6d8000,0xbe483f6dbf558000,0x3f7bbec4bf0e3f80
.quad 0xbf353f80bf358000,0xbf353f80bf358000,0xbf7b3f6dbf0e8000,0xbe48bec43f55bf80,0xbf6d3f35bec48000,0x3f6dbf353ec48000,0xbf0e3ec4be488000,0xbf553f6dbf7b3f80
.quad 0x8000800080008000,0x8000800080008000,0x3f0ebec43e488000,0x3f55bf6d3f7bbf80,0x3f6dbf353ec48000,0xbf6d3f35bec48000,0x3f7bbf6d3f0e8000,0x3e483ec4bf553f80
.quad 0x3f35bf803f358000,0x3f35bf803f358000,0x3e48bf6d3f558000,0xbf7b3ec43f0ebf80,0xbec4bf353f6d8000,0x3ec43f35bf6d8000,0xbf55bec43f7b8000,0x3f0ebf6dbe483f80
.quad 0xbf8080003f808000,0xbf8080003f808000,0xbf553ec43f7b8000,0x3f0e3f6dbe48bf80,0xbec43f353f6d8000,0x3ec4bf35bf6d8000,0x3e483f6d3f558000,0xbf7bbec43f0e3f80
.quad 0x3f353f803f358000,0x3f353f803f358000,0x3f7b3f6d3f0e8000,0x3e48bec4bf55bf80,0x3f6d3f353ec48000,0xbf6dbf35bec48000,0x3f0e3ec43e488000,0x3f553f6d3f7b3f80
.quad 0x8000800080008000,0x8000800080008000,0xbf7bbf6dbf55bf35,0xbe48bec4bf0ebf35,0xbec4bf35bf6dbf80,0x3ec43f353f6d3f80,0x3f553ec4be48bf35,0xbf0ebf6dbf7bbf35
.quad 0x3f353f803f358000,0x3f353f803f358000,0xbf0e3ec43f7b3f35,0xbf55bf6dbe483f35,0xbf6dbf353ec43f80,0x3f6d3f35bec4bf80,0x3e48bf6dbf0e3f35,0xbf7bbec43f553f35
.quad 0x3f808000bf808000,0x3f808000bf808000,0x3e483f6dbf0ebf35,0xbf7b3ec43f55bf35,0xbf6d3f353ec4bf80,0x3f6dbf35bec43f80,0xbf0ebec43f7bbf35,0xbf553f6dbe48bf35
.quad 0x3f35bf803f358000,0x3f35bf803f358000,0x3f55bec4be483f35,0xbf0e3f6dbf7b3f35,0xbec43f35bf6d3f80,0x3ec4bf353f6dbf80,0xbf7b3f6dbf553f35,0xbe483ec4bf0e3f35
.quad 0x8000800080008000,0x8000800080008000,0x3f7bbf6d3f55bf35,0x3e48bec43f0ebf35,0x3ec4bf353f6dbf80,0xbec43f35bf6d3f80,0xbf553ec43e48bf35,0x3f0ebf6d3f7bbf35
.quad 0xbf353f80bf358000,0xbf353f80bf358000,0x3f0e3ec4bf7b3f35,0x3f55bf6d3e483f35,0x3f6dbf35bec43f80,0xbf6d3f353ec4bf80,0xbe48bf6d3f0e3f35,0x3f7bbec4bf553f35
.quad 0xbf8080003f808000,0xbf8080003f808000,0xbe483f6d3f0ebf35,0x3f7b3ec4bf55bf35,0x3f6d3f35bec4bf80,0xbf6dbf353ec43f80,0x3f0ebec4bf7bbf35,0x3f553f6d3e48bf35
.quad 0xbf35bf80bf358000,0xbf35bf80bf358000,0xbf55bec43e483f35,0x3f0e3f6d3f7b3f35,0x3ec43f353f6d3f80,0xbec4bf35bf6dbf80,0x3f7b3f6d3f553f35,0x3e483ec43f0e3f35
.quad 0x8000800080008000,0x8000800080008000,0x3f0e3ec43e488000,0x3f553f6d3f7b3f80,0xbf6dbf35bec48000,0x3f6d3f353ec48000,0x3f7b3f6d3f0e8000,0x3e48bec4bf55bf80
.quad 0xbf35bf80bf358000,0xbf35bf80bf358000,0x3e483f6d3f558000,0xbf7bbec43f0e3f80,0x3ec4bf35bf6d8000,0xbec43f353f6d8000,0xbf553ec43f7b8000,0x3f0e3f6dbe48bf80
.quad 0x3f808000bf808000,0x3f808000bf808000,0xbf55bec43f7b8000,0x3f0ebf6dbe483f80,0x3ec43f35bf6d8000,0xbec4bf353f6d8000,0x3e48bf6d3f558000,0xbf7b3ec43f0ebf80
.quad 0xbf353f80bf358000,0xbf353f80bf358000,0x3f7bbf6d3f0e8000,0x3e483ec4bf553f80,0xbf6d3f35bec48000,0x3f6dbf353ec48000,0x3f0ebec43e488000,0x3f55bf6d3f7bbf80
.quad 0x8000800080008000,0x8000800080008000,0xbf0e3ec4be488000,0xbf553f6dbf7b3f80,0x3f6dbf353ec48000,0xbf6d3f35bec48000,0xbf7b3f6dbf0e8000,0xbe48bec43f55bf80
.quad 0x3f35bf803f358000,0x3f35bf803f358000,0xbe483f6dbf558000,0x3f7bbec4bf0e3f80,0xbec4bf353f6d8000,0x3ec43f35bf6d8000,0x3f553ec4bf7b8000,0xbf0e3f6d3e48bf80
.quad 0xbf8080003f808000,0xbf8080003f808000,0x3f55bec4bf7b8000,0xbf0ebf6d3e483f80,0xbec43f353f6d8000,0x3ec4bf35bf6d8000,0xbe48bf6dbf558000,0x3f7b3ec4bf0ebf80
.quad 0x3f353f803f358000,0x3f353f803f358000,0xbf7bbf6dbf0e8000,0xbe483ec43f553f80,0x3f6d3f353ec48000,0xbf6dbf35bec48000,0xbf0ebec4be488000,0xbf55bf6dbf7bbf80
.quad 0x8000800080008000,0x8000800080008000,0x3f7b3f6d3f553f35,0x3e483ec43f0e3f35,0xbec4bf35bf6dbf80,0x3ec43f353f6d3f80,0xbf55bec43e483f35,0x3f0e3f6d3f7b3f35
.quad 0x3f353f803f358000,0x3f353f803f358000,0x3f0ebec4bf7bbf35,0x3f553f6d3e48bf35,0xbf6dbf353ec43f80,0x3f6d3f35bec4bf80,0xbe483f6d3f0ebf35,0x3f7b3ec4bf55bf35
.quad 0x3f808000bf808000,0x3f808000bf808000,0xbe48bf6d3f0e3f35,0x3f7bbec4bf553f35,0xbf6d3f353ec4bf80,0x3f6dbf35bec43f80,0x3f0e3ec4bf7b3f35,0x3f55bf6d3e483f35
.quad 0x3f35bf803f358000,0x3f35bf803f358000,0xbf553ec43e48bf35,0x3f0ebf6d3f7bbf35,0xbec43f35bf6d3f80,0x3ec4bf353f6dbf80,0x3f7bbf6d3f55bf35,0x3e48bec43f0ebf35
.quad 0x8000800080008000,0x8000800080008000,0xbf7b3f6dbf553f35,0xbe483ec4bf0e3f35,0x3ec4bf353f6dbf80,0xbec43f35bf6d3f80,0x3f55bec4be483f35,0xbf0e3f6dbf7b3f35
.quad 0xbf353f80bf358000,0xbf353f80bf358000,0xbf0ebec43f7bbf35,0xbf553f6dbe48bf35,0x3f6dbf35bec43f80,0xbf6d3f353ec4bf80,0x3e483f6dbf0ebf35,0xbf7b3ec43f55bf35
.quad 0xbf8080003f808000,0xbf8080003f808000,0x3e48bf6dbf0e3f35,0xbf7bbec43f553f35,0x3f6d3f35bec4bf80,0xbf6dbf353ec43f80,0xbf0e3ec43f7b3f35,0xbf55bf6dbe483f35
.quad 0xbf35bf80bf358000,0xbf35bf80bf358000,0x3f553ec4be48bf35,0xbf0ebf6dbf7bbf35,0x3ec43f353f6d3f80,0xbec4bf35bf6dbf80,0xbf7bbf6dbf55bf35,0xbe48bec4bf0ebf35
.quad 0x3f8000003f800000,0x3f8000003f800000,0x3f7fffb13f800000,0x3f7ffd393f7ffec4,0x3f7ffec43f800000,0x3f7ff4e63f7ffb11,0x3f7ffd393f800000,0x3f7fe7053f7ff4e6
.quad 0x3f7ffb113f800000,0x3f7fd3973f7fec43,0x3f7ff84a3f800000,0x3f7fba9e3f7fe129,0x3f7ff4e63f800000,0x3f7f9c183f7fd397,0x3f7ff0e33f800000,0x3f7f78083f7fc38f
.quad 0x3f7fec433f800000,0x3f7f4e6d3f7fb10f,0x3f7fe7053f800000,0x3f7f1f493f7f9c18,0x3f7fe1293f800000,0x3f7eea9d3f7f84ab,0x3f7fdaaf3f800000,0x3f7eb0693f7f6ac7
.quad 0x3f7fd3973f800000,0x3f7e70b03f7f4e6d,0x3f7fcbe23f800000,0x3f7e2b723f7f2f9d,0x3f7fc38f3f800000,0x3f7de0b13f7f0e58,0x3f7fba9e3f800000,0x3f7d906e3f7eea9d
.quad 0x3f7fb10f3f800000,0x3f7d3aac3f7ec46d,0x3f7fa6e33f800000,0x3f7cdf6c3f7e9bc9,0x3f7f9c183f800000,0x3f7c7eb03f7e70b0,0x3f7f90b13f800000,0x3f7c187a3f7e4323
.quad 0x3f7f84ab3f800000,0x3f7baccd3f7e1324,0x3f7f78083f800000,0x3f7b3bab3f7de0b1,0x3f7f6ac73f800000,0x3f7ac5163f7dabcc,0x3f7f5ce93f800000,0x3f7a49103f7d7474
.quad 0x3f7f4e6d3f800000,0x3f79c79d3f7d3aac,0x3f7f3f543f800000,0x3f7940c03f7cfe73,0x3f7f2f9d3f800000,0x3f78b47b3f7cbfc9,0x3f7f1f493f800000,0x3f7822d13f7c7eb0
.quad 0x3f7f0e583f800000,0x3f778bc53f7c3b28,0x3f7efcc93f800000,0x3f76ef5b3f7bf531,0x3f7eea9d3f800000,0x3f764d973f7baccd,0x3f7ed7d43f800000,0x3f75a67b3f7b61fc
.quad 0x3f8000003f800000,0x3f8000003f800000,0x3f7ff84a3f7ffb11,0x3f7ff0e33f7ff4e6,0x3f7fe1293f7fec43,0x3f7fc38f3f7fd397,0x3f7fba9e3f7fd397,0x3f7f78083f7f9c18
.quad 0x3f7f84ab3f7fb10f,0x3f7f0e583f7f4e6d,0x3f7f3f543f7f84ab,0x3f7e868b3f7eea9d,0x3f7eea9d3f7f4e6d,0x3f7de0b13f7e70b0,0x3f7e868b3f7f0e58,0x3f7d1cdd3f7de0b1
.quad 0x3f7e13243f7ec46d,0x3f7c3b283f7d3aac,0x3f7d906e3f7e70b0,0x3f7b3bab3f7c7eb0,0x3f7cfe733f7e1324,0x3f7a1e843f7baccd,0x3f7c5d3a3f7dabcc,0x3f78e3d63f7ac516
.quad 0x3f7baccd3f7d3aac,0x3f778bc53f79c79d,0x3f7aed373f7cbfc9,0x3f76167a3f78b47b,0x3f7a1e843f7c3b28,0x3f7484223f778bc5,0x3f7940c03f7baccd,0x3f72d4eb3f764d97
.quad 0x3f7853f83f7b14be,0x3f7109083f74fa0b,0x3f77583a3f7a7302,0x3f6f20b03f73913f,0x3f764d973f79c79d,0x3f6d1c1d3f721352,0x3f75341d3f791298,0x3f6afb8c3f708066
.quad 0x3f740bdd3f7853f8,0x3f68bf3c3f6ed89e,0x3f72d4eb3f778bc5,0x3f6667713f6d1c1d,0x3f718f573f76ba07,0x3f63f4733f6b4b0c,0x3f703b373f75dec6,0x3f61668a3f696591
.quad 0x3f6ed89e3f74fa0b,0x3f5ebe053f676bd8,0x3f6d67a13f740bdd,0x3f5bfb343f655e0b,0x3f6be8583f731447,0x3f591e6a3f633c5a,0x3f6a5ad93f721352,0x3f5627fe3f6106f2
.quad 0x3f68bf3c3f710908,0x3f5318493f5ebe05,0x3f6715993f6ff573,0x3f4fefa83f5c61c7,0x3f655e0b3f6ed89e,0x3f4cae793f59f26a,0x3f6398ac3f6db293,0x3f4955213f577026
.quad 0x3f8000003f800000,0x3f8000003f800000,0x3f7fe7053f7fec43,0x3f7fdaaf3f7fe129,0x3f7f9c183f7fb10f,0x3f7f6ac73f7f84ab,0x3f7f1f493f7f4e6d,0x3f7eb0693f7eea9d
.quad 0x3f7e70b03f7ec46d,0x3f7dabcc3f7e1324,0x3f7d906e3f7e1324,0x3f7c5d3a3f7cfe73,0x3f7c7eb03f7d3aac,0x3f7ac5163f7baccd,0x3f7b3bab3f7c3b28,0x3f78e3d63f7a1e84
.quad 0x3f79c79d3f7b14be,0x3f76ba073f7853f8,0x3f7822d13f79c79d,0x3f74484b3f764d97,0x3f764d973f7853f8,0x3f718f573f740bdd,0x3f74484b3f76ba07,0x3f6e8ff83f718f57
.quad 0x3f7213523f74fa0b,0x3f6b4b0c3f6ed89e,0x3f6faf1b3f731447,0x3f67c1873f6be858,0x3f6d1c1d3f710908,0x3f63f4733f68bf3c,0x3f6a5ad93f6ed89e,0x3f5fe4e93f655e0b
.quad 0x3f676bd83f6c835e,0x3f5b941a3f61c598,0x3f644fac3f6a09a7,0x3f5703483f5df6be,0x3f6106f23f676bd8,0x3f5233c63f59f26a,0x3f5d924d3f64aa59,0x3f4d26fd3f55b993
.quad 0x3f59f26a3f61c598,0x3f47de653f514d3d,0x3f5627fe3f5ebe05,0x3f425b893f4cae79,0x3f5233c63f5b941a,0x3f3ca0033f47de65,0x3f4e16893f584853,0x3f36ad7f3f42de29
.quad 0x3f49d1123f54db31,0x3f3085bb3f3daef9,0x3f4564393f514d3d,0x3f2a2a803f385216,0x3f40d0da3f4d9f02,0x3f239da93f32c8c9,0x3f3c17d93f49d112,0x3f1ce11f3f2d1469
.quad 0x3f373a233f45e403,0x3f15f6d93f273656,0x3f3238aa3f41d870,0x3f0ee0db3f212ff9,0x3f2d14693f3daef9,0x3f07a1363f1b02c6,0x3f27ce613f396842,0x3f003a063f14b039
.quad 0x3f8000003f800000,0x3f8000003f800000,0x3f7fcbe23f7fd397,0x3f7fba9e3f7fc38f,0x3f7f2f9d3f7f4e6d,0x3f7eea9d3f7f0e58,0x3f7e2b723f7e70b0,0x3f7d906e3f7de0b1
.quad 0x3f7cbfc93f7d3aac,0x3f7baccd3f7c3b28,0x3f7aed373f7baccd,0x3f7940c03f7a1e84,0x3f78b47b3f79c79d,0x3f764d973f778bc5,0x3f76167a3f778bc5,0x3f72d4eb3f748422
.quad 0x3f7314473f74fa0b,0x3f6ed89e3f710908,0x3f6faf1b3f721352,0x3f6a5ad93f6d1c1d,0x3f6be8583f6ed89e,0x3f655e0b3f68bf3c,0x3f67c1873f6b4b0c,0x3f5fe4e93f63f473
.quad 0x3f633c5a3f676bd8,0x3f59f26a3f5ebe05,0x3f5e5aa63f633c5a,0x3f5389c73f591e6a,0x3f591e6a3f5ebe05,0x3f4cae793f531849,0x3f5389c73f59f26a,0x3f4564393f4cae79
.quad 0x3f4d9f023f54db31,0x3f3daef93f45e403,0x3f4760853f4f7a1f,0x3f3592e73f3ebc1b,0x3f40d0da3f49d112,0x3f2d14693f373a23,0x3f39f2ac3f43e200,0x3f24381a3f2f61a5
.quad 0x3f32c8c93f3daef9,0x3f1b02c63f273656,0x3f2b561b3f373a23,0x3f11796b3f1ebc12,0x3f239da93f3085bb,0x3f07a1363f15f6d9,0x3f1ba2993f299415,0x3efafef73f0cead0
.quad 0x3f13682a3f226799,0x3ee633753f039c3d,0x3f0af1b73f1b02c6,0x3ed0eb2a3ef41f07,0x3f0242b13f13682a,0x3ebb31a03ee0924f,0x3ef2bd433f0b9a6b,0x3ea5129f3ecc9b8b
.quad 0x3ee0924f3f039c3d,0x3e8e9a223eb8442a,0x3ece0bea3ef6e0cb,0x3e6fa8b23ea395c5,0x3ebb31a03ee63375,0x3e419b373e8e9a22,0x3ea80b1f3ed53641,0x3e1324ca3e72b651
.quad 0x3f8000003f800000,0x3f8000003f800000,0x3f7fa6e33f7fb10f,0x3f7f90b13f7f9c18,0x3f7e9bc93f7ec46d,0x3f7e43233f7e70b0,0x3f7cdf6c3f7d3aac,0x3f7c187a3f7c7eb0
.quad 0x3f7a73023f7b14be,0x3f7912983f79c79d,0x3f77583a3f7853f8,0x3f75341d3f764d97,0x3f73913f3f74fa0b,0x3f7080663f721352,0x3f6f20b03f710908,0x3f6afb8c3f6d1c1d
.quad 0x3f6a09a73f6c835e,0x3f64aa593f676bd8,0x3f644fac3f676bd8,0x3f5d924d3f6106f2,0x3f5df6be3f61c598,0x3f55b9933f59f26a,0x3f5703483f5b941a,0x3f4d26fd3f5233c6
.quad 0x3f4f7a1f3f54db31,0x3f43e2003f49d112,0x3f4760853f4d9f02,0x3f39f2ac3f40d0da,0x3f3ebc1b3f45e403,0x3f2f61a53f373a23,0x3f3592e73f3daef9,0x3f24381a3f2d1469
.quad 0x3f2beb4a3f3504f3,0x3f187fc03f226799,0x3f21cbfb3f2beb4a,0x3f0c42c93f173c07,0x3f173c073f226799,0x3eff17b23f0b9a6b,0x3f0c42c93f187fc0,0x3ee4cbfe3eff17b2
.quad 0x3f00e7e43f0e39da,0x3ec9b9533ee63375,0x3eea66813f039c3d,0x3eadf73c3ecc9b8b,0x3ed25a093ef15aea,0x3e919ddd3eb263ef,0x3eb9bb1e3edae880,0x3e698bba3e97a117
.quad 0x3ea09ae53ec3ef15,0x3e2f10a23e78cfcc,0x3e870ada3eac7cd4,0x3de7fa9a3e419b37,0x3e5a39973e94a031,0x3d6214693e09cf86,0x3e25c58c3e78cfcc,0xbb490fc63da3308c
.quad 0x3de1bc2e3e47c5c2,0xbd7b2b743cc90ab0,0x3d6ea0383e164083,0xbdf475c0bcfb49ba,0x3bc90f883dc8bd36,0xbe354098bdafb680,0xbd3c6dd53d48fb30,0xbe6fa8b2be1008b7
.quad 0x3f8000003f800000,0x3f8000003f800000,0x3f7f78083f7f84ab,0x3f7f5ce93f7f6ac7,0x3f7de0b13f7e1324,0x3f7d74743f7dabcc,0x3f7b3bab3f7baccd,0x3f7a49103f7ac516
.quad 0x3f778bc53f7853f8,0x3f75dec63f76ba07,0x3f72d4eb3f740bdd,0x3f703b373f718f57,0x3f6d1c1d3f6ed89e,0x3f6965913f6b4b0c,0x3f6667713f68bf3c,0x3f61668a3f63f473
.quad 0x3f5ebe053f61c598,0x3f5848533f5b941a,0x3f5627fe3f59f26a,0x3f4e16893f5233c6,0x3f4cae793f514d3d,0x3f42de293f47de65,0x3f425b893f47de65,0x3f36ad7f3f3ca003
.quad 0x3f373a233f3daef9,0x3f2994153f3085bb,0x3f2b561b3f32c8c9,0x3f1ba2993f239da9,0x3f1ebc123f273656,0x3f0cead03f15f6d9,0x3f11796b3f1b02c6,0x3efafef73f07a136
.quad 0x3f039c3d3f0e39da,0x3edae8803ef15aea,0x3eea66813f00e7e4,0x3eb9bb1e3ed25a09,0x3ecc9b8b3ee63375,0x3e97a1173eb263ef,0x3eadf73c3ec9b953,0x3e698bba3e919ddd
.quad 0x3e8e9a223eac7cd4,0x3e22abb63e605c13,0x3e5d4b1a3e8e9a22,0x3db5f8da3e1c76de,0x3e1c76de3e605c13,0x3c96c9b63dafb680,0x3db5f8da3e22abb6,0xbd55880e3c96c9b6
.quad 0x3cc90ab03dc8bd36,0xbdfab273bd48fb30,0xbd2351cb3d16c32c,0xbe44b0b9bdee3876,0xbdd53db9bcc90ab0,0xbe8586cebe3b6ecf,0xbe2bf804bdafb680,0xbea80b1fbe7ee6e1
.quad 0xbe6c9a7fbe164083,0xbec9b953bea09ae5,0xbe9620d2be541501,0xbeea6681bec1071e,0xbeb554ecbe888e93,0xbf04f484bee0924f,0xbed3c867bea68f12,0xbf140c5fbeff17b2
.quad 0x3f8000003f800000,0x3f8000003f800000,0x3f7f3f543f7f4e6d,0x3f7f1f493f7f2f9d,0x3f7cfe733f7d3aac,0x3f7c7eb03f7cbfc9,0x3f7940c03f79c79d,0x3f7822d13f78b47b
.quad 0x3f740bdd3f74fa0b,0x3f7213523f731447,0x3f6d67a13f6ed89e,0x3f6a5ad93f6be858,0x3f655e0b3f676bd8,0x3f6106f23f633c5a,0x3f5bfb343f5ebe05,0x3f5627fe3f591e6a
.quad 0x3f514d3d3f54db31,0x3f49d1123f4d9f02,0x3f4564393f49d112,0x3f3c17d93f40d0da,0x3f3852163f3daef9,0x3f2d14693f32c8c9,0x3f2a2a803f3085bb,0x3f1ce11f3f239da9
.quad 0x3f1b02c63f226799,0x3f0b9a6b3f13682a,0x3f0af1b73f13682a,0x3ef2bd433f0242b1,0x3ef41f073f039c3d,0x3ecc9b8b3ee0924f,0x3ed0eb2a3ee63375,0x3ea5129f3ebb31a0
.quad 0x3eac7cd43ec3ef15,0x3e78cfcc3e94a031,0x3e870ada3ea09ae5,0x3e25c58c3e5a3997,0x3e419b373e78cfcc,0x3da3308c3e09cf86,0x3de7fa9a3e2f10a2,0xbb490fc63d621469
.quad 0x3d16c32c3dc8bd36,0xbdafb680bcc90ab0,0xbd2351cb3cc90ab0,0xbe2bf804bdd53db9,0xbdee3876bd48fb30,0xbe7ee6e1be3b6ecf,0xbe44b0b9bdfab273,0xbea80b1fbe8586ce
.quad 0xbe888e93be47c5c2,0xbecf7bcabeac7cd4,0xbeadf73cbe888e93,0xbef58035bed25a09,0xbed25a09beac7cd4,0xbf0cead0bef6e0cb,0xbef58035becf7bca,0xbf1e1e22bf0cead0
.quad 0xbf0b9a6bbef15aea,0xbf2e3bdebf1d7fd1,0xbf1ba299bf08f59b,0xbf3d27b8bf2d1469,0xbf2ac082bf187fc0,0xbf4ac77fbf3b8f3b,0xbf38dd65bf273656,0xbf570348bf48d8b3
.quad 0x3f8000003f800000,0x3f8000003f800000,0x3f7efcc93f7f0e58,0x3f7ed7d43f7eea9d,0x3f7bf5313f7c3b28,0x3f7b61fc3f7baccd,0x3f76ef5b3f778bc5,0x3f75a67b3f764d97
.quad 0x3f6ff5733f710908,0x3f6db2933f6ed89e,0x3f6715993f68bf3c,0x3f6398ac3f655e0b,0x3f5c61c73f5ebe05,0x3f5770263f59f26a,0x3f4fefa83f531849,0x3f4955213f4cae79
.quad 0x3f41d8703f45e403,0x3f3968423f3daef9,0x3f3238aa3f373a23,0x3f27ce613f2d1469,0x3f212ff93f273656,0x3f14b0393f1b02c6,0x3f0ee0db3f15f6d9,0x3f003a063f07a136
.quad 0x3ef6e0cb3f039c3d,0x3ed536413ee63375,0x3ece0bea3ee0924f,0x3ea80b1f3ebb31a0,0x3ea395c53eb8442a,0x3e72b6513e8e9a22,0x3e6fa8b23e8e9a22,0x3e1324ca3e419b37
.quad 0x3e1640833e47c5c2,0x3d48fb303dc8bd36,0x3d6ea0383de1bc2e,0xbd3c6dd53bc90f88,0xbcfb49ba3cc90ab0,0xbe1008b7bdafb680,0xbdf475c0bd7b2b74,0xbe6fa8b2be354098
.quad 0xbe541501be164083,0xbea68f12be888e93,0xbe9620d2be6c9a7f,0xbed3c867beb554ec,0xbec1071ebea09ae5,0xbeff17b2bee0924f,0xbeea6681bec9b953,0xbf140c5fbf04f484
.quad 0xbf08f59bbef15aea,0xbf273656bf187fc0,0xbf1ba299bf0b9a6b,0xbf38dd65bf2ac082,0xbf2d1469bf1d7fd1,0xbf48d8b3bf3b8f3b,0xbf3d27b8bf2e3bde,0xbf570348bf4ac77f
.quad 0xbf4bbbf8bf3daef9,0xbf633c5abf584853,0xbf58b3a1bf4bbbf8,0xbf6d67a1bf63f473,0xbf63f473bf584853,0xbf756d97bf6db293,0xbf6d67a1bf633c5a,0xbf7b3babbf756d97
.quad 0x0,0x0,0x3b490fc600000000,0x3c16cb583bc90f88,0x3bc90f8800000000,0x3c96c9b63c490e90,0x3c16cb5800000000,0x3ce22a7a3c96c9b6
.quad 0x3c490e9000000000,0x3d16c32c3cc90ab0,0x3c7b514b00000000,0x3d3c6dd53cfb49ba,0x3c96c9b600000000,0x3d6214693d16c32c,0x3cafea6900000000,0x3d83db0a3d2fe007
.quad 0x3cc90ab000000000,0x3d96a9053d48fb30,0x3ce22a7a00000000,0x3da973ba3d621469,0x3cfb49ba00000000,0x3dbc3ac33d7b2b74,0x3d0a342f00000000,0x3dcefdb73d8a200a
.quad 0x3d16c32c00000000,0x3de1bc2e3d96a905,0x3d2351cb00000000,0x3df475c03da3308c,0x3d2fe00700000000,0x3e0395023dafb680,0x3d3c6dd500000000,0x3e0cec4a3dbc3ac3
.quad 0x3d48fb3000000000,0x3e1640833dc8bd36,0x3d55880e00000000,0x3e1f917b3dd53db9,0x3d62146900000000,0x3e28defc3de1bc2e,0x3d6ea03800000000,0x3e3228d43dee3876
.quad 0x3d7b2b7400000000,0x3e3b6ecf3dfab273,0x3d83db0a00000000,0x3e44b0b93e039502,0x3d8a200a00000000,0x3e4dee603e09cf86,0x3d9064b400000000,0x3e57278f3e1008b7
.quad 0x3d96a90500000000,0x3e605c133e164083,0x3d9cecf900000000,0x3e698bba3e1c76de,0x3da3308c00000000,0x3e72b6513e22abb6,0x3da973ba00000000,0x3e7bdba43e28defc
.quad 0x3dafb68000000000,0x3e827dc03e2f10a2,0x3db5f8da00000000,0x3e870ada3e354098,0x3dbc3ac300000000,0x3e8b95073e3b6ecf,0x3dc27c3900000000,0x3e901c2c3e419b37
.quad 0x0,0x0,0x3c7b514b3c490e90,0x3cafea693c96c9b6,0x3cfb49ba3cc90ab0,0x3d2fe0073d16c32c,0x3d3c6dd53d16c32c,0x3d83db0a3d621469
.quad 0x3d7b2b743d48fb30,0x3dafb6803d96a905,0x3d9cecf93d7b2b74,0x3ddb7d373dbc3ac3,0x3dbc3ac33d96a905,0x3e0395023de1bc2e,0x3ddb7d373dafb680,0x3e195be03e039502
.quad 0x3dfab2733dc8bd36,0x3e2f10a23e164083,0x3e0cec4a3de1bc2e,0x3e44b0b93e28defc,0x3e1c76de3dfab273,0x3e5a39973e3b6ecf,0x3e2bf8043e09cf86,0x3e6fa8b23e4dee60
.quad 0x3e3b6ecf3e164083,0x3e827dc03e605c13,0x3e4ada4f3e22abb6,0x3e8d17c03e72b651,0x3e5a39973e2f10a2,0x3e97a1173e827dc0,0x3e698bba3e3b6ecf,0x3ea218873e8b9507
.quad 0x3e78cfcc3e47c5c2,0x3eac7cd43e94a031,0x3e8402703e541501,0x3eb6ccc33e9d9e78,0x3e8b95073e605c13,0x3ec1071e3ea68f12,0x3e931f353e6c9a7f,0x3ecb2aae3eaf713a
.quad 0x3e9aa0863e78cfcc,0x3ed536413eb8442a,0x3ea218873e827dc0,0x3edf28a93ec1071e,0x3ea986c43e888e93,0x3ee900b73ec9b953,0x3eb0eacb3e8e9a22,0x3ef2bd433ed25a09
.quad 0x3eb8442a3e94a031,0x3efc5d273edae880,0x3ebf926f3e9aa086,0x3f02ef9f3ee363fa,0x3ec6d5293ea09ae5,0x3f07a1363eebcbbb,0x3ece0bea3ea68f12,0x3f0c42c93ef41f07
.quad 0x3ed536413eac7cd4,0x3f10d3cd3efc5d27,0x3edc53c13eb263ef,0x3f1553b73f0242b1,0x3ee363fa3eb8442a,0x3f19c2003f064b82,0x3eea66813ebe1d4a,0x3f1e1e223f0a48ad
.quad 0x0,0x0,0x3ce22a7a3cc90ab0,0x3d0a342f3cfb49ba,0x3d6214693d48fb30,0x3d8a200a3d7b2b74,0x3da973ba3d96a905,0x3dcefdb73dbc3ac3
.quad 0x3de1bc2e3dc8bd36,0x3e09cf863dfab273,0x3e0cec4a3dfab273,0x3e2bf8043e1c76de,0x3e28defc3e164083,0x3e4dee603e3b6ecf,0x3e44b0b93e2f10a2,0x3e6fa8b23e5a3997
.quad 0x3e605c133e47c5c2,0x3e888e933e78cfcc,0x3e7bdba43e605c13,0x3e9920fe3e8b9507,0x3e8b95073e78cfcc,0x3ea986c43e9aa086,0x3e9920fe3e888e93,0x3eb9bb1e3ea986c4
.quad 0x3ea68f123e94a031,0x3ec9b9533eb8442a,0x3eb3dca53ea09ae5,0x3ed97cb93ec6d529,0x3ec1071e3eac7cd4,0x3ee900b73ed53641,0x3ece0bea3eb8442a,0x3ef840c83ee363fa
.quad 0x3edae8803ec3ef15,0x3f039c3d3ef15aea,0x3ee79a5d3ecf7bca,0x3f0af1b73eff17b2,0x3ef41f073edae880,0x3f121eb03f064b82,0x3f003a063ee63375,0x3f19210f3f0cead0
.quad 0x3f064b823ef15aea,0x3f1ff6cb3f13682a,0x3f0c42c93efc5d27,0x3f269de33f19c200,0x3f121eb03f039c3d,0x3f2d14693f1ff6cb,0x3f17de123f08f59b,0x3f33587a3f26050a
.quad 0x3f1d7fd13f0e39da,0x3f3968423f2beb4a,0x3f2302d33f13682a,0x3f3f41fc3f31a81d,0x3f2866053f187fc0,0x3f44e3f53f373a23,0x3f2da8593f1d7fd1,0x3f4a4c873f3ca003
.quad 0x3f32c8c93f226799,0x3f4f7a1f3f41d870,0x3f37c6553f273656,0x3f546b3b3f46e22a,0x3f3ca0033f2beb4a,0x3f591e6a3f4bbbf8,0x3f4154e13f3085bb,0x3f5d924d3f5064af
.quad 0x0,0x0,0x3d2351cb3d16c32c,0x3d3c6dd53d2fe007,0x3da3308c3d96a905,0x3dbc3ac33dafb680,0x3df475c03de1bc2e,0x3e0cec4a3e039502
.quad 0x3e22abb63e164083,0x3e3b6ecf3e2f10a2,0x3e4ada4f3e3b6ecf,0x3e698bba3e5a3997,0x3e72b6513e605c13,0x3e8b95073e827dc0,0x3e8d17c03e827dc0,0x3ea218873e97a117
.quad 0x3ea09ae53e94a031,0x3eb8442a3eac7cd4,0x3eb3dca53ea68f12,0x3ece0bea3ec1071e,0x3ec6d5293eb8442a,0x3ee363fa3ed53641,0x3ed97cb93ec9b953,0x3ef840c83ee900b7
.quad 0x3eebcbbb3edae880,0x3f064b823efc5d27,0x3efdbabb3eebcbbb,0x3f102dd53f07a136,0x3f07a1363efc5d27,0x3f19c2003f10d3cd,0x3f102dd53f064b82,0x3f2302d33f19c200
.quad 0x3f187fc03f0e39da,0x3f2beb4a3f226799,0x3f2093933f15f6d9,0x3f34768f3f2ac082,0x3f2866053f1d7fd1,0x3f3ca0033f32c8c9,0x3f2ff3e63f24d225,0x3f4463373f3a7ca4
.quad 0x3f373a233f2beb4a,0x3f4bbbf83f41d870,0x3f3e35c53f32c8c9,0x3f52a6493f48d8b3,0x3f44e3f53f396842,0x3f591e6a3f4f7a1f,0x3f4b41fa3f3fc767,0x3f5f20db3f55b993
.quad 0x3f514d3d3f45e403,0x3f64aa593f5b941a,0x3f5703483f4bbbf8,0x3f69b7e43f6106f2,0x3f5c61c73f514d3d,0x3f6e46be3f660f88,0x3f61668a3f5695e5,0x3f7254703f6aab7b
.quad 0x3f660f883f5b941a,0x3f75dec63f6ed89e,0x3f6a5ad93f604621,0x3f78e3d63f7294f8,0x3f6e46be3f64aa59,0x3f7b61fc3f75dec6,0x3f71d19f3f68bf3c,0x3f7d57de3f78b47b
.quad 0x0,0x0,0x3d55880e3d48fb30,0x3d6ea0383d621469,0x3dd53db93dc8bd36,0x3dee38763de1bc2e,0x3e1f917b3e164083,0x3e3228d43e28defc
.quad 0x3e5415013e47c5c2,0x3e6c9a7f3e605c13,0x3e8402703e78cfcc,0x3e931f353e8b9507,0x3e9d9e783e94a031,0x3eaf713a3ea68f12,0x3eb6ccc33eac7cd4,0x3ecb2aae3ec1071e
.quad 0x3ecf7bca3ec3ef15,0x3ee633753edae880,0x3ee79a5d3edae880,0x3f003a063ef41f07,0x3eff17b23ef15aea,0x3f0cead03f064b82,0x3f0af1b73f039c3d,0x3f19210f3f121eb0
.quad 0x3f15f6d93f0e39da,0x3f24d2253f1d7fd1,0x3f2093933f187fc0,0x3f2ff3e63f286605,0x3f2ac0823f226799,0x3f3a7ca43f32c8c9,0x3f34768f3f2beb4a,0x3f4463373f3ca003
.quad 0x3f3daef93f3504f3,0x3f4d9f023f45e403,0x3f4663543f3daef9,0x3f5627fe3f4e8d90,0x3f4e8d903f45e403,0x3f5df6be3f5695e5,0x3f5627fe3f4d9f02,0x3f6504793f5df6be
.quad 0x3f5d2d533f54db31,0x3f6b4b0c3f64aa59,0x3f6398ac3f5b941a,0x3f70c5013f6aab7b,0x3f6965913f61c598,0x3f756d973f6ff573,0x3f6e8ff83f676bd8,0x3f7940c03f748422
.quad 0x3f7314473f6c835e,0x3f7c3b283f7853f8,0x3f76ef5b3f710908,0x3f7e5a383f7b61fc,0x3f7a1e843f74fa0b,0x3f7f9c183f7dabcc,0x3f7c9f8a3f7853f8,0x3f7fffb13f7f2f9d
.quad 0x3f7e70b03f7b14be,0x3f7f84ab3f7fec43,0x3f7f90b13f7d3aac,0x3f7e2b723f7fe129,0x3f7ffec43f7ec46d,0x3f7bf5313f7f0e58,0x3f7fba9e3f7fb10f,0x3f78e3d63f7d7474
.quad 0x0,0x0,0x3d83db0a3d7b2b74,0x3d9064b43d8a200a,0x3e0395023dfab273,0x3e1008b73e09cf86,0x3e44b0b93e3b6ecf,0x3e57278f3e4dee60
.quad 0x3e827dc03e78cfcc,0x3e8e9a223e888e93,0x3ea218873e9aa086,0x3eb0eacb3ea986c4,0x3ec1071e3eb8442a,0x3ed25a093ec9b953,0x3edf28a93ed53641,0x3ef2bd433ee900b7
.quad 0x3efc5d273ef15aea,0x3f08f59b3f039c3d,0x3f0c42c93f064b82,0x3f17de123f121eb0,0x3f19c2003f13682a,0x3f26050a3f1ff6cb,0x3f269de33f1ff6cb,0x3f33587a3f2d1469
.quad 0x3f32c8c93f2beb4a,0x3f3fc7673f396842,0x3f3e35c53f373a23,0x3f4b41fa3f44e3f5,0x3f48d8b33f41d870,0x3f55b9933f4f7a1f,0x3f52a6493f4bbbf8,0x3f5f20db3f591e6a
.quad 0x3f5b941a3f54db31,0x3f676bd83f61c598,0x3f6398ac3f5d2d53,0x3f6e8ff83f696591,0x3f6aab7b3f64aa59,0x3f7484223f6ff573,0x3f70c5013f6b4b0c,0x3f7940c03f756d97
.quad 0x3f75dec63f710908,0x3f7cbfc93f79c79d,0x3f79f35e3f75dec6,0x3f7efcc93f7cfe73,0x3f7cfe733f79c79d,0x3f7ff4e63f7f0e58,0x3f7efcc93f7cbfc9,0x3f7fa6e33f7ff4e6
.quad 0x3f7fec433f7ec46d,0x3f7e13243f7fb10f,0x3f7fcbe23f7fd397,0x3f7b3bab3f7e4323,0x3f7e9bc93f7fec43,0x3f7724173f7baccd,0x3f7c5d3a3f7f0e58,0x3f71d19f3f77f110
.quad 0x3f7912983f7d3aac,0x3f6b4b0c3f731447,0x3f74bf623f7a7302,0x3f6398ac3f6d1c1d,0x3f6f68303f76ba07,0x3f5ac4503f660f88,0x3f6912ae3f721352,0x3f50d9373f5df6be
.quad 0x0,0x0,0x3d9cecf93d96a905,0x3da973ba3da3308c,0x3e1c76de3e164083,0x3e28defc3e22abb6,0x3e698bba3e605c13,0x3e7bdba43e72b651
.quad 0x3e9aa0863e94a031,0x3ea68f123ea09ae5,0x3ebf926f3eb8442a,0x3ece0bea3ec6d529,0x3ee363fa3edae880,0x3ef41f073eebcbbb,0x3f02ef9f3efc5d27,0x3f0c42c93f07a136
.quad 0x3f13682a3f0e39da,0x3f1d7fd13f187fc0,0x3f2302d33f1d7fd1,0x3f2da8593f286605,0x3f31a81d3f2beb4a,0x3f3ca0033f373a23,0x3f3f41fc3f396842,0x3f4a4c873f44e3f5
.quad 0x3f4bbbf83f45e403,0x3f5695e53f514d3d,0x3f5703483f514d3d,0x3f61668a3f5c61c7,0x3f6106f23f5b941a,0x3f6aab7b3f660f88,0x3f69b7e43f64aa59,0x3f7254703f6e46be
.quad 0x3f7109083f6c835e,0x3f7853f83f74fa0b,0x3f76ef5b3f731447,0x3f7c9f8a3f7a1e84,0x3f7b61fc3f7853f8,0x3f7f2f9d3f7dabcc,0x3f7e5a383f7c3b28,0x3f7fffb13f7f9c18
.quad 0x3f7fd3973f7ec46d,0x3f7f0e583f7fec43,0x3f7fcbe23f7fec43,0x3f7c5d3a3f7e9bc9,0x3f7e43233f7fb10f,0x3f77f1103f7baccd,0x3f7b3bab3f7e1324,0x3f71d19f3f772417
.quad 0x3f76ba073f7b14be,0x3f6a09a73f710908,0x3f70c5013f76ba07,0x3f60a6cf3f696591,0x3f6965913f710908,0x3f55b9933f604621,0x3f60a6cf3f6a09a7,0x3f4955213f55b993
.quad 0x3f5695e53f61c598,0x3f3b8f3b3f49d112,0x3f4b41fa3f584853,0x3f2c800f3f3ca003,0x3f3ebc1b3f4d9f02,0x3f1c420c3f2e3bde,0x3f3117223f41d870,0x3f0af1b73f1ebc12
.quad 0x0,0x0,0x3db5f8da3dafb680,0x3dc27c393dbc3ac3,0x3e3540983e2f10a2,0x3e419b373e3b6ecf,0x3e870ada3e827dc0,0x3e901c2c3e8b9507
.quad 0x3eb263ef3eac7cd4,0x3ebe1d4a3eb8442a,0x3edc53c13ed53641,0x3eea66813ee363fa,0x3f0242b13efc5d27,0x3f0a48ad3f064b82,0x3f1553b73f10d3cd,0x3f1e1e223f19c200
.quad 0x3f2736563f226799,0x3f3085bb3f2beb4a,0x3f37c6553f32c8c9,0x3f4154e13f3ca003,0x3f46e22a3f41d870,0x3f5064af3f4bbbf8,0x3f546b3b3f4f7a1f,0x3f5d924d3f591e6a
.quad 0x3f6046213f5b941a,0x3f68bf3c3f64aa59,0x3f6a5ad93f660f88,0x3f71d19f3f6e46be,0x3f7294f83f6ed89e,0x3f78b47b3f75dec6,0x3f78e3d63f75dec6,0x3f7d57de3f7b61fc
.quad 0x3f7d3aac3f7b14be,0x3f7fb10f3f7ec46d,0x3f7f90b13f7e70b0,0x3f7fba9e3f7ffec4,0x3f7fe1293f7fec43,0x3f7d74743f7f0e58,0x3f7e2b723f7f84ab,0x3f78e3d63f7bf531
.quad 0x3f7a73023f7d3aac,0x3f7213523f76ba07,0x3f74bf623f791298,0x3f6912ae3f6f6830,0x3f6d1c1d3f731447,0x3f5df6be3f660f88,0x3f6398ac3f6b4b0c,0x3f50d9373f5ac450
.quad 0x3f5848533f61c598,0x3f41d8703f4d9f02,0x3f4b41fa3f5695e5,0x3f3117223f3ebc1b,0x3f3ca0033f49d112,0x3f1ebc123f2e3bde,0x3f2c800f3f3b8f3b,0x3f0af1b73f1c420c
.quad 0x3f1b02c63f2beb4a,0x3eebcbbb3f08f59b,0x3f084b923f1b02c6,0x3ebf926f3ee900b7,0x3ee900b73f08f59b,0x3e919ddd3ebe1d4a,0x3ebf926f3eebcbbb,0x3e44b0b93e919ddd
.quad 0x3f7ec46d3f800000,0x3f74fa0b3f7b14be,0x3f7eb0693f800000,0x3f74484b3f7ac516,0x3f7e9bc93f800000,0x3f73913f3f7a7302,0x3f7e868b3f800000,0x3f72d4eb3f7a1e84
.quad 0x3f7e70b03f800000,0x3f7213523f79c79d,0x3f7e5a383f800000,0x3f714c7a3f796e4e,0x3f7e43233f800000,0x3f7080663f791298,0x3f7e2b723f800000,0x3f6faf1b3f78b47b
.quad 0x3f7e13243f800000,0x3f6ed89e3f7853f8,0x3f7dfa383f800000,0x3f6dfcf23f77f110,0x3f7de0b13f800000,0x3f6d1c1d3f778bc5,0x3f7dc68c3f800000,0x3f6c36243f772417
.quad 0x3f7dabcc3f800000,0x3f6b4b0c3f76ba07,0x3f7d906e3f800000,0x3f6a5ad93f764d97,0x3f7d74743f800000,0x3f6965913f75dec6,0x3f7d57de3f800000,0x3f686b393f756d97
.quad 0x3f7d3aac3f800000,0x3f676bd83f74fa0b,0x3f7d1cdd3f800000,0x3f6667713f748422,0x3f7cfe733f800000,0x3f655e0b3f740bdd,0x3f7cdf6c3f800000,0x3f644fac3f73913f
.quad 0x3f7cbfc93f800000,0x3f633c5a3f731447,0x3f7c9f8a3f800000,0x3f62241a3f7294f8,0x3f7c7eb03f800000,0x3f6106f23f721352,0x3f7c5d3a3f800000,0x3f5fe4e93f718f57
.quad 0x3f7c3b283f800000,0x3f5ebe053f710908,0x3f7c187a3f800000,0x3f5d924d3f708066,0x3f7bf5313f800000,0x3f5c61c73f6ff573,0x3f7bd14d3f800000,0x3f5b2c793f6f6830
.quad 0x3f7baccd3f800000,0x3f59f26a3f6ed89e,0x3f7b87b23f800000,0x3f58b3a13f6e46be,0x3f7b61fc3f800000,0x3f5770263f6db293,0x3f7b3bab3f800000,0x3f5627fe3f6d1c1d
.quad 0x3f61c5983f6c835e,0x3f45e4033f54db31,0x3f5fe4e93f6b4b0c,0x3f425b893f5233c6,0x3f5df6be3f6a09a7,0x3f3ebc1b3f4f7a1f,0x3f5bfb343f68bf3c,0x3f3b06293f4cae79
.quad 0x3f59f26a3f676bd8,0x3f373a233f49d112,0x3f57dc7f3f660f88,0x3f33587a3f46e22a,0x3f55b9933f64aa59,0x3f2f61a53f43e200,0x3f5389c73f633c5a,0x3f2b561b3f40d0da
.quad 0x3f514d3d3f61c598,0x3f2736563f3daef9,0x3f4f04173f604621,0x3f2302d33f3a7ca4,0x3f4cae793f5ebe05,0x3f1ebc123f373a23,0x3f4a4c873f5d2d53,0x3f1a62933f33e7bc
.quad 0x3f47de653f5b941a,0x3f15f6d93f3085bb,0x3f4564393f59f26a,0x3f11796b3f2d1469,0x3f42de293f584853,0x3f0cead03f299415,0x3f404c5c3f5695e5,0x3f084b923f26050a
.quad 0x3f3daef93f54db31,0x3f039c3d3f226799,0x3f3b06293f531849,0x3efdbabb3f1ebc12,0x3f3852163f514d3d,0x3ef41f073f1b02c6,0x3f3592e73f4f7a1f,0x3eea66813f173c07
.quad 0x3f32c8c93f4d9f02,0x3ee0924f3f13682a,0x3f2ff3e63f4bbbf8,0x3ed6a3993f0f8784,0x3f2d14693f49d112,0x3ecc9b8b3f0b9a6b,0x3f2a2a803f47de65,0x3ec27b553f07a136
.quad 0x3f2736563f45e403,0x3eb8442a3f039c3d,0x3f24381a3f43e200,0x3eadf73c3eff17b2,0x3f212ff93f41d870,0x3ea395c53ef6e0cb,0x3f1e1e223f3fc767,0x3e9920fe3eee9479
.quad 0x3f1b02c63f3daef9,0x3e8e9a223ee63375,0x3f17de123f3b8f3b,0x3e8402703eddbe79,0x3f14b0393f396842,0x3e72b6513ed53641,0x3f11796b3f373a23,0x3e5d4b1a3ecc9b8b
.quad 0x3f2267993f3504f3,0x3ef15aea3f0e39da,0x3f1ce11f3f3085bb,0x3ee1fb6a3f07a136,0x3f173c073f2beb4a,0x3ed25a093f00e7e4,0x3f11796b3f273656,0x3ec27b553ef41f07
.quad 0x3f0b9a6b3f226799,0x3eb263ef3ee63375,0x3f05a02c3f1d7fd1,0x3ea218873ed8106b,0x3eff17b23f187fc0,0x3e919ddd3ec9b953,0x3ef2bd433f13682a,0x3e80f8c03ebb31a0
.quad 0x3ee633753f0e39da,0x3e605c133eac7cd4,0x3ed97cb93f08f59b,0x3e3e853e3e9d9e78,0x3ecc9b8b3f039c3d,0x3e1c76de3e8e9a22,0x3ebf926f3efc5d27,0x3df475c03e7ee6e1
.quad 0x3eb263ef3ef15aea,0x3dafb6803e605c13,0x3ea5129f3ee63375,0x3d55880e3e419b37,0x3e97a1173edae880,0x3c96c9b63e22abb6,0x3e8a11f73ecf7bca,0xbc7b514b3e039502
.quad 0x3e78cfcc3ec3ef15,0xbd48fb303dc8bd36,0x3e5d4b1a3eb8442a,0xbda973ba3d8a200a,0x3e419b373eac7cd4,0xbdee38763d16c32c,0x3e25c58c3ea09ae5,0xbe195be03bc90f88
.quad 0x3e09cf863e94a031,0xbe3b6ecfbcc90ab0,0x3ddb7d373e888e93,0xbe5d4b1abd621469,0x3da3308c3e78cfcc,0xbe7ee6e1bdafb680,0x3d55880e3e605c13,0xbe901c2cbdee3876
.quad 0x3cc90ab03e47c5c2,0xbea09ae5be164083,0xbb490fc63e2f10a2,0xbeb0eacbbe354098,0xbcfb49ba3e164083,0xbec1071ebe541501,0xbd6ea0383dfab273,0xbed0eb2abe72b651
.quad 0xbdafb6803dc8bd36,0xbee0924fbe888e93,0xbde7fa9a3d96a905,0xbeeff7fbbe97a117,0xbe1008b73d48fb30,0xbeff17b2bea68f12,0xbe2bf8043cc90ab0,0xbf06f686beb554ec
.quad 0x3e94a0313ec3ef15,0x3dc8bd363e47c5c2,0x3e80f8c03eb263ef,0x3d55880e3e1c76de,0x3e5a39973ea09ae5,0x3bc90f883de1bc2e,0x3e3228d43e8e9a22,0xbd2351cb3d8a200a
.quad 0x3e09cf863e78cfcc,0xbdafb6803cc90ab0,0x3dc27c393e541501,0xbe06b26ebc96c9b6,0x3d6214693e2f10a2,0xbe354098bd7b2b74,0x3c7b514b3e09cf86,0xbe636c83bdd53db9
.quad 0xbcc90ab03dc8bd36,0xbe888e93be164083,0xbd83db0a3d7b2b74,0xbe9f1cdfbe419b37,0xbdd53db93cc90ab0,0xbeb554ecbe6c9a7f,0xbe1324cabc490e90,0xbecb2aaebe8b9507
.quad 0xbe3b6ecfbd48fb30,0xbee0924fbea09ae5,0xbe636c83bdafb680,0xbef58035beb554ec,0xbe8586cebdfab273,0xbf04f484bec9b953,0xbe9920febe22abb6,0xbf0ee0dbbeddbe79
.quad 0xbeac7cd4be47c5c2,0xbf187fc0bef15aea,0xbebf926fbe6c9a7f,0xbf21cbfbbf0242b1,0xbed25a09be888e93,0xbf2ac082bf0b9a6b,0xbee4cbfebe9aa086,0xbf33587abf14b039
.quad 0xbef6e0cbbeac7cd4,0xbf3b8f3bbf1d7fd1,0xbf044889bebe1d4a,0xbf436051bf26050a,0xbf0cead0becf7bca,0xbf4ac77fbf2e3bde,0xbf1553b7bee0924f,0xbf51c0c2bf36206c
.quad 0xbf1d7fd1bef15aea,0xbf584853bf3daef9,0xbf256bcbbf00e7e4,0xbf5e5aa6bf44e3f5,0xbf2d1469bf08f59b,0xbf63f473bf4bbbf8,0xbf34768fbf10d3cd,0xbf6912aebf5233c6
.quad 0xbf3b8f3bbf187fc0,0xbf6db293bf584853,0xbf425b89bf1ff6cb,0xbf71d19fbf5df6be,0xbf48d8b3bf273656,0xbf756d97bf633c5a,0xbf4f0417bf2e3bde,0xbf788486bf6816a8
.quad 0xbdc8bd3600000000,0xbe94a031be47c5c2,0xbe195be0bd48fb30,0xbeb0eacbbe7ee6e1,0xbe4dee60bdc8bd36,0xbecc9b8bbe9aa086,0xbe80f8c0be164083,0xbee79a5dbeb554ec
.quad 0xbe9aa086be47c5c2,0xbf00e7e4becf7bca,0xbeb3dca5be78cfcc,0xbf0d9281bee900b7,0xbecc9b8bbe94a031,0xbf19c200bf00e7e4,0xbee4cbfebeac7cd4,0xbf256bcbbf0cead0
.quad 0xbefc5d27bec3ef15,0xbf3085bbbf187fc0,0xbf099f4ebedae880,0xbf3b0629bf239da9,0xbf14b039bef15aea,0xbf44e3f5bf2e3bde,0xbf1f599fbf039c3d,0xbf4e1689bf385216
.quad 0xbf299415bf0e39da,0xbf5695e5bf41d870,0xbf33587abf187fc0,0xbf5e5aa6bf4ac77f,0xbf3ca003bf226799,0xbf655e0bbf531849,0xbf456439bf2beb4a,0xbf6b99fbbf5ac450
.quad 0xbf4d9f02bf3504f3,0xbf710908bf61c598,0xbf554aa4bf3daef9,0xbf75a67bbf6816a8,0xbf5c61c7bf45e403,0xbf796e4ebf6db293,0xbf62df7bbf4d9f02,0xbf7c5d3abf7294f8
.quad 0xbf68bf3cbf54db31,0xbf7e70b0bf76ba07,0xbf6dfcf2bf5b941a,0xbf7fa6e3bf7a1e84,0xbf7294f8bf61c598,0xbf7ffec4bf7cbfc9,0xbf76841bbf676bd8,0xbf7f7808bf7e9bc9
.quad 0xbf79c79dbf6c835e,0xbf7e1324bf7fb10f,0xbf7c5d3abf710908,0xbf7bd14dbf7ffec4,0xbf7e4323bf74fa0b,0xbf78b47bbf7f84ab,0xbf7f7808bf7853f8,0xbf74bf62bf7e4323
.quad 0xbf7ffb11bf7b14be,0xbf6ff573bf7c3b28,0xbf7fcbe2bf7d3aac,0xbf6a5ad9bf796e4e,0xbf7eea9dbf7ec46d,0xbf63f473bf75dec6,0xbf7d57debf7fb10f,0xbf5cc7d1bf718f57
.quad 0xbef15aeabec3ef15,0xbf226799bf0e39da,0xbf06f686bee0924f,0xbf2ff3e6bf1c420c,0xbf14b039befc5d27,0xbf3ca003bf299415,0xbf21cbfbbf0b9a6b,0xbf485bcabf36206c
.quad 0xbf2e3bdebf187fc0,0xbf531849bf41d870,0xbf39f2acbf24d225,0xbf5cc7d1bf4cae79,0xbf44e3f5bf3085bb,0xbf655e0bbf5695e5,0xbf4f0417bf3b8f3b,0xbf6cd007bf5f8327
.quad 0xbf584853bf45e403,0xbf731447bf676bd8,0xbf60a6cfbf4f7a1f,0xbf7822d1bf6e46be,0xbf6816a8bf584853,0xbf7bf531bf740bdd,0xbf6e8ff8bf604621,0xbf7e868bbf78b47b
.quad 0xbf740bddbf676bd8,0xbf7fd397bf7c3b28,0xbf788486bf6db293,0xbf7fdaafbf7e9bc9,0xbf7bf531bf731447,0xbf7e9bc9bf7fd397,0xbf7e5a38bf778bc5,0xbf7c187abf7fe129
.quad 0xbf7fb10fbf7b14be,0xbf7853f8bf7ec46d,0xbf7ff84abf7dabcc,0xbf73530ebf7c7eb0,0xbf7f2f9dbf7f4e6d,0xbf6d1c1dbf791298,0xbf7d57debf7ffb11,0xbf65b710bf748422
.quad 0xbf7a7302bf7fb10f,0xbf5d2d53bf6ed89e,0xbf76841bbf7e70b0,0xbf5389c7bf6816a8,0xbf718f57bf7c3b28,0xbf48d8b3bf604621,0xbf6b99fbbf791298,0xbf3d27b8bf577026
.quad 0xbf64aa59bf74fa0b,0xbf3085bbbf4d9f02,0xbf5cc7d1bf6ff573,0xbf2302d3bf42de29,0xbf53fac3bf6a09a7,0xbf14b039bf373a23,0xbf4a4c87bf633c5a,0xbf05a02cbf2ac082
.quad 0xbf3fc767bf5b941a,0xbeebcbbbbf1d7fd1,0xbf34768fbf531849,0xbecb2aaebf0f8784,0xbf286605bf49d112,0xbea986c4bf00e7e4,0xbf1ba299bf3fc767,0xbe870adabee363fa
.quad 0xbf45e403bf3504f3,0xbf61c598bf54db31,0xbf51c0c2bf41d870,0xbf6afb8cbf5f8327,0xbf5c61c7bf4d9f02,0xbf7294f8bf68bf3c,0xbf65b710bf584853,0xbf788486bf708066
.quad 0xbf6db293bf61c598,0xbf7cbfc9bf76ba07,0xbf74484bbf6a09a7,0xbf7f3f54bf7b61fc,0xbf796e4ebf710908,0xbf7ffec4bf7e70b0,0xbf7d1cddbf76ba07,0xbf7efcc9bf7fe129
.quad 0xbf7f4e6dbf7b14be,0xbf7c3b28bf7fb10f,0xbf7fffb1bf7e1324,0xbf77beb7bf7de0b1,0xbf7f2f9dbf7fb10f,0xbf718f57bf7a7302,0xbf7cdf6cbf7fec43,0xbf69b7e4bf756d97
.quad 0xbf791298bf7ec46d,0xbf604621bf6ed89e,0xbf73ced9bf7c3b28,0xbf554aa4bf66becc,0xbf6d1c1dbf7853f8,0xbf48d8b3bf5d2d53,0xbf650479bf731447,0xbf3b0629bf5233c6
.quad 0xbf5b941abf6c835e,0xbf2beb4abf45e403,0xbf50d937bf64aa59,0xbf1ba299bf385216,0xbf44e3f5bf5b941a,0xbf0a48adbf299415,0xbf37c655bf514d3d,0xbeeff7fbbf19c200
.quad 0xbf299415bf45e403,0xbec9b953bf08f59b,0xbf1a6293bf396842,0xbea21887beee9479,0xbf0a48adbf2beb4a,0xbe72b651bec9b953,0xbef2bd43bf1d7fd1,0xbe1f917bbea395c5
.quad 0xbecf7bcabf0e39da,0xbd96a905be78cfcc,0xbeab0201befc5d27,0x3c16cb58be28defc,0xbe8586cebedae880,0x3dbc3ac3bdafb680,0xbe3e853ebeb8442a,0x3e3228d4bbc90f88
.quad 0xbde1bc2ebe94a031,0x3e827dc03d96a905,0xbd0a342fbe605c13,0x3eab02013e1c76de,0x3d2fe007be164083,0x3ed25a093e6c9a7f,0x3df475c0bd96a905,0x3ef840c83e9d9e78
.quad 0xbf74fa0bbf6c835e,0xbf7ec46dbf7b14be,0xbf7a9c59bf740bdd,0xbf7fffb1bf7e9bc9,0xbf7e4323bf79c79d,0xbf7eea9dbf7ffb11,0xbf7fe705bf7dabcc,0xbf7b87b2bf7f2f9d
.quad 0xbf7f84abbf7fb10f,0xbf75dec6bf7c3b28,0xbf7d1cddbf7fd397,0xbf6dfcf2bf772417,0xbf78b47bbf7e1324,0xbf63f473bf6ff573,0xbf725470bf7a7302,0xbf57dc7fbf66becc
.quad 0xbf6a09a7bf74fa0b,0xbf49d112bf5b941a,0xbf5fe4e9bf6db293,0xbf39f2acbf4e8d90,0xbf53fac3bf64aa59,0xbf286605bf3fc767,0xbf466354bf59f26a,0xbf1553b7bf2f61a5
.quad 0xbf373a23bf4d9f02,0xbf00e7e4bf1d7fd1,0xbf269de3bf3fc767,0xbed6a399bf0a48ad,0xbf14b039bf3085bb,0xbea986c4beebcbbb,0xbf019573bf1ff6cb,0xbe75c35abec1071e
.quad 0xbedae880bf0e39da,0xbe164083be94a031,0xbeb0eacbbef6e0cb,0xbd55880ebe4dee60,0xbe8586cebecf7bca,0x3d2fe007bde1bc2e,0xbe3228d4bea68f12,0x3e0cec4abc96c9b6
.quad 0xbdafb680be78cfcc,0x3e6c9a7f3d96a905,0x3b490fc6be22abb6,0x3ea5129f3e28defc,0x3dbc3ac3bd96a905,0x3ed25a093e827dc0,0x3e3857ec3c490e90,0x3efdbabb3eaf713a
.quad 0x3e888e933dc8bd36,0x3f13682a3edae880,0x3eb3dca53e3b6ecf,0x3f269de33f0242b1,0x3eddbe793e888e93,0x3f3852163f15f6d9,0x3f02ef9f3eb263ef,0x3f485bca3f286605
.quad 0x3f15f6d93edae880,0x3f5695e53f396842,0x3f27ce613f00e7e4,0x3f62df7b3f48d8b3,0x3f3852163f13682a,0x3f6d1c1d3f5695e5,0x3f4760853f24d225,0x3f75341d3f628210
.quad 0x3dc8bd3600000000,0x3e94a0313e47c5c2,0x3dcefdb700000000,0x3e9920fe3e4dee60,0x3dd53db900000000,0x3e9d9e783e541501,0x3ddb7d3700000000,0x3ea218873e5a3997
.quad 0x3de1bc2e00000000,0x3ea68f123e605c13,0x3de7fa9a00000000,0x3eab02013e667c66,0x3dee387600000000,0x3eaf713a3e6c9a7f,0x3df475c000000000,0x3eb3dca53e72b651
.quad 0x3dfab27300000000,0x3eb8442a3e78cfcc,0x3e00774500000000,0x3ebca7af3e7ee6e1,0x3e03950200000000,0x3ec1071e3e827dc0,0x3e06b26e00000000,0x3ec5625c3e8586ce
.quad 0x3e09cf8600000000,0x3ec9b9533e888e93,0x3e0cec4a00000000,0x3ece0bea3e8b9507,0x3e1008b700000000,0x3ed25a093e8e9a22,0x3e1324ca00000000,0x3ed6a3993e919ddd
.quad 0x3e16408300000000,0x3edae8803e94a031,0x3e195be000000000,0x3edf28a93e97a117,0x3e1c76de00000000,0x3ee363fa3e9aa086,0x3e1f917b00000000,0x3ee79a5d3e9d9e78
.quad 0x3e22abb600000000,0x3eebcbbb3ea09ae5,0x3e25c58c00000000,0x3eeff7fb3ea395c5,0x3e28defc00000000,0x3ef41f073ea68f12,0x3e2bf80400000000,0x3ef840c83ea986c4
.quad 0x3e2f10a200000000,0x3efc5d273eac7cd4,0x3e3228d400000000,0x3f003a063eaf713a,0x3e35409800000000,0x3f0242b13eb263ef,0x3e3857ec00000000,0x3f0448893eb554ec
.quad 0x3e3b6ecf00000000,0x3f064b823eb8442a,0x3e3e853e00000000,0x3f084b923ebb31a0,0x3e419b3700000000,0x3f0a48ad3ebe1d4a,0x3e44b0b900000000,0x3f0c42c93ec1071e
.quad 0x3ef15aea3ec3ef15,0x3f2267993f0e39da,0x3ef840c83ec9b953,0x3f269de33f121eb0,0x3eff17b23ecf7bca,0x3f2ac0823f15f6d9,0x3f02ef9f3ed53641,0x3f2ecef73f19c200
.quad 0x3f064b823edae880,0x3f32c8c93f1d7fd1,0x3f099f4e3ee0924f,0x3f36ad7f3f212ff9,0x3f0cead03ee63375,0x3f3a7ca43f24d225,0x3f102dd53eebcbbb,0x3f3e35c53f286605
.quad 0x3f13682a3ef15aea,0x3f41d8703f2beb4a,0x3f16999f3ef6e0cb,0x3f4564393f2f61a5,0x3f19c2003efc5d27,0x3f48d8b33f32c8c9,0x3f1ce11f3f00e7e4,0x3f4c35783f36206c
.quad 0x3f1ff6cb3f039c3d,0x3f4f7a1f3f396842,0x3f2302d33f064b82,0x3f52a6493f3ca003,0x3f26050a3f08f59b,0x3f55b9933f3fc767,0x3f28fd413f0b9a6b,0x3f58b3a13f42de29
.quad 0x3f2beb4a3f0e39da,0x3f5b941a3f45e403,0x3f2ecef73f10d3cd,0x3f5e5aa63f48d8b3,0x3f31a81d3f13682a,0x3f6106f23f4bbbf8,0x3f34768f3f15f6d9,0x3f6398ac3f4e8d90
.quad 0x3f373a233f187fc0,0x3f660f883f514d3d,0x3f39f2ac3f1b02c6,0x3f686b393f53fac3,0x3f3ca0033f1d7fd1,0x3f6aab7b3f5695e5,0x3f3f41fc3f1ff6cb,0x3f6cd0073f591e6a
.quad 0x3f41d8703f226799,0x3f6ed89e3f5b941a,0x3f4463373f24d225,0x3f70c5013f5df6be,0x3f46e22a3f273656,0x3f7294f83f604621,0x3f4955213f299415,0x3f74484b3f628210
.quad 0x3f4bbbf83f2beb4a,0x3f75dec63f64aa59,0x3f4e16893f2e3bde,0x3f77583a3f66becc,0x3f5064af3f3085bb,0x3f78b47b3f68bf3c,0x3f52a6493f32c8c9,0x3f79f35e3f6aab7b
.quad 0x3f45e4033f3504f3,0x3f61c5983f54db31,0x3f4a4c873f396842,0x3f65b7103f591e6a,0x3f4e8d903f3daef9,0x3f6965913f5d2d53,0x3f52a6493f41d870,0x3f6cd0073f6106f2
.quad 0x3f5695e53f45e403,0x3f6ff5733f64aa59,0x3f5a5ba03f49d112,0x3f72d4eb3f6816a8,0x3f5df6be3f4d9f02,0x3f756d973f6b4b0c,0x3f61668a3f514d3d,0x3f77beb73f6e46be
.quad 0x3f64aa593f54db31,0x3f79c79d3f710908,0x3f67c1873f584853,0x3f7b87b23f73913f,0x3f6aab7b3f5b941a,0x3f7cfe733f75dec6,0x3f6d67a13f5ebe05,0x3f7e2b723f77f110
.quad 0x3f6ff5733f61c598,0x3f7f0e583f79c79d,0x3f7254703f64aa59,0x3f7fa6e33f7b61fc,0x3f7484223f676bd8,0x3f7ff4e63f7cbfc9,0x3f76841b3f6a09a7,0x3f7ff84a3f7de0b1
.quad 0x3f7853f83f6c835e,0x3f7fb10f3f7ec46d,0x3f79f35e3f6ed89e,0x3f7f1f493f7f6ac7,0x3f7b61fc3f710908,0x3f7e43233f7fd397,0x3f7c9f8a3f731447,0x3f7d1cdd3f7ffec4
.quad 0x3f7dabcc3f74fa0b,0x3f7baccd3f7fec43,0x3f7e868b3f76ba07,0x3f79f35e3f7f9c18,0x3f7f2f9d3f7853f8,0x3f77f1103f7f0e58,0x3f7fa6e33f79c79d,0x3f75a67b3f7e4323
.quad 0x3f7fec433f7b14be,0x3f7314473f7d3aac,0x3f7fffb13f7c3b28,0x3f703b373f7bf531,0x3f7fe1293f7d3aac,0x3f6d1c1d3f7a7302,0x3f7f90b13f7e1324,0x3f69b7e43f78b47b
.quad 0x3f7f0e583f7ec46d,0x3f660f883f76ba07,0x3f7e5a383f7f4e6d,0x3f62241a3f748422,0x3f7d74743f7fb10f,0x3f5df6be3f721352,0x3f7c5d3a3f7fec43,0x3f5988ad3f6f6830
.quad 0x3f74fa0b3f6c835e,0x3f7ec46d3f7b14be,0x3f77beb73f6ff573,0x3f7fa6e33f7cfe73,0x3f7a1e843f731447,0x3f7ffec43f7e70b0,0x3f7c187a3f75dec6,0x3f7fcbe23f7f6ac7
.quad 0x3f7dabcc3f7853f8,0x3f7f0e583f7fec43,0x3f7ed7d43f7a7302,0x3f7dc68c3f7ff4e6,0x3f7f9c183f7c3b28,0x3f7bf5313f7f84ab,0x3f7ff84a3f7dabcc,0x3f799b433f7e9bc9
.quad 0x3f7fec433f7ec46d,0x3f76ba073f7d3aac,0x3f7f78083f7f84ab,0x3f73530e3f7b61fc,0x3f7e9bc93f7fec43,0x3f6f68303f791298,0x3f7d57de3f7ffb11,0x3f6afb8c3f764d97
.quad 0x3f7baccd3f7fb10f,0x3f660f883f731447,0x3f799b433f7f0e58,0x3f60a6cf3f6f6830,0x3f7724173f7e1324,0x3f5ac4503f6b4b0c,0x3f74484b3f7cbfc9,0x3f546b3b3f66becc
.quad 0x3f7109083f7b14be,0x3f4d9f023f61c598,0x3f6d67a13f791298,0x3f4663543f5c61c7,0x3f6965913f76ba07,0x3f3ebc1b3f5695e5,0x3f6504793f740bdd,0x3f36ad7f3f5064af
.quad 0x3f6046213f710908,0x3f2e3bde3f49d112,0x3f5b2c793f6db293,0x3f256bcb3f42de29,0x3f55b9933f6a09a7,0x3f1c420c3f3b8f3b,0x3f4fefa83f660f88,0x3f12c39a3f33e7bc
.quad 0x3f49d1123f61c598,0x3f08f59b3f2beb4a,0x3f4360513f5d2d53,0x3efdbabb3f239da9,0x3f3ca0033f584853,0x3ee900b73f1b02c6,0x3f3592e73f531849,0x3ed3c8673f121eb0
.quad 0x3f2e3bde3f4d9f02,0x3ebe1d4a3f08f59b,0x3f269de33f47de65,0x3ea80b1f3eff17b2,0x3f1ebc123f41d870,0x3e919ddd3eebcbbb,0x3f16999f3f3b8f3b,0x3e75c35a3ed8106b
.quad 0x3f7ec46d3f800000,0x3f74fa0b3f7b14be,0x3f7d1cdd3f7fb10f,0x3f703b373f77f110,0x3f7ac5163f7ec46d,0x3f6aab7b3f740bdd,0x3f77beb73f7d3aac,0x3f644fac3f6f6830
.quad 0x3f740bdd3f7b14be,0x3f5d2d533f6a09a7,0x3f6faf1b3f7853f8,0x3f554aa43f63f473,0x3f6aab7b3f74fa0b,0x3f4cae793f5d2d53,0x3f6504793f710908,0x3f4360513f55b993
.quad 0x3f5ebe053f6c835e,0x3f3968423f4d9f02,0x3f57dc7f3f676bd8,0x3f2ecef73f44e3f5,0x3f5064af3f61c598,0x3f239da93f3b8f3b,0x3f485bca3f5b941a,0x3f17de123f31a81d
.quad 0x3f3fc7673f54db31,0x3f0b9a6b3f273656,0x3f36ad7f3f4d9f02,0x3efdbabb3f1c420c,0x3f2d14693f45e403,0x3ee363fa3f10d3cd,0x3f2302d33f3daef9,0x3ec8477c3f04f484
.quad 0x3f187fc03f3504f3,0x3eac7cd43ef15aea,0x3f0d92813f2beb4a,0x3e901c2c3ed8106b,0x3f0242b13f226799,0x3e667c663ebe1d4a,0x3eed30633f187fc0,0x3e2bf8043ea395c5
.quad 0x3ed536413f0e39da,0x3de1bc2e3e888e93,0x3ebca7af3f039c3d,0x3d55880e3e5a3997,0x3ea395c53ef15aea,0xbbc90f883e22abb6,0x3e8a11f73edae880,0xbd83db0a3dd53db9
.quad 0x3e605c133ec3ef15,0xbdfab2733d48fb30,0x3e2bf8043eac7cd4,0xbe3857ecbbc90f88,0x3dee38763e94a031,0xbe72b651bd7b2b74,0x3d83db0a3e78cfcc,0xbe9620d2bdee3876
.quad 0x3c490e903e47c5c2,0xbeb263efbe2f10a2,0xbd2351cb3e164083,0xbece0beabe667c66,0xbdbc3ac33dc8bd36,0xbee900b7be8e9a22,0xbe1324ca3d48fb30,0xbf019573bea986c4
.quad 0x3f61c5983f6c835e,0x3f45e4033f54db31,0x3f5988ad3f660f88,0x3f39f2ac3f4ac77f,0x3f5064af3f5ebe05,0x3f2d14693f3fc767,0x3f4663543f5695e5,0x3f1f599f3f33e7bc
.quad 0x3f3b8f3b3f4d9f02,0x3f10d3cd3f273656,0x3f2ff3e63f43e200,0x3f0195733f19c200,0x3f239da93f396842,0x3ee363fa3f0b9a6b,0x3f16999f3f2e3bde,0x3ec27b553ef9a02d
.quad 0x3f08f59b3f226799,0x3ea09ae53edae880,0x3ef580353f15f6d9,0x3e7bdba43ebb31a0,0x3ed8106b3f08f59b,0x3e3540983e9aa086,0x3eb9bb1e3ef6e0cb,0x3ddb7d373e72b651
.quad 0x3e9aa0863edae880,0x3d16c32c3e2f10a2,0x3e75c35a3ebe1d4a,0xbd0a342f3dd53db9,0x3e3540983ea09ae5,0xbdd53db93d16c32c,0x3de7fa9a3e827dc0,0xbe3228d4bcfb49ba
.quad 0x3d48fb303e47c5c2,0xbe78cfccbdc8bd36,0xbc7b514b3e09cf86,0xbe9f1cdfbe28defc,0xbda3308c3d96a905,0xbec1071ebe6c9a7f,0xbe1324ca3c490e90,0xbee1fb6abe97a117
.quad 0xbe541501bd48fb30,0xbf00e7e4beb8442a,0xbe8a11f7bde1bc2e,0xbf102dd5bed8106b,0xbea986c4be2f10a2,0xbf1ebc12bef6e0cb,0xbec8477cbe6c9a7f,0xbf2c800fbf0a48ad
.quad 0xbee63375be94a031,0xbf396842bf187fc0,0xbf019573beb263ef,0xbf456439bf26050a,0xbf0f8784becf7bca,0xbf5064afbf32c8c9,0xbf1ce11fbeebcbbb,0xbf5a5ba0bf3ebc1b
.quad 0xbf299415bf039c3d,0xbf633c5abf49d112,0xbf3592e7bf10d3cd,0xbf6afb8cbf53fac3,0xbf40d0dabf1d7fd1,0xbf718f57bf5d2d53,0xbf4b41fabf299415,0xbf76ef5bbf655e0b
.quad 0x3f2267993f3504f3,0x3ef15aea3f0e39da,0x3f12c39a3f273656,0x3ecb2aae3ef9a02d,0x3f0242b13f187fc0,0x3ea395c53ed53641,0x3ee1fb6a3f08f59b,0x3e75c35a3eaf713a
.quad 0x3ebe1d4a3ef15aea,0x3e22abb63e888e93,0x3e9920fe3ecf7bca,0x3d9cecf93e419b37,0x3e667c663eac7cd4,0xbbc90f883de1bc2e,0x3e195be03e888e93,0xbdb5f8da3cfb49ba
.quad 0x3d96a9053e47c5c2,0xbe2f10a2bd48fb30,0xbb490fc63dfab273,0xbe80f8c0be039502,0xbda3308c3d48fb30,0xbea986c4be541501,0xbe1f917bbcc90ab0,0xbed0eb2abe919ddd
.quad 0xbe6c9a7fbdc8bd36,0xbef6e0cbbeb8442a,0xbe9c1fafbe2f10a2,0xbf0d9281beddbe79,0xbec1071ebe78cfcc,0xbf1ebc12bf00e7e4,0xbee4cbfebea09ae5,0xbf2ecef7bf121eb0
.quad 0xbf039c3dbec3ef15,0xbf3daef9bf226799,0xbf140c5fbee63375,0xbf4b41fabf31a81d,0xbf239da9bf039c3d,0xbf577026bf3fc767,0xbf3238aabf13682a,0xbf62241abf4cae79
.quad 0xbf3fc767bf226799,0xbf6b4b0cbf584853,0xbf4c3578bf3085bb,0xbf72d4ebbf628210,0xbf577026bf3daef9,0xbf78b47bbf6b4b0c,0xbf61668abf49d112,0xbf7cdf6cbf7294f8
.quad 0xbf6a09a7bf54db31,0xbf7f4e6dbf7853f8,0xbf714c7abf5ebe05,0xbf7ffd39bf7c7eb0,0xbf772417bf676bd8,0xbf7eea9dbf7f0e58,0xbf7b87b2bf6ed89e,0xbf7c187abf7ffec4
.quad 0xbf7e70b0bf74fa0b,0xbf778bc5bf7f4e6d,0xbf7fdaafbf79c79d,0xbf714c7abf7cfe73,0xbf7fc38fbf7d3aac,0xbf696591bf791298,0xbf7e2b72bf7f4e6d,0xbf5fe4e9bf73913f
.quad 0x3e94a0313ec3ef15,0x3dc8bd363e47c5c2,0x3e5101f13e9aa086,0x3b490fc63dd53db9,0x3dee38763e605c13,0xbdbc3ac33c490e90,0x3ce22a7a3e09cf86,0xbe3e853ebda3308c
.quad 0xbd7b2b743d48fb30,0xbe8e9a22be2f10a2,0xbe195be0bd16c32c,0xbebca7afbe8586ce,0xbe72b651bdfab273,0xbee900b7beb263ef,0xbea5129fbe541501,0xbf099f4ebeddbe79
.quad 0xbecf7bcabe94a031,0xbf1d7fd1bf039c3d,0xbef840c8bebe1d4a,0xbf2ff3e6bf173c07,0xbf0f8784bee63375,0xbf40d0dabf299415,0xbf21cbfbbf064b82,0xbf4fefa8bf3a7ca4
.quad 0xbf32c8c9bf187fc0,0xbf5d2d53bf49d112,0xbf425b89bf299415,0xbf686b39bf577026,0xbf5064afbf396842,0xbf718f57bf633c5a,0xbf5cc7d1bf47de65,0xbf788486bf6d1c1d
.quad 0xbf676bd8bf54db31,0xbf7d3aacbf74fa0b,0xbf703b37bf604621,0xbf7fa6e3bf7ac516,0xbf772417bf6a09a7,0xbf7fc38fbf7e70b0,0xbf7c187abf721352,0xbf7d906ebf7ff4e6
.quad 0xbf7f0e58bf7853f8,0xbf791298bf7f4e6d,0xbf7fffb1bf7cbfc9,0xbf725470bf7c7eb0,0xbf7eea9dbf7f4e6d,0xbf696591bf778bc5,0xbf7bd14dbf7ffb11,0xbf5e5aa6bf708066
.quad 0xbf76ba07bf7ec46d,0xbf514d3dbf676bd8,0xbf6faf1bbf7baccd,0xbf425b89bf5c61c7,0xbf66beccbf76ba07,0xbf31a81dbf4f7a1f,0xbf5bfb34bf6ff573,0xbf1f599fbf40d0da
.quad 0xbf4f7a1fbf676bd8,0xbf0b9a6bbf3085bb,0xbf4154e1bf5d2d53,0xbeed3063bf1ebc12,0xbf31a81dbf514d3d,0xbec1071ebf0b9a6b,0xbf209393bf43e200,0xbe931f35beee9479
.fill 2048,1,0
.set C0,16256
.set C1,16256
.set C2,16256
.set C3,16256
.set C4,16256
.set C5,16255
.set C6,16255
.set C7,16255
.set C8,16254
.set C9,16254
.set C10,16253
.set C11,16253
.set C12,16252
.set C13,16252
.set C14,16251
.set C15,16250
.set C16,16250
.set C17,16249
.set C18,16248
.set C19,16247
.set C20,16246
.set C21,16245
.set C22,16244
.set C23,16243
.set C24,16242
.set C25,16240
.set C26,16239
.set C27,16238
.set C28,16237
.set C29,16235
.set C30,16234
.set C31,16232
.set C32,16231
.set C33,16229
.set C34,16227
.set C35,16226
.set C36,16224
.set C37,16222
.set C38,16220
.set C39,16219
.set C40,16217
.set C41,16215
.set C42,16213
.set C43,16211
.set C44,16209
.set C45,16207
.set C46,16205
.set C47,16202
.set C48,16200
.set C49,16198
.set C50,16196
.set C51,16193
.set C52,16191
.set C53,16188
.set C54,16186
.set C55,16184
.set C56,16181
.set C57,16178
.set C58,16176
.set C59,16173
.set C60,16171
.set C61,16168
.set C62,16165
.set C63,16162
.set C64,16160
.set C65,16157
.set C66,16154
.set C67,16151
.set C68,16148
.set C69,16145
.set C70,16142
.set C71,16139
.set C72,16136
.set C73,16133
.set C74,16130
.set C75,16126
.set C76,16120
.set C77,16113
.set C78,16107
.set C79,16101
.set C80,16094
.set C81,16088
.set C82,16081
.set C83,16075
.set C84,16068
.set C85,16061
.set C86,16055
.set C87,16048
.set C88,16041
.set C89,16034
.set C90,16027
.set C91,16021
.set C92,16014
.set C93,16007
.set C94,16000
.set C95,15986
.set C96,15972
.set C97,15958
.set C98,15944
.set C99,15930
.set C100,15916
.set C101,15901
.set C102,15887
.set C103,15873
.set C104,15845
.set C105,15817
.set C106,15788
.set C107,15759
.set C108,15718
.set C109,15660
.set C110,15590
.set C111,15462
.set C112,0
.set C113,48230
.set C114,48358
.set C115,48428
.set C116,48486
.set C117,48527
.set C118,48556
.set C119,48585
.set C120,48613
.set C121,48641
.set C122,48655
.set C123,48669
.set C124,48684
.set C125,48698
.set C126,48712
.set C127,48726
.set C128,48740
.set C129,48754
.set C130,48768
.set C131,48775
.set C132,48782
.set C133,48789
.set C134,48795
.set C135,48802
.set C136,48809
.set C137,48816
.set C138,48823
.set C139,48829
.set C140,48836
.set C141,48843
.set C142,48849
.set C143,48856
.set C144,48862
.set C145,48869
.set C146,48875
.set C147,48881
.set C148,48888
.set C149,48894
.set C150,48898
.set C151,48901
.set C152,48904
.set C153,48907
.set C154,48910
.set C155,48913
.set C156,48916
.set C157,48919
.set C158,48922
.set C159,48925
.set C160,48928
.set C161,48930
.set C162,48933
.set C163,48936
.set C164,48939
.set C165,48941
.set C166,48944
.set C167,48946
.set C168,48949
.set C169,48952
.set C170,48954
.set C171,48956
.set C172,48959
.set C173,48961
.set C174,48964
.set C175,48966
.set C176,48968
.set C177,48970
.set C178,48973
.set C179,48975
.set C180,48977
.set C181,48979
.set C182,48981
.set C183,48983
.set C184,48985
.set C185,48987
.set C186,48988
.set C187,48990
.set C188,48992
.set C189,48994
.set C190,48995
.set C191,48997
.set C192,48999
.set C193,49000
.set C194,49002
.set C195,49003
.set C196,49005
.set C197,49006
.set C198,49007
.set C199,49008
.set C200,49010
.set C201,49011
.set C202,49012
.set C203,49013
.set C204,49014
.set C205,49015
.set C206,49016
.set C207,49017
.set C208,49018
.set C209,49018
.set C210,49019
.set C211,49020
.set C212,49020
.set C213,49021
.set C214,49021
.set C215,49022
.set C216,49022
.set C217,49023
.set C218,49023
.set C219,49023
.set C220,49024
.set C221,49024
.set C222,49024
.set C223,49024
.set C224,49024
.set C225,49024
.set C226,49024
.set C227,49024
.set C228,49024
.set C229,49023
.set C230,49023
.set C231,49023
.set C232,49022
.set C233,49022
.set C234,49021
.set C235,49021
.set C236,49020
.set C237,49020
.set C238,49019
.set C239,49018
.set C240,49018
.set C241,49017
.set C242,49016
.set C243,49015
.set C244,49014
.set C245,49013
.set C246,49012
.set C247,49011
.set C248,49010
.set C249,49008
.set C250,49007
.set C251,49006
.set C252,49005
.set C253,49003
.set C254,49002
.set C255,49000
.set C256,48999
.set C257,48997
.set C258,48995
.set C259,48994
.set C260,48992
.set C261,48990
.set C262,48988
.set C263,48987
.set C264,48985
.set C265,48983
.set C266,48981
.set C267,48979
.set C268,48977
.set C269,48975
.set C270,48973
.set C271,48970
.set C272,48968
.set C273,48966
.set C274,48964
.set C275,48961
.set C276,48959
.set C277,48956
.set C278,48954
.set C279,48952
.set C280,48949
.set C281,48946
.set C282,48944
.set C283,48941
.set C284,48939
.set C285,48936
.set C286,48933
.set C287,48930
.set C288,48928
.set C289,48925
.set C290,48922
.set C291,48919
.set C292,48916
.set C293,48913
.set C294,48910
.set C295,48907
.set C296,48904
.set C297,48901
.set C298,48898
.set C299,48894
.set C300,48888
.set C301,48881
.set C302,48875
.set C303,48869
.set C304,48862
.set C305,48856
.set C306,48849
.set C307,48843
.set C308,48836
.set C309,48829
.set C310,48823
.set C311,48816
.set C312,48809
.set C313,48802
.set C314,48795
.set C315,48789
.set C316,48782
.set C317,48775
.set C318,48768
.set C319,48754
.set C320,48740
.set C321,48726
.set C322,48712
.set C323,48698
.set C324,48684
.set C325,48669
.set C326,48655
.set C327,48641
.set C328,48613
.set C329,48585
.set C330,48556
.set C331,48527
.set C332,48486
.set C333,48428
.set C334,48358
.set C335,48230
.set C336,0
.set C337,15462
.set C338,15590
.set C339,15660
.set C340,15718
.set C341,15759
.set C342,15788
.set C343,15817
.set C344,15845
.set C345,15873
.set C346,15887
.set C347,15901
.set C348,15916
.set C349,15930
.set C350,15944
.set C351,15958
.set C352,15972
.set C353,15986
.set C354,16000
.set C355,16007
.set C356,16014
.set C357,16021
.set C358,16027
.set C359,16034
.set C360,16041
.set C361,16048
.set C362,16055
.set C363,16061
.set C364,16068
.set C365,16075
.set C366,16081
.set C367,16088
.set C368,16094
.set C369,16101
.set C370,16107
.set C371,16113
.set C372,16120
.set C373,16126
.set C374,16130
.set C375,16133
.set C376,16136
.set C377,16139
.set C378,16142
.set C379,16145
.set C380,16148
.set C381,16151
.set C382,16154
.set C383,16157
.set C384,16160
.set C385,16162
.set C386,16165
.set C387,16168
.set C388,16171
.set C389,16173
.set C390,16176
.set C391,16178
.set C392,16181
.set C393,16184
.set C394,16186
.set C395,16188
.set C396,16191
.set C397,16193
.set C398,16196
.set C399,16198
.set C400,16200
.set C401,16202
.set C402,16205
.set C403,16207
.set C404,16209
.set C405,16211
.set C406,16213
.set C407,16215
.set C408,16217
.set C409,16219
.set C410,16220
.set C411,16222
.set C412,16224
.set C413,16226
.set C414,16227
.set C415,16229
.set C416,16231
.set C417,16232
.set C418,16234
.set C419,16235
.set C420,16237
.set C421,16238
.set C422,16239
.set C423,16240
.set C424,16242
.set C425,16243
.set C426,16244
.set C427,16245
.set C428,16246
.set C429,16247
.set C430,16248
.set C431,16249
.set C432,16250
.set C433,16250
.set C434,16251
.set C435,16252
.set C436,16252
.set C437,16253
.set C438,16253
.set C439,16254
.set C440,16254
.set C441,16255
.set C442,16255
.set C443,16255
.set C444,16256
.set C445,16256
.set C446,16256
.set C447,16256
.set D0,13842
.set D1,13842
.set D2,13842
.set D3,13842
.set D4,13842
.set D5,13842
.set D6,13842
.set D7,13842
.set D8,13841
.set D9,13841
.set D10,13841
.set D11,13841
.set D12,13840
.set D13,13840
.set D14,13839
.set D15,13839
.set D16,13839
.set D17,13838
.set D18,13838
.set D19,13837
.set D20,13837
.set D21,13836
.set D22,13835
.set D23,13835
.set D24,13834
.set D25,13833
.set D26,13833
.set D27,13832
.set D28,13831
.set D29,13830
.set D30,13830
.set D31,13829
.set D32,13828
.set D33,13827
.set D34,13826
.set D35,13825
.set D36,13824
.set D37,13822
.set D38,13820
.set D39,13818
.set D40,13816
.set D41,13814
.set D42,13811
.set D43,13809
.set D44,13807
.set D45,13804
.set D46,13802
.set D47,13799
.set D48,13797
.set D49,13794
.set D50,13792
.set D51,13789
.set D52,13786
.set D53,13783
.set D54,13781
.set D55,13778
.set D56,13775
.set D57,13772
.set D58,13769
.set D59,13766
.set D60,13763
.set D61,13760
.set D62,13757
.set D63,13754
.set D64,13750
.set D65,13747
.set D66,13744
.set D67,13741
.set D68,13737
.set D69,13734
.set D70,13731
.set D71,13727
.set D72,13724
.set D73,13720
.set D74,13717
.set D75,13713
.set D76,13710
.set D77,13706
.set D78,13702
.set D79,13699
.set D80,13694
.set D81,13686
.set D82,13679
.set D83,13671
.set D84,13664
.set D85,13656
.set D86,13649
.set D87,13641
.set D88,13633
.set D89,13625
.set D90,13618
.set D91,13610
.set D92,13602
.set D93,13594
.set D94,13586
.set D95,13578
.set D96,13570
.set D97,13556
.set D98,13540
.set D99,13524
.set D100,13508
.set D101,13492
.set D102,13476
.set D103,13459
.set D104,13443
.set D105,13413
.set D106,13381
.set D107,13348
.set D108,13315
.set D109,13253
.set D110,13187
.set D111,13059
.set D112,0
.set D113,45827
.set D114,45955
.set D115,46021
.set D116,46083
.set D117,46116
.set D118,46149
.set D119,46181
.set D120,46211
.set D121,46227
.set D122,46244
.set D123,46260
.set D124,46276
.set D125,46292
.set D126,46308
.set D127,46324
.set D128,46338
.set D129,46346
.set D130,46354
.set D131,46362
.set D132,46370
.set D133,46378
.set D134,46386
.set D135,46393
.set D136,46401
.set D137,46409
.set D138,46417
.set D139,46424
.set D140,46432
.set D141,46439
.set D142,46447
.set D143,46454
.set D144,46462
.set D145,46467
.set D146,46470
.set D147,46474
.set D148,46478
.set D149,46481
.set D150,46485
.set D151,46488
.set D152,46492
.set D153,46495
.set D154,46499
.set D155,46502
.set D156,46505
.set D157,46509
.set D158,46512
.set D159,46515
.set D160,46518
.set D161,46522
.set D162,46525
.set D163,46528
.set D164,46531
.set D165,46534
.set D166,46537
.set D167,46540
.set D168,46543
.set D169,46546
.set D170,46549
.set D171,46551
.set D172,46554
.set D173,46557
.set D174,46560
.set D175,46562
.set D176,46565
.set D177,46567
.set D178,46570
.set D179,46572
.set D180,46575
.set D181,46577
.set D182,46579
.set D183,46582
.set D184,46584
.set D185,46586
.set D186,46588
.set D187,46590
.set D188,46592
.set D189,46593
.set D190,46594
.set D191,46595
.set D192,46596
.set D193,46597
.set D194,46598
.set D195,46598
.set D196,46599
.set D197,46600
.set D198,46601
.set D199,46601
.set D200,46602
.set D201,46603
.set D202,46603
.set D203,46604
.set D204,46605
.set D205,46605
.set D206,46606
.set D207,46606
.set D208,46607
.set D209,46607
.set D210,46607
.set D211,46608
.set D212,46608
.set D213,46609
.set D214,46609
.set D215,46609
.set D216,46609
.set D217,46610
.set D218,46610
.set D219,46610
.set D220,46610
.set D221,46610
.set D222,46610
.set D223,46610
.set D224,46610
.set D225,46610
.set D226,46610
.set D227,46610
.set D228,46610
.set D229,46610
.set D230,46610
.set D231,46610
.set D232,46609
.set D233,46609
.set D234,46609
.set D235,46609
.set D236,46608
.set D237,46608
.set D238,46607
.set D239,46607
.set D240,46607
.set D241,46606
.set D242,46606
.set D243,46605
.set D244,46605
.set D245,46604
.set D246,46603
.set D247,46603
.set D248,46602
.set D249,46601
.set D250,46601
.set D251,46600
.set D252,46599
.set D253,46598
.set D254,46598
.set D255,46597
.set D256,46596
.set D257,46595
.set D258,46594
.set D259,46593
.set D260,46592
.set D261,46590
.set D262,46588
.set D263,46586
.set D264,46584
.set D265,46582
.set D266,46579
.set D267,46577
.set D268,46575
.set D269,46572
.set D270,46570
.set D271,46567
.set D272,46565
.set D273,46562
.set D274,46560
.set D275,46557
.set D276,46554
.set D277,46551
.set D278,46549
.set D279,46546
.set D280,46543
.set D281,46540
.set D282,46537
.set D283,46534
.set D284,46531
.set D285,46528
.set D286,46525
.set D287,46522
.set D288,46518
.set D289,46515
.set D290,46512
.set D291,46509
.set D292,46505
.set D293,46502
.set D294,46499
.set D295,46495
.set D296,46492
.set D297,46488
.set D298,46485
.set D299,46481
.set D300,46478
.set D301,46474
.set D302,46470
.set D303,46467
.set D304,46462
.set D305,46454
.set D306,46447
.set D307,46439
.set D308,46432
.set D309,46424
.set D310,46417
.set D311,46409
.set D312,46401
.set D313,46393
.set D314,46386
.set D315,46378
.set D316,46370
.set D317,46362
.set D318,46354
.set D319,46346
.set D320,46338
.set D321,46324
.set D322,46308
.set D323,46292
.set D324,46276
.set D325,46260
.set D326,46244
.set D327,46227
.set D328,46211
.set D329,46181
.set D330,46149
.set D331,46116
.set D332,46083
.set D333,46021
.set D334,45955
.set D335,45827
.set D336,0
.set D337,13059
.set D338,13187
.set D339,13253
.set D340,13315
.set D341,13348
.set D342,13381
.set D343,13413
.set D344,13443
.set D345,13459
.set D346,13476
.set D347,13492
.set D348,13508
.set D349,13524
.set D350,13540
.set D351,13556
.set D352,13570
.set D353,13578
.set D354,13586
.set D355,13594
.set D356,13602
.set D357,13610
.set D358,13618
.set D359,13625
.set D360,13633
.set D361,13641
.set D362,13649
.set D363,13656
.set D364,13664
.set D365,13671
.set D366,13679
.set D367,13686
.set D368,13694
.set D369,13699
.set D370,13702
.set D371,13706
.set D372,13710
.set D373,13713
.set D374,13717
.set D375,13720
.set D376,13724
.set D377,13727
.set D378,13731
.set D379,13734
.set D380,13737
.set D381,13741
.set D382,13744
.set D383,13747
.set D384,13750
.set D385,13754
.set D386,13757
.set D387,13760
.set D388,13763
.set D389,13766
.set D390,13769
.set D391,13772
.set D392,13775
.set D393,13778
.set D394,13781
.set D395,13783
.set D396,13786
.set D397,13789
.set D398,13792
.set D399,13794
.set D400,13797
.set D401,13799
.set D402,13802
.set D403,13804
.set D404,13807
.set D405,13809
.set D406,13811
.set D407,13814
.set D408,13816
.set D409,13818
.set D410,13820
.set D411,13822
.set D412,13824
.set D413,13825
.set D414,13826
.set D415,13827
.set D416,13828
.set D417,13829
.set D418,13830
.set D419,13830
.set D420,13831
.set D421,13832
.set D422,13833
.set D423,13833
.set D424,13834
.set D425,13835
.set D426,13835
.set D427,13836
.set D428,13837
.set D429,13837
.set D430,13838
.set D431,13838
.set D432,13839
.set D433,13839
.set D434,13839
.set D435,13840
.set D436,13840
.set D437,13841
.set D438,13841
.set D439,13841
.set D440,13841
.set D441,13842
.set D442,13842
.set D443,13842
.set D444,13842
.set D445,13842
.set D446,13842
.set D447,13842
.set D448,13714
.set D449,46482
.set KA0,0
.set KB0,0
.set KC0,448
.set KD0,448
.set KA1,2
.set KB1,0
.set KC1,448
.set KD1,0
.set KA2,4
.set KB2,0
.set KC2,448
.set KD2,0
.set KA3,6
.set KB3,0
.set KC3,448
.set KD3,0
.set KA4,8
.set KB4,0
.set KC4,448
.set KD4,0
.set KA5,10
.set KB5,0
.set KC5,448
.set KD5,0
.set KA6,12
.set KB6,0
.set KC6,448
.set KD6,0
.set KA7,14
.set KB7,0
.set KC7,448
.set KD7,0
.set KA8,16
.set KB8,0
.set KC8,448
.set KD8,0
.set KA9,18
.set KB9,0
.set KC9,448
.set KD9,0
.set KA10,20
.set KB10,0
.set KC10,448
.set KD10,0
.set KA11,22
.set KB11,0
.set KC11,448
.set KD11,0
.set KA12,24
.set KB12,0
.set KC12,448
.set KD12,0
.set KA13,26
.set KB13,0
.set KC13,448
.set KD13,0
.set KA14,28
.set KB14,0
.set KC14,448
.set KD14,0
.set KA15,30
.set KB15,0
.set KC15,448
.set KD15,0
.set KA16,32
.set KB16,0
.set KC16,448
.set KD16,0
.set KA17,34
.set KB17,0
.set KC17,448
.set KD17,0
.set KA18,36
.set KB18,0
.set KC18,448
.set KD18,0
.set KA19,38
.set KB19,0
.set KC19,448
.set KD19,0
.set KA20,40
.set KB20,0
.set KC20,448
.set KD20,0
.set KA21,42
.set KB21,0
.set KC21,448
.set KD21,0
.set KA22,44
.set KB22,0
.set KC22,448
.set KD22,0
.set KA23,46
.set KB23,0
.set KC23,448
.set KD23,0
.set KA24,48
.set KB24,0
.set KC24,448
.set KD24,0
.set KA25,50
.set KB25,0
.set KC25,448
.set KD25,0
.set KA26,52
.set KB26,0
.set KC26,448
.set KD26,0
.set KA27,54
.set KB27,0
.set KC27,448
.set KD27,0
.set KA28,56
.set KB28,0
.set KC28,448
.set KD28,0
.set KA29,58
.set KB29,0
.set KC29,448
.set KD29,0
.set KA30,60
.set KB30,0
.set KC30,448
.set KD30,0
.set KA31,62
.set KB31,0
.set KC31,448
.set KD31,0
.set KA32,64
.set KB32,0
.set KC32,448
.set KD32,0
.set KA33,66
.set KB33,0
.set KC33,448
.set KD33,0
.set KA34,68
.set KB34,0
.set KC34,448
.set KD34,0
.set KA35,70
.set KB35,0
.set KC35,448
.set KD35,0
.set KA36,72
.set KB36,0
.set KC36,448
.set KD36,0
.set KA37,74
.set KB37,0
.set KC37,448
.set KD37,0
.set KA38,76
.set KB38,0
.set KC38,448
.set KD38,0
.set KA39,78
.set KB39,0
.set KC39,448
.set KD39,0
.set KA40,80
.set KB40,0
.set KC40,448
.set KD40,0
.set KA41,82
.set KB41,0
.set KC41,448
.set KD41,0
.set KA42,84
.set KB42,0
.set KC42,448
.set KD42,0
.set KA43,86
.set KB43,0
.set KC43,448
.set KD43,0
.set KA44,88
.set KB44,0
.set KC44,448
.set KD44,0
.set KA45,90
.set KB45,0
.set KC45,448
.set KD45,0
.set KA46,92
.set KB46,0
.set KC46,448
.set KD46,0
.set KA47,94
.set KB47,0
.set KC47,448
.set KD47,0
.set KA48,96
.set KB48,0
.set KC48,448
.set KD48,0
.set KA49,98
.set KB49,0
.set KC49,448
.set KD49,0
.set KA50,100
.set KB50,0
.set KC50,448
.set KD50,0
.set KA51,102
.set KB51,0
.set KC51,448
.set KD51,0
.set KA52,104
.set KB52,0
.set KC52,448
.set KD52,0
.set KA53,106
.set KB53,0
.set KC53,448
.set KD53,0
.set KA54,108
.set KB54,0
.set KC54,448
.set KD54,0
.set KA55,110
.set KB55,0
.set KC55,448
.set KD55,0
.set KA56,112
.set KB56,0
.set KC56,448
.set KD56,0
.set KA57,114
.set KB57,0
.set KC57,448
.set KD57,0
.set KA58,116
.set KB58,0
.set KC58,448
.set KD58,0
.set KA59,118
.set KB59,0
.set KC59,448
.set KD59,0
.set KA60,120
.set KB60,0
.set KC60,448
.set KD60,0
.set KA61,122
.set KB61,0
.set KC61,448
.set KD61,0
.set KA62,124
.set KB62,0
.set KC62,448
.set KD62,0
.set KA63,126
.set KB63,0
.set KC63,448
.set KD63,0
.set KA64,128
.set KB64,0
.set KC64,448
.set KD64,0
.set KA65,130
.set KB65,0
.set KC65,448
.set KD65,0
.set KA66,132
.set KB66,0
.set KC66,448
.set KD66,0
.set KA67,134
.set KB67,0
.set KC67,448
.set KD67,0
.set KA68,136
.set KB68,0
.set KC68,448
.set KD68,0
.set KA69,138
.set KB69,0
.set KC69,448
.set KD69,0
.set KA70,140
.set KB70,0
.set KC70,448
.set KD70,0
.set KA71,142
.set KB71,0
.set KC71,448
.set KD71,0
.set KA72,144
.set KB72,0
.set KC72,448
.set KD72,0
.set KA73,146
.set KB73,0
.set KC73,448
.set KD73,0
.set KA74,148
.set KB74,0
.set KC74,448
.set KD74,0
.set KA75,150
.set KB75,0
.set KC75,448
.set KD75,0
.set KA76,152
.set KB76,0
.set KC76,448
.set KD76,0
.set KA77,154
.set KB77,0
.set KC77,448
.set KD77,0
.set KA78,156
.set KB78,0
.set KC78,448
.set KD78,0
.set KA79,158
.set KB79,0
.set KC79,448
.set KD79,0
.set KA80,160
.set KB80,0
.set KC80,448
.set KD80,0
.set KA81,162
.set KB81,0
.set KC81,448
.set KD81,0
.set KA82,164
.set KB82,0
.set KC82,448
.set KD82,0
.set KA83,166
.set KB83,0
.set KC83,448
.set KD83,0
.set KA84,168
.set KB84,0
.set KC84,448
.set KD84,0
.set KA85,170
.set KB85,0
.set KC85,448
.set KD85,0
.set KA86,172
.set KB86,0
.set KC86,448
.set KD86,0
.set KA87,174
.set KB87,0
.set KC87,448
.set KD87,0
.set KA88,176
.set KB88,0
.set KC88,448
.set KD88,0
.set KA89,178
.set KB89,0
.set KC89,448
.set KD89,0
.set KA90,180
.set KB90,0
.set KC90,448
.set KD90,0
.set KA91,182
.set KB91,0
.set KC91,448
.set KD91,0
.set KA92,184
.set KB92,0
.set KC92,448
.set KD92,0
.set KA93,186
.set KB93,0
.set KC93,448
.set KD93,0
.set KA94,188
.set KB94,0
.set KC94,448
.set KD94,0
.set KA95,190
.set KB95,0
.set KC95,448
.set KD95,0
.set KA96,192
.set KB96,0
.set KC96,448
.set KD96,0
.set KA97,194
.set KB97,0
.set KC97,448
.set KD97,0
.set KA98,196
.set KB98,0
.set KC98,448
.set KD98,0
.set KA99,198
.set KB99,0
.set KC99,448
.set KD99,0
.set KA100,200
.set KB100,0
.set KC100,448
.set KD100,0
.set KA101,202
.set KB101,0
.set KC101,448
.set KD101,0
.set KA102,204
.set KB102,0
.set KC102,448
.set KD102,0
.set KA103,206
.set KB103,0
.set KC103,448
.set KD103,0
.set KA104,208
.set KB104,0
.set KC104,448
.set KD104,0
.set KA105,210
.set KB105,0
.set KC105,448
.set KD105,0
.set KA106,212
.set KB106,0
.set KC106,448
.set KD106,0
.set KA107,214
.set KB107,0
.set KC107,448
.set KD107,0
.set KA108,216
.set KB108,0
.set KC108,448
.set KD108,0
.set KA109,218
.set KB109,0
.set KC109,448
.set KD109,0
.set KA110,220
.set KB110,0
.set KC110,448
.set KD110,0
.set KA111,222
.set KB111,0
.set KC111,448
.set KD111,0
.set KA112,1
.set KB112,0
.set KC112,2
.set KD112,448
.set KA113,2
.set KB113,112
.set KC113,448
.set KD113,0
.set KA114,4
.set KB114,112
.set KC114,448
.set KD114,0
.set KA115,6
.set KB115,112
.set KC115,448
.set KD115,0
.set KA116,8
.set KB116,112
.set KC116,448
.set KD116,0
.set KA117,10
.set KB117,112
.set KC117,448
.set KD117,0
.set KA118,12
.set KB118,112
.set KC118,448
.set KD118,0
.set KA119,14
.set KB119,112
.set KC119,448
.set KD119,0
.set KA120,16
.set KB120,112
.set KC120,448
.set KD120,0
.set KA121,18
.set KB121,112
.set KC121,448
.set KD121,0
.set KA122,20
.set KB122,112
.set KC122,448
.set KD122,0
.set KA123,22
.set KB123,112
.set KC123,448
.set KD123,0
.set KA124,24
.set KB124,112
.set KC124,448
.set KD124,0
.set KA125,26
.set KB125,112
.set KC125,448
.set KD125,0
.set KA126,28
.set KB126,112
.set KC126,448
.set KD126,0
.set KA127,30
.set KB127,112
.set KC127,448
.set KD127,0
.set KA128,32
.set KB128,112
.set KC128,448
.set KD128,0
.set KA129,34
.set KB129,112
.set KC129,448
.set KD129,0
.set KA130,36
.set KB130,112
.set KC130,448
.set KD130,0
.set KA131,38
.set KB131,112
.set KC131,448
.set KD131,0
.set KA132,40
.set KB132,112
.set KC132,448
.set KD132,0
.set KA133,42
.set KB133,112
.set KC133,448
.set KD133,0
.set KA134,44
.set KB134,112
.set KC134,448
.set KD134,0
.set KA135,46
.set KB135,112
.set KC135,448
.set KD135,0
.set KA136,48
.set KB136,112
.set KC136,448
.set KD136,0
.set KA137,50
.set KB137,112
.set KC137,448
.set KD137,0
.set KA138,52
.set KB138,112
.set KC138,448
.set KD138,0
.set KA139,54
.set KB139,112
.set KC139,448
.set KD139,0
.set KA140,56
.set KB140,112
.set KC140,448
.set KD140,0
.set KA141,58
.set KB141,112
.set KC141,448
.set KD141,0
.set KA142,60
.set KB142,112
.set KC142,448
.set KD142,0
.set KA143,62
.set KB143,112
.set KC143,448
.set KD143,0
.set KA144,64
.set KB144,112
.set KC144,448
.set KD144,0
.set KA145,66
.set KB145,112
.set KC145,448
.set KD145,0
.set KA146,68
.set KB146,112
.set KC146,448
.set KD146,0
.set KA147,70
.set KB147,112
.set KC147,448
.set KD147,0
.set KA148,72
.set KB148,112
.set KC148,448
.set KD148,0
.set KA149,74
.set KB149,112
.set KC149,448
.set KD149,0
.set KA150,76
.set KB150,112
.set KC150,448
.set KD150,0
.set KA151,78
.set KB151,112
.set KC151,448
.set KD151,0
.set KA152,80
.set KB152,112
.set KC152,448
.set KD152,0
.set KA153,82
.set KB153,112
.set KC153,448
.set KD153,0
.set KA154,84
.set KB154,112
.set KC154,448
.set KD154,0
.set KA155,86
.set KB155,112
.set KC155,448
.set KD155,0
.set KA156,88
.set KB156,112
.set KC156,448
.set KD156,0
.set KA157,90
.set KB157,112
.set KC157,448
.set KD157,0
.set KA158,92
.set KB158,112
.set KC158,448
.set KD158,0
.set KA159,94
.set KB159,112
.set KC159,448
.set KD159,0
.set KA160,96
.set KB160,112
.set KC160,448
.set KD160,0
.set KA161,98
.set KB161,112
.set KC161,448
.set KD161,0
.set KA162,100
.set KB162,112
.set KC162,448
.set KD162,0
.set KA163,102
.set KB163,112
.set KC163,448
.set KD163,0
.set KA164,104
.set KB164,112
.set KC164,448
.set KD164,0
.set KA165,106
.set KB165,112
.set KC165,448
.set KD165,0
.set KA166,108
.set KB166,112
.set KC166,448
.set KD166,0
.set KA167,110
.set KB167,112
.set KC167,448
.set KD167,0
.set KA168,112
.set KB168,112
.set KC168,448
.set KD168,0
.set KA169,114
.set KB169,112
.set KC169,448
.set KD169,0
.set KA170,116
.set KB170,112
.set KC170,448
.set KD170,0
.set KA171,118
.set KB171,112
.set KC171,448
.set KD171,0
.set KA172,120
.set KB172,112
.set KC172,448
.set KD172,0
.set KA173,122
.set KB173,112
.set KC173,448
.set KD173,0
.set KA174,124
.set KB174,112
.set KC174,448
.set KD174,0
.set KA175,126
.set KB175,112
.set KC175,448
.set KD175,0
.set KA176,128
.set KB176,112
.set KC176,448
.set KD176,0
.set KA177,130
.set KB177,112
.set KC177,448
.set KD177,0
.set KA178,132
.set KB178,112
.set KC178,448
.set KD178,0
.set KA179,134
.set KB179,112
.set KC179,448
.set KD179,0
.set KA180,136
.set KB180,112
.set KC180,448
.set KD180,0
.set KA181,138
.set KB181,112
.set KC181,448
.set KD181,0
.set KA182,140
.set KB182,112
.set KC182,448
.set KD182,0
.set KA183,142
.set KB183,112
.set KC183,448
.set KD183,0
.set KA184,144
.set KB184,112
.set KC184,448
.set KD184,0
.set KA185,146
.set KB185,112
.set KC185,448
.set KD185,0
.set KA186,148
.set KB186,112
.set KC186,448
.set KD186,0
.set KA187,150
.set KB187,112
.set KC187,448
.set KD187,0
.set KA188,152
.set KB188,112
.set KC188,448
.set KD188,0
.set KA189,154
.set KB189,112
.set KC189,448
.set KD189,0
.set KA190,156
.set KB190,112
.set KC190,448
.set KD190,0
.set KA191,158
.set KB191,112
.set KC191,448
.set KD191,0
.set KA192,160
.set KB192,112
.set KC192,448
.set KD192,0
.set KA193,162
.set KB193,112
.set KC193,448
.set KD193,0
.set KA194,164
.set KB194,112
.set KC194,448
.set KD194,0
.set KA195,166
.set KB195,112
.set KC195,448
.set KD195,0
.set KA196,168
.set KB196,112
.set KC196,448
.set KD196,0
.set KA197,170
.set KB197,112
.set KC197,448
.set KD197,0
.set KA198,172
.set KB198,112
.set KC198,448
.set KD198,0
.set KA199,174
.set KB199,112
.set KC199,448
.set KD199,0
.set KA200,176
.set KB200,112
.set KC200,448
.set KD200,0
.set KA201,178
.set KB201,112
.set KC201,448
.set KD201,0
.set KA202,180
.set KB202,112
.set KC202,448
.set KD202,0
.set KA203,182
.set KB203,112
.set KC203,448
.set KD203,0
.set KA204,184
.set KB204,112
.set KC204,448
.set KD204,0
.set KA205,186
.set KB205,112
.set KC205,448
.set KD205,0
.set KA206,188
.set KB206,112
.set KC206,448
.set KD206,0
.set KA207,190
.set KB207,112
.set KC207,448
.set KD207,0
.set KA208,192
.set KB208,112
.set KC208,448
.set KD208,0
.set KA209,194
.set KB209,112
.set KC209,448
.set KD209,0
.set KA210,196
.set KB210,112
.set KC210,448
.set KD210,0
.set KA211,198
.set KB211,112
.set KC211,448
.set KD211,0
.set KA212,200
.set KB212,112
.set KC212,448
.set KD212,0
.set KA213,202
.set KB213,112
.set KC213,448
.set KD213,0
.set KA214,204
.set KB214,112
.set KC214,448
.set KD214,0
.set KA215,206
.set KB215,112
.set KC215,448
.set KD215,0
.set KA216,208
.set KB216,112
.set KC216,448
.set KD216,0
.set KA217,210
.set KB217,112
.set KC217,448
.set KD217,0
.set KA218,212
.set KB218,112
.set KC218,448
.set KD218,0
.set KA219,214
.set KB219,112
.set KC219,448
.set KD219,0
.set KA220,216
.set KB220,112
.set KC220,448
.set KD220,0
.set KA221,218
.set KB221,112
.set KC221,448
.set KD221,0
.set KA222,220
.set KB222,112
.set KC222,448
.set KD222,0
.set KA223,222
.set KB223,112
.set KC223,448
.set KD223,0
.set KA224,1
.set KB224,0
.set KC224,448
.set KD224,0
.set KA225,3
.set KB225,0
.set KC225,448
.set KD225,0
.set KA226,5
.set KB226,0
.set KC226,448
.set KD226,0
.set KA227,7
.set KB227,0
.set KC227,448
.set KD227,0
.set KA228,9
.set KB228,0
.set KC228,448
.set KD228,0
.set KA229,11
.set KB229,0
.set KC229,448
.set KD229,0
.set KA230,13
.set KB230,0
.set KC230,448
.set KD230,0
.set KA231,15
.set KB231,0
.set KC231,448
.set KD231,0
.set KA232,17
.set KB232,0
.set KC232,448
.set KD232,0
.set KA233,19
.set KB233,0
.set KC233,448
.set KD233,0
.set KA234,21
.set KB234,0
.set KC234,448
.set KD234,0
.set KA235,23
.set KB235,0
.set KC235,448
.set KD235,0
.set KA236,25
.set KB236,0
.set KC236,448
.set KD236,0
.set KA237,27
.set KB237,0
.set KC237,448
.set KD237,0
.set KA238,29
.set KB238,0
.set KC238,448
.set KD238,0
.set KA239,31
.set KB239,0
.set KC239,448
.set KD239,0
.set KA240,33
.set KB240,0
.set KC240,448
.set KD240,0
.set KA241,35
.set KB241,0
.set KC241,448
.set KD241,0
.set KA242,37
.set KB242,0
.set KC242,448
.set KD242,0
.set KA243,39
.set KB243,0
.set KC243,448
.set KD243,0
.set KA244,41
.set KB244,0
.set KC244,448
.set KD244,0
.set KA245,43
.set KB245,0
.set KC245,448
.set KD245,0
.set KA246,45
.set KB246,0
.set KC246,448
.set KD246,0
.set KA247,47
.set KB247,0
.set KC247,448
.set KD247,0
.set KA248,49
.set KB248,0
.set KC248,448
.set KD248,0
.set KA249,51
.set KB249,0
.set KC249,448
.set KD249,0
.set KA250,53
.set KB250,0
.set KC250,448
.set KD250,0
.set KA251,55
.set KB251,0
.set KC251,448
.set KD251,0
.set KA252,57
.set KB252,0
.set KC252,448
.set KD252,0
.set KA253,59
.set KB253,0
.set KC253,448
.set KD253,0
.set KA254,61
.set KB254,0
.set KC254,448
.set KD254,0
.set KA255,63
.set KB255,0
.set KC255,448
.set KD255,0
.set KA256,65
.set KB256,0
.set KC256,448
.set KD256,0
.set KA257,67
.set KB257,0
.set KC257,448
.set KD257,0
.set KA258,69
.set KB258,0
.set KC258,448
.set KD258,0
.set KA259,71
.set KB259,0
.set KC259,448
.set KD259,0
.set KA260,73
.set KB260,0
.set KC260,448
.set KD260,0
.set KA261,75
.set KB261,0
.set KC261,448
.set KD261,0
.set KA262,77
.set KB262,0
.set KC262,448
.set KD262,0
.set KA263,79
.set KB263,0
.set KC263,448
.set KD263,0
.set KA264,81
.set KB264,0
.set KC264,448
.set KD264,0
.set KA265,83
.set KB265,0
.set KC265,448
.set KD265,0
.set KA266,85
.set KB266,0
.set KC266,448
.set KD266,0
.set KA267,87
.set KB267,0
.set KC267,448
.set KD267,0
.set KA268,89
.set KB268,0
.set KC268,448
.set KD268,0
.set KA269,91
.set KB269,0
.set KC269,448
.set KD269,0
.set KA270,93
.set KB270,0
.set KC270,448
.set KD270,0
.set KA271,95
.set KB271,0
.set KC271,448
.set KD271,0
.set KA272,97
.set KB272,0
.set KC272,448
.set KD272,0
.set KA273,99
.set KB273,0
.set KC273,448
.set KD273,0
.set KA274,101
.set KB274,0
.set KC274,448
.set KD274,0
.set KA275,103
.set KB275,0
.set KC275,448
.set KD275,0
.set KA276,105
.set KB276,0
.set KC276,448
.set KD276,0
.set KA277,107
.set KB277,0
.set KC277,448
.set KD277,0
.set KA278,109
.set KB278,0
.set KC278,448
.set KD278,0
.set KA279,111
.set KB279,0
.set KC279,448
.set KD279,0
.set KA280,113
.set KB280,0
.set KC280,448
.set KD280,0
.set KA281,115
.set KB281,0
.set KC281,448
.set KD281,0
.set KA282,117
.set KB282,0
.set KC282,448
.set KD282,0
.set KA283,119
.set KB283,0
.set KC283,448
.set KD283,0
.set KA284,121
.set KB284,0
.set KC284,448
.set KD284,0
.set KA285,123
.set KB285,0
.set KC285,448
.set KD285,0
.set KA286,125
.set KB286,0
.set KC286,448
.set KD286,0
.set KA287,127
.set KB287,0
.set KC287,448
.set KD287,0
.set KA288,129
.set KB288,0
.set KC288,448
.set KD288,0
.set KA289,131
.set KB289,0
.set KC289,448
.set KD289,0
.set KA290,133
.set KB290,0
.set KC290,448
.set KD290,0
.set KA291,135
.set KB291,0
.set KC291,448
.set KD291,0
.set KA292,137
.set KB292,0
.set KC292,448
.set KD292,0
.set KA293,139
.set KB293,0
.set KC293,448
.set KD293,0
.set KA294,141
.set KB294,0
.set KC294,448
.set KD294,0
.set KA295,143
.set KB295,0
.set KC295,448
.set KD295,0
.set KA296,145
.set KB296,0
.set KC296,448
.set KD296,0
.set KA297,147
.set KB297,0
.set KC297,448
.set KD297,0
.set KA298,149
.set KB298,0
.set KC298,448
.set KD298,0
.set KA299,151
.set KB299,0
.set KC299,448
.set KD299,0
.set KA300,153
.set KB300,0
.set KC300,448
.set KD300,0
.set KA301,155
.set KB301,0
.set KC301,448
.set KD301,0
.set KA302,157
.set KB302,0
.set KC302,448
.set KD302,0
.set KA303,159
.set KB303,0
.set KC303,448
.set KD303,0
.set KA304,161
.set KB304,0
.set KC304,448
.set KD304,0
.set KA305,163
.set KB305,0
.set KC305,448
.set KD305,0
.set KA306,165
.set KB306,0
.set KC306,448
.set KD306,0
.set KA307,167
.set KB307,0
.set KC307,448
.set KD307,0
.set KA308,169
.set KB308,0
.set KC308,448
.set KD308,0
.set KA309,171
.set KB309,0
.set KC309,448
.set KD309,0
.set KA310,173
.set KB310,0
.set KC310,448
.set KD310,0
.set KA311,175
.set KB311,0
.set KC311,448
.set KD311,0
.set KA312,177
.set KB312,0
.set KC312,448
.set KD312,0
.set KA313,179
.set KB313,0
.set KC313,448
.set KD313,0
.set KA314,181
.set KB314,0
.set KC314,448
.set KD314,0
.set KA315,183
.set KB315,0
.set KC315,448
.set KD315,0
.set KA316,185
.set KB316,0
.set KC316,448
.set KD316,0
.set KA317,187
.set KB317,0
.set KC317,448
.set KD317,0
.set KA318,189
.set KB318,0
.set KC318,448
.set KD318,0
.set KA319,191
.set KB319,0
.set KC319,448
.set KD319,0
.set KA320,193
.set KB320,0
.set KC320,448
.set KD320,0
.set KA321,195
.set KB321,0
.set KC321,448
.set KD321,0
.set KA322,197
.set KB322,0
.set KC322,448
.set KD322,0
.set KA323,199
.set KB323,0
.set KC323,448
.set KD323,0
.set KA324,201
.set KB324,0
.set KC324,448
.set KD324,0
.set KA325,203
.set KB325,0
.set KC325,448
.set KD325,0
.set KA326,205
.set KB326,0
.set KC326,448
.set KD326,0
.set KA327,207
.set KB327,0
.set KC327,448
.set KD327,0
.set KA328,209
.set KB328,0
.set KC328,448
.set KD328,0
.set KA329,211
.set KB329,0
.set KC329,448
.set KD329,0
.set KA330,213
.set KB330,0
.set KC330,448
.set KD330,0
.set KA331,215
.set KB331,0
.set KC331,448
.set KD331,0
.set KA332,217
.set KB332,0
.set KC332,448
.set KD332,0
.set KA333,219
.set KB333,0
.set KC333,448
.set KD333,0
.set KA334,221
.set KB334,0
.set KC334,448
.set KD334,0
.set KA335,223
.set KB335,0
.set KC335,448
.set KD335,0
.set KA336,1
.set KB336,112
.set KC336,448
.set KD336,0
.set KA337,3
.set KB337,112
.set KC337,448
.set KD337,0
.set KA338,5
.set KB338,112
.set KC338,448
.set KD338,0
.set KA339,7
.set KB339,112
.set KC339,448
.set KD339,0
.set KA340,9
.set KB340,112
.set KC340,448
.set KD340,0
.set KA341,11
.set KB341,112
.set KC341,448
.set KD341,0
.set KA342,13
.set KB342,112
.set KC342,448
.set KD342,0
.set KA343,15
.set KB343,112
.set KC343,448
.set KD343,0
.set KA344,17
.set KB344,112
.set KC344,448
.set KD344,0
.set KA345,19
.set KB345,112
.set KC345,448
.set KD345,0
.set KA346,21
.set KB346,112
.set KC346,448
.set KD346,0
.set KA347,23
.set KB347,112
.set KC347,448
.set KD347,0
.set KA348,25
.set KB348,112
.set KC348,448
.set KD348,0
.set KA349,27
.set KB349,112
.set KC349,448
.set KD349,0
.set KA350,29
.set KB350,112
.set KC350,448
.set KD350,0
.set KA351,31
.set KB351,112
.set KC351,448
.set KD351,0
.set KA352,33
.set KB352,112
.set KC352,448
.set KD352,0
.set KA353,35
.set KB353,112
.set KC353,448
.set KD353,0
.set KA354,37
.set KB354,112
.set KC354,448
.set KD354,0
.set KA355,39
.set KB355,112
.set KC355,448
.set KD355,0
.set KA356,41
.set KB356,112
.set KC356,448
.set KD356,0
.set KA357,43
.set KB357,112
.set KC357,448
.set KD357,0
.set KA358,45
.set KB358,112
.set KC358,448
.set KD358,0
.set KA359,47
.set KB359,112
.set KC359,448
.set KD359,0
.set KA360,49
.set KB360,112
.set KC360,448
.set KD360,0
.set KA361,51
.set KB361,112
.set KC361,448
.set KD361,0
.set KA362,53
.set KB362,112
.set KC362,448
.set KD362,0
.set KA363,55
.set KB363,112
.set KC363,448
.set KD363,0
.set KA364,57
.set KB364,112
.set KC364,448
.set KD364,0
.set KA365,59
.set KB365,112
.set KC365,448
.set KD365,0
.set KA366,61
.set KB366,112
.set KC366,448
.set KD366,0
.set KA367,63
.set KB367,112
.set KC367,448
.set KD367,0
.set KA368,65
.set KB368,112
.set KC368,448
.set KD368,0
.set KA369,67
.set KB369,112
.set KC369,448
.set KD369,0
.set KA370,69
.set KB370,112
.set KC370,448
.set KD370,0
.set KA371,71
.set KB371,112
.set KC371,448
.set KD371,0
.set KA372,73
.set KB372,112
.set KC372,448
.set KD372,0
.set KA373,75
.set KB373,112
.set KC373,448
.set KD373,0
.set KA374,77
.set KB374,112
.set KC374,448
.set KD374,0
.set KA375,79
.set KB375,112
.set KC375,448
.set KD375,0
.set KA376,81
.set KB376,112
.set KC376,448
.set KD376,0
.set KA377,83
.set KB377,112
.set KC377,448
.set KD377,0
.set KA378,85
.set KB378,112
.set KC378,448
.set KD378,0
.set KA379,87
.set KB379,112
.set KC379,448
.set KD379,0
.set KA380,89
.set KB380,112
.set KC380,448
.set KD380,0
.set KA381,91
.set KB381,112
.set KC381,448
.set KD381,0
.set KA382,93
.set KB382,112
.set KC382,448
.set KD382,0
.set KA383,95
.set KB383,112
.set KC383,448
.set KD383,0
.set KA384,97
.set KB384,112
.set KC384,448
.set KD384,0
.set KA385,99
.set KB385,112
.set KC385,448
.set KD385,0
.set KA386,101
.set KB386,112
.set KC386,448
.set KD386,0
.set KA387,103
.set KB387,112
.set KC387,448
.set KD387,0
.set KA388,105
.set KB388,112
.set KC388,448
.set KD388,0
.set KA389,107
.set KB389,112
.set KC389,448
.set KD389,0
.set KA390,109
.set KB390,112
.set KC390,448
.set KD390,0
.set KA391,111
.set KB391,112
.set KC391,448
.set KD391,0
.set KA392,113
.set KB392,112
.set KC392,448
.set KD392,0
.set KA393,115
.set KB393,112
.set KC393,448
.set KD393,0
.set KA394,117
.set KB394,112
.set KC394,448
.set KD394,0
.set KA395,119
.set KB395,112
.set KC395,448
.set KD395,0
.set KA396,121
.set KB396,112
.set KC396,448
.set KD396,0
.set KA397,123
.set KB397,112
.set KC397,448
.set KD397,0
.set KA398,125
.set KB398,112
.set KC398,448
.set KD398,0
.set KA399,127
.set KB399,112
.set KC399,448
.set KD399,0
.set KA400,129
.set KB400,112
.set KC400,448
.set KD400,0
.set KA401,131
.set KB401,112
.set KC401,448
.set KD401,0
.set KA402,133
.set KB402,112
.set KC402,448
.set KD402,0
.set KA403,135
.set KB403,112
.set KC403,448
.set KD403,0
.set KA404,137
.set KB404,112
.set KC404,448
.set KD404,0
.set KA405,139
.set KB405,112
.set KC405,448
.set KD405,0
.set KA406,141
.set KB406,112
.set KC406,448
.set KD406,0
.set KA407,143
.set KB407,112
.set KC407,448
.set KD407,0
.set KA408,145
.set KB408,112
.set KC408,448
.set KD408,0
.set KA409,147
.set KB409,112
.set KC409,448
.set KD409,0
.set KA410,149
.set KB410,112
.set KC410,448
.set KD410,0
.set KA411,151
.set KB411,112
.set KC411,448
.set KD411,0
.set KA412,153
.set KB412,112
.set KC412,448
.set KD412,0
.set KA413,155
.set KB413,112
.set KC413,448
.set KD413,0
.set KA414,157
.set KB414,112
.set KC414,448
.set KD414,0
.set KA415,159
.set KB415,112
.set KC415,448
.set KD415,0
.set KA416,161
.set KB416,112
.set KC416,448
.set KD416,0
.set KA417,163
.set KB417,112
.set KC417,448
.set KD417,0
.set KA418,165
.set KB418,112
.set KC418,448
.set KD418,0
.set KA419,167
.set KB419,112
.set KC419,448
.set KD419,0
.set KA420,169
.set KB420,112
.set KC420,448
.set KD420,0
.set KA421,171
.set KB421,112
.set KC421,448
.set KD421,0
.set KA422,173
.set KB422,112
.set KC422,448
.set KD422,0
.set KA423,175
.set KB423,112
.set KC423,448
.set KD423,0
.set KA424,177
.set KB424,112
.set KC424,448
.set KD424,0
.set KA425,179
.set KB425,112
.set KC425,448
.set KD425,0
.set KA426,181
.set KB426,112
.set KC426,448
.set KD426,0
.set KA427,183
.set KB427,112
.set KC427,448
.set KD427,0
.set KA428,185
.set KB428,112
.set KC428,448
.set KD428,0
.set KA429,187
.set KB429,112
.set KC429,448
.set KD429,0
.set KA430,189
.set KB430,112
.set KC430,448
.set KD430,0
.set KA431,191
.set KB431,112
.set KC431,448
.set KD431,0
.set KA432,193
.set KB432,112
.set KC432,448
.set KD432,0
.set KA433,195
.set KB433,112
.set KC433,448
.set KD433,0
.set KA434,197
.set KB434,112
.set KC434,448
.set KD434,0
.set KA435,199
.set KB435,112
.set KC435,448
.set KD435,0
.set KA436,201
.set KB436,112
.set KC436,448
.set KD436,0
.set KA437,203
.set KB437,112
.set KC437,448
.set KD437,0
.set KA438,205
.set KB438,112
.set KC438,448
.set KD438,0
.set KA439,207
.set KB439,112
.set KC439,448
.set KD439,0
.set KA440,209
.set KB440,112
.set KC440,448
.set KD440,0
.set KA441,211
.set KB441,112
.set KC441,448
.set KD441,0
.set KA442,213
.set KB442,112
.set KC442,448
.set KD442,0
.set KA443,215
.set KB443,112
.set KC443,448
.set KD443,0
.set KA444,217
.set KB444,112
.set KC444,448
.set KD444,0
.set KA445,219
.set KB445,112
.set KC445,448
.set KD445,0
.set KA446,221
.set KB446,112
.set KC446,448
.set KD446,0
.set KA447,223
.set KB447,112
.set KC447,448
.set KD447,0
.altmacro
.macro FW4 a,b,c,d
.short C\a,C\b,C\c,C\d
.endm
.macro LK i
.short D\i
.endm
.macro IV1 d,r
LK %((KA\r*\d+KB\r)%KC\r+KD\r)
.endm
.p2align 8
tab_fwd:
.set td,0
.rept 448
.set tg,0
.rept 14
.set tk,(tg>>1)*32
.set tp,(tg&1)*112
.rept 8
FW4 %((tk*td+tp)%448),%(((tk+1)*td+tp)%448),%(((tk+2)*td+tp)%448),%(((tk+3)*td+tp)%448)
.set tk,tk+4
.endr
.set tg,tg+1
.endr
FW4 %((224*td)%448),112,112,112
.fill 60,2,0
.set td,td+1
.endr
.p2align 8
tab_inv:
.set tn,0
.rept 14
.set tc,0
.rept 28
.set tr,tc*16
.set tl,0
.rept 64
.set tj,0
.rept 8
IV1 %(tn*32+(tl&31)),%(tr+(tl>>5)*8+tj)
.set tj,tj+1
.endr
.set tl,tl+1
.endr
.set tc,tc+1
.endr
.set tn,tn+1
.endr
.noaltmacro
```
